```python
import torch

def _softmax(x, axis=-1):
    return torch.softmax(x, dim=axis)
def _gelu(x):
    return torch.nn.functional.gelu(x, approximate="tanh")
def _silu(x):
    return torch.nn.functional.silu(x)
def _sigmoid(x):
    return torch.sigmoid(x)
def _layernorm(x, axis=-1, eps=1e-5):
    m = x.mean(dim=axis, keepdim=True)
    v = x.var(dim=axis, keepdim=True, unbiased=False)
    return (x - m) / torch.sqrt(v + eps)
def _scatter_add(tgt, idx, src, axis=0):
    return tgt.clone().index_add_(axis, idx, src)
def _segment_sum(src, seg, n):
    out = torch.zeros((n,) + src.shape[1:], dtype=src.dtype)
    return out.index_add_(0, seg, src)
def _pad(x, pw):
    flat = tuple(v for pair in reversed(pw) for v in pair)
    return torch.nn.functional.pad(x, flat)

kernel_name = 'standalone__mha_softmax__near_ridge'

def setup_inputs():

    _w = (lambda a: (lambda t: t.to(torch.bfloat16) if t.is_floating_point() else t)(torch.as_tensor(a)))
    B, H, Sq, Sk, D = 8, 32, 624, 1024, 128
    return {
        "q": _w((lambda *s: torch.randn(*s, dtype=torch.bfloat16) * 0.8)(B, H, Sq, D)),
        "k": _w((lambda *s: torch.randn(*s, dtype=torch.bfloat16) * 0.8)(B, H, Sk, D)),
        "v": _w((lambda *s: torch.randn(*s, dtype=torch.bfloat16) * 0.05)(B, H, Sk, D)),
    }

def reference(q, k, v):
    scale = q.shape[-1] ** -0.5
    scores = torch.einsum("bhqd,bhkd->bhqk", q, k) * scale
    p = _softmax(scores, axis=-1)
    return torch.einsum("bhqk,bhkd->bhqd", p, v)
```

```asm
; @launch grid=(256,1,1) block=(256,1,1) lds=163840
.amdgcn_target "amdgcn-amd-amdhsa--gfx950"
.text
.globl standalone__mha_softmax__near_ridge_kernel
.p2align 8
.type standalone__mha_softmax__near_ridge_kernel,@function
standalone__mha_softmax__near_ridge_kernel:
    s_load_dwordx4 s[4:7], s[0:1], 0
    s_load_dwordx4 s[8:11], s[0:1], 16
    s_cmp_ge_u32 s2, 256
    s_cbranch_scc1 L_end
    v_lshrrev_b32 v72, 6, v0
    v_bfe_u32 v77, v0, 4, 2
    s_lshr_b32 s3, s2, 3
    v_lshl_add_u32 v252, s3, 2, v72
    v_readfirstlane_b32 s35, v72
    s_getpc_b64 s[58:59]
L_pc:
    v_lshl_add_u32 v252, v77, 7, v252
    v_lshlrev_b32 v252, 7, v252
    v_min_u32 v252, L_all_end-L_pc-4, v252
    global_load_dword a255, v252, s[58:59]
    v_and_b32 v231, 63, v0
    s_getreg_b32 s67, hwreg(HW_REG_XCC_ID, 0, 1)
    s_and_b32 s37, s2, 7
    s_lshl_b32 s37, s37, 5
    s_lshr_b32 s3, s2, 3
    s_and_b32 s36, s3, 1
    s_and_b32 s3, s3, 30
    s_add_u32 s37, s37, s3
    s_lshl_b32 s29, s35, 10
    s_mul_i32 s39, s35, 21504
    s_add_u32 s39, s39, 66560
    v_and_b32 v74, 15, v231
    v_lshrrev_b32 v75, 4, v231
    v_lshlrev_b32 v77, 2, v75
    v_xor_b32 v77, v74, v77
    v_lshlrev_b32 v77, 4, v77
    v_lshl_add_u32 v227, v75, 8, v77
    v_lshl_add_u32 v76, v72, 2, v75
    v_xor_b32 v77, v74, v76
    v_lshlrev_b32 v77, 4, v77
    v_lshl_add_u32 v224, v76, 8, v77
    v_and_b32 v77, 4, v76
    v_lshl_add_u32 v77, v77, 1, v75
    v_xor_b32 v77, v74, v77
    v_lshlrev_b32 v77, 4, v77
    v_lshl_add_u32 v225, v76, 8, v77
    s_mul_i32 s3, s37, 262144
    s_mov_b32 s14, 524288
    s_mov_b32 s15, 0x20000
    s_mov_b32 s18, 524288
    s_mov_b32 s19, 0x20000
    s_mov_b32 s28, 0
    s_mov_b32 s66, 0
    s_mov_b32 s40, 0
    s_mov_b32 s41, 4096
    s_mov_b32 s42, 8192
    s_mov_b32 s43, 12288
    s_mov_b32 s44, 16384
    s_xor_b32 s47, s36, 0
    s_mul_i32 s47, s47, 81920
    s_mul_i32 s48, s35, 20480
    s_add_u32 s47, s47, s48
    s_add_u32 s46, s37, 0
    s_mul_i32 s46, s46, 159744
    s_add_u32 s46, s46, s47
    s_sub_u32 s47, 159744, s47
    s_min_u32 s22, s47, 20480
    s_mov_b32 s23, 0x20000
    s_waitcnt lgkmcnt(0)
    s_add_u32 s20, s4, s46
    s_addc_u32 s21, s5, 0
    s_add_u32 s12, s6, s3
    s_addc_u32 s13, s7, 0
    s_add_u32 s16, s8, s3
    s_addc_u32 s17, s9, 0
    s_add_u32 m0, s29, 0
    s_nop 0
    buffer_load_dwordx4 v224, s[12:15], s28 offen lds
    s_add_u32 s28, s28, 4096
    s_add_u32 m0, s29, 4096
    s_nop 0
    buffer_load_dwordx4 v224, s[12:15], s28 offen lds
    s_add_u32 s28, s28, 4096
    s_add_u32 m0, s29, 8192
    s_nop 0
    buffer_load_dwordx4 v224, s[12:15], s28 offen lds
    s_add_u32 s28, s28, 4096
    s_add_u32 m0, s29, 12288
    s_nop 0
    buffer_load_dwordx4 v224, s[12:15], s28 offen lds
    s_add_u32 s28, s28, 4096
    s_cmp_lg_u32 s67, 0
    s_cbranch_scc1 L_deep1
    s_waitcnt vmcnt(0)
L_deep1:
    s_add_u32 m0, s39, 0
    s_nop 0
    buffer_load_dwordx4 v227, s[20:23], s40 offen offset:0 nt lds
    buffer_load_dwordx4 v227, s[20:23], s40 offen offset:1024 nt lds
    buffer_load_dwordx4 v227, s[20:23], s40 offen offset:2048 nt lds
    buffer_load_dwordx4 v227, s[20:23], s40 offen offset:3072 nt lds
    s_cmp_lg_u32 s67, 0
    s_cbranch_scc1 L_deep2
    s_waitcnt vmcnt(0)
L_deep2:
    s_add_u32 m0, s39, 4096
    s_nop 0
    buffer_load_dwordx4 v227, s[20:23], s41 offen offset:0 nt lds
    buffer_load_dwordx4 v227, s[20:23], s41 offen offset:1024 nt lds
    buffer_load_dwordx4 v227, s[20:23], s41 offen offset:2048 nt lds
    buffer_load_dwordx4 v227, s[20:23], s41 offen offset:3072 nt lds
    s_mov_b32 s34, 0
    s_mov_b32 s38, 0xffff0000
    s_mov_b32 s32, 0x3e0293ee
    s_mov_b32 s33, s32
    s_mov_b32 s30, 7
    s_mov_b32 s31, 0
    s_mov_b32 s74, s39
    s_add_u32 s75, s39, 20480
    s_lshl1_add_u32 s3, s35, s36
    s_mov_b32 s45, 0xc0800000
    s_cmp_eq_u32 s3, 7
    s_cselect_b32 s54, 0xc3800000, s45
    s_cmp_eq_u32 s3, 6
    s_cselect_b32 s55, 0xc3800000, s45
    v_add_u32 v77, 0, v75
    v_xor_b32 v77, v77, v74
    v_lshlrev_b32 v77, 4, v77
    v_lshl_add_u32 v212, v74, 8, v77
    v_add_u32 v77, 4, v75
    v_xor_b32 v77, v77, v74
    v_lshlrev_b32 v77, 4, v77
    v_lshl_add_u32 v213, v74, 8, v77
    v_add_u32 v77, 8, v75
    v_xor_b32 v77, v77, v74
    v_lshlrev_b32 v77, 4, v77
    v_lshl_add_u32 v214, v74, 8, v77
    v_add_u32 v77, 12, v75
    v_xor_b32 v77, v77, v74
    v_lshlrev_b32 v77, 4, v77
    v_lshl_add_u32 v215, v74, 8, v77
    v_lshrrev_b32 v77, 2, v231
    v_and_b32 v78, 3, v231
    v_lshlrev_b32 v229, 4, v231
    v_lshlrev_b32 v76, 4, v75
    v_lshl_add_u32 v76, v74, 8, v76
    v_lshl_add_u32 v76, v78, 6, v76
    v_add_u32 v230, s39, v76
    v_lshl_add_u32 v228, v231, 3, s39
    v_add_u32 v228, -1024, v228
    v_lshl_add_u32 v247, v75, 8, s39
    v_lshl_add_u32 v247, v78, 6, v247
    v_bfe_u32 v76, v231, 2, 2
    v_lshl_add_u32 v247, v76, 3, v247
    v_lshl_add_u32 v246, v74, 3, s39
    v_lshl_add_u32 v246, v75, 10, v246
    s_lshl_b32 s68, s35, 8
    s_add_u32 s68, s68, 152832
    v_lshl_add_u32 v244, v231, 2, s68
    v_lshl_add_u32 v245, v75, 4, s68
    v_lshlrev_b32 v248, 2, v231
    v_add_u32 v248, 152576, v248
    v_mov_b32 v249, 0
    ds_write_b32 v248, v249
    s_mov_b32 s69, 0
    s_mov_b32 s76, 0x5d800000
    v_and_b32 v78, 1, v231
    v_lshlrev_b32 v78, 3, v78
    v_lshl_add_u32 v78, v77, 8, v78
    v_and_b32 v76, 4, v77
    v_and_b32 v77, 3, v77
    v_lshl_add_u32 v77, v76, 1, v77
    v_and_b32 v76, 2, v231
    v_lshl_add_u32 v77, v76, 1, v77
    v_xor_b32 v76, 0, v77
    v_lshl_add_u32 v216, v76, 4, v78
    v_xor_b32 v76, 1, v77
    v_lshl_add_u32 v217, v76, 4, v78
    v_xor_b32 v76, 2, v77
    v_lshl_add_u32 v218, v76, 4, v78
    v_xor_b32 v76, 3, v77
    v_lshl_add_u32 v219, v76, 4, v78
    v_xor_b32 v76, 8, v77
    v_lshl_add_u32 v220, v76, 4, v78
    v_xor_b32 v76, 9, v77
    v_lshl_add_u32 v221, v76, 4, v78
    v_xor_b32 v76, 10, v77
    v_lshl_add_u32 v222, v76, 4, v78
    v_xor_b32 v76, 11, v77
    v_lshl_add_u32 v223, v76, 4, v78
    v_and_b32 v77, 1, v231
    v_mul_u32_u24 v77, 0xaaaa, v77
    v_add_u32 v226, 0x4444, v77
    v_lshrrev_b32 v77, 1, v74
    v_mov_b32 v76, 0x3f803f80
    v_cmp_eq_u32 vcc, 0, v77
    s_nop 1
    v_cndmask_b32 v78, 0, v76, vcc
    v_accvgpr_write_b32 a208, v78
    v_accvgpr_write_b32 a209, v78
    v_accvgpr_write_b32 a210, v78
    v_accvgpr_write_b32 a211, v78
    v_cmp_eq_u32 vcc, 1, v77
    s_nop 1
    v_cndmask_b32 v78, 0, v76, vcc
    v_accvgpr_write_b32 a212, v78
    v_accvgpr_write_b32 a213, v78
    v_accvgpr_write_b32 a214, v78
    v_accvgpr_write_b32 a215, v78
    v_cmp_eq_u32 vcc, 2, v77
    s_nop 1
    v_cndmask_b32 v78, 0, v76, vcc
    v_accvgpr_write_b32 a216, v78
    v_accvgpr_write_b32 a217, v78
    v_accvgpr_write_b32 a218, v78
    v_accvgpr_write_b32 a219, v78
    v_cmp_eq_u32 vcc, 3, v77
    s_nop 1
    v_cndmask_b32 v78, 0, v76, vcc
    v_accvgpr_write_b32 a220, v78
    v_accvgpr_write_b32 a221, v78
    v_accvgpr_write_b32 a222, v78
    v_accvgpr_write_b32 a223, v78
    v_cmp_eq_u32 vcc, 4, v77
    s_nop 1
    v_cndmask_b32 v78, 0, v76, vcc
    v_accvgpr_write_b32 a224, v78
    v_accvgpr_write_b32 a225, v78
    v_accvgpr_write_b32 a226, v78
    v_accvgpr_write_b32 a227, v78
    v_accvgpr_write_b32 a228, 0
    v_accvgpr_write_b32 a229, 0
    v_accvgpr_write_b32 a230, 0
    v_accvgpr_write_b32 a231, 0
    v_accvgpr_write_b32 a232, 0
    v_accvgpr_write_b32 a233, 0
    v_accvgpr_write_b32 a234, 0
    v_accvgpr_write_b32 a235, 0
    v_xor_b32 v240, 64, v230
    v_xor_b32 v241, 128, v230
    v_xor_b32 v242, 192, v230
    s_xor_b32 s47, s36, 0
    s_mul_i32 s47, s47, 81920
    s_mul_i32 s48, s35, 20480
    s_add_u32 s47, s47, s48
    s_add_u32 s46, s37, 0
    s_mul_i32 s46, s46, 159744
    s_add_u32 s46, s46, s47
    s_add_u32 s24, s10, s46
    s_addc_u32 s25, s11, 0
    s_sub_u32 s47, 159744, s47
    s_min_u32 s26, s47, 20480
    s_mov_b32 s27, 0x20000
    s_branch L_hop0
L_waits:
L_wait_peel:
    ds_read_b32 v249, v248
    s_waitcnt lgkmcnt(0)
    v_cmp_gt_u32 vcc, s69, v249
    s_nop 4
    s_cbranch_vccnz L_wait_peel
    s_branch L_go_peel
L_wait_tr_0_a:
    ds_read_b32 v249, v248
    s_waitcnt lgkmcnt(0)
    v_cmp_gt_u32 vcc, s69, v249
    s_nop 4
    s_cbranch_vccnz L_wait_tr_0_a
    s_branch L_go_tr_0_a
L_wait_tr_0_b:
    ds_read_b32 v249, v248
    s_waitcnt lgkmcnt(0)
    v_cmp_gt_u32 vcc, s69, v249
    s_nop 4
    s_cbranch_vccnz L_wait_tr_0_b
    s_branch L_go_tr_0_b
L_wait_tr_1_a:
    ds_read_b32 v249, v248
    s_waitcnt lgkmcnt(0)
    v_cmp_gt_u32 vcc, s69, v249
    s_nop 4
    s_cbranch_vccnz L_wait_tr_1_a
    s_branch L_go_tr_1_a
L_wait_tr_1_b:
    ds_read_b32 v249, v248
    s_waitcnt lgkmcnt(0)
    v_cmp_gt_u32 vcc, s69, v249
    s_nop 4
    s_cbranch_vccnz L_wait_tr_1_b
    s_branch L_go_tr_1_b
L_wait_fin_0_a:
    ds_read_b32 v249, v248
    s_waitcnt lgkmcnt(0)
    v_cmp_gt_u32 vcc, s69, v249
    s_nop 4
    s_cbranch_vccnz L_wait_fin_0_a
    s_branch L_go_fin_0_a
L_wait_fin_0_b:
    ds_read_b32 v249, v248
    s_waitcnt lgkmcnt(0)
    v_cmp_gt_u32 vcc, s69, v249
    s_nop 4
    s_cbranch_vccnz L_wait_fin_0_b
    s_branch L_go_fin_0_b
L_wait_fin_1_a:
    ds_read_b32 v249, v248
    s_waitcnt lgkmcnt(0)
    v_cmp_gt_u32 vcc, s69, v249
    s_nop 4
    s_cbranch_vccnz L_wait_fin_1_a
    s_branch L_go_fin_1_a
L_hop0:
    s_branch L_hop1
L_wait_fin_1_b:
    ds_read_b32 v249, v248
    s_waitcnt lgkmcnt(0)
    v_cmp_gt_u32 vcc, s69, v249
    s_nop 4
    s_cbranch_vccnz L_wait_fin_1_b
    s_branch L_go_fin_1_b
L_wait_A_0_a:
    ds_read_b32 v249, v248
    s_waitcnt lgkmcnt(0)
    v_cmp_gt_u32 vcc, s69, v249
    s_nop 4
    s_cbranch_vccnz L_wait_A_0_a
    s_branch L_go_A_0_a
L_wait_A_0_b:
    ds_read_b32 v249, v248
    s_waitcnt lgkmcnt(0)
    v_cmp_gt_u32 vcc, s69, v249
    s_nop 4
    s_cbranch_vccnz L_wait_A_0_b
    s_branch L_go_A_0_b
L_wait_A_1_a:
    ds_read_b32 v249, v248
    s_waitcnt lgkmcnt(0)
    v_cmp_gt_u32 vcc, s69, v249
    s_nop 4
    s_cbranch_vccnz L_wait_A_1_a
    s_branch L_go_A_1_a
L_wait_A_1_b:
    ds_read_b32 v249, v248
    s_waitcnt lgkmcnt(0)
    v_cmp_gt_u32 vcc, s69, v249
    s_nop 4
    s_cbranch_vccnz L_wait_A_1_b
    s_branch L_go_A_1_b
L_wait_B_0_a:
    ds_read_b32 v249, v248
    s_waitcnt lgkmcnt(0)
    v_cmp_gt_u32 vcc, s69, v249
    s_nop 4
    s_cbranch_vccnz L_wait_B_0_a
    s_branch L_go_B_0_a
L_wait_B_0_b:
    ds_read_b32 v249, v248
    s_waitcnt lgkmcnt(0)
    v_cmp_gt_u32 vcc, s69, v249
    s_nop 4
    s_cbranch_vccnz L_wait_B_0_b
    s_branch L_go_B_0_b
L_wait_B_1_a:
    ds_read_b32 v249, v248
    s_waitcnt lgkmcnt(0)
    v_cmp_gt_u32 vcc, s69, v249
    s_nop 4
    s_cbranch_vccnz L_wait_B_1_a
    s_branch L_go_B_1_a
L_wait_B_1_b:
    ds_read_b32 v249, v248
    s_waitcnt lgkmcnt(0)
    v_cmp_gt_u32 vcc, s69, v249
    s_nop 4
    s_cbranch_vccnz L_wait_B_1_b
    s_branch L_go_B_1_b
L_hop1:
    s_waitcnt vmcnt(8)
    s_cmp_lg_u32 s67, 0
    s_cbranch_scc1 L_deep3
    s_waitcnt vmcnt(0)
L_deep3:
    s_add_u32 m0, s29, 32768
    s_nop 0
    buffer_load_dwordx4 v225, s[16:19], s66 offen lds
    s_add_u32 s66, s66, 4096
    s_add_u32 m0, s29, 36864
    s_nop 0
    buffer_load_dwordx4 v225, s[16:19], s66 offen lds
    s_add_u32 s66, s66, 4096
    s_add_u32 m0, s29, 40960
    s_nop 0
    buffer_load_dwordx4 v225, s[16:19], s66 offen lds
    s_add_u32 s66, s66, 4096
    s_add_u32 m0, s29, 45056
    s_nop 0
    buffer_load_dwordx4 v225, s[16:19], s66 offen lds
    s_add_u32 s66, s66, 4096
    s_barrier
    ds_read_b128 a[80:83], v212 offset:0
    ds_read_b128 a[84:87], v213 offset:0
    ds_read_b128 a[88:91], v214 offset:0
    ds_read_b128 a[92:95], v215 offset:0
    s_waitcnt vmcnt(8)
    ds_read_b128 v[128:131], v230 offset:0
    ds_read_b128 v[132:135], v240 offset:0
    ds_read_b128 v[136:139], v241 offset:0
    ds_read_b128 v[140:143], v242 offset:0
    s_add_u32 m0, s39, 8192
    s_nop 0
    buffer_load_dwordx4 v227, s[20:23], s42 offen offset:0 nt lds
    buffer_load_dwordx4 v227, s[20:23], s42 offen offset:1024 nt lds
    buffer_load_dwordx4 v227, s[20:23], s42 offen offset:2048 nt lds
    buffer_load_dwordx4 v227, s[20:23], s42 offen offset:3072 nt lds
    ds_read_b128 a[108:111], v215 offset:4096
    ds_read_b128 a[104:107], v214 offset:4096
    ds_read_b128 a[100:103], v213 offset:4096
    ds_read_b128 a[96:99], v212 offset:4096
    ds_read_b128 a[112:115], v212 offset:8192
    ds_read_b128 a[116:119], v213 offset:8192
    ds_read_b128 a[120:123], v214 offset:8192
    ds_read_b128 a[124:127], v215 offset:8192
    ds_read_b128 a[140:143], v215 offset:12288
    ds_read_b128 a[136:139], v214 offset:12288
    ds_read_b128 a[132:135], v213 offset:12288
    ds_read_b128 a[128:131], v212 offset:12288
    s_waitcnt lgkmcnt(15)
    v_lshlrev_b32 v96, 16, v128
    v_and_b32 v97, s38, v128
    v_lshlrev_b32 v98, 16, v129
    v_and_b32 v99, s38, v129
    v_lshlrev_b32 v100, 16, v130
    v_and_b32 v101, s38, v130
    v_lshlrev_b32 v102, 16, v131
    v_and_b32 v103, s38, v131
    s_waitcnt lgkmcnt(14)
    v_lshlrev_b32 v104, 16, v132
    v_and_b32 v105, s38, v132
    v_lshlrev_b32 v106, 16, v133
    v_and_b32 v107, s38, v133
    v_lshlrev_b32 v108, 16, v134
    v_and_b32 v109, s38, v134
    v_lshlrev_b32 v110, 16, v135
    v_and_b32 v111, s38, v135
    s_waitcnt lgkmcnt(13)
    v_lshlrev_b32 v112, 16, v136
    v_and_b32 v113, s38, v136
    v_lshlrev_b32 v114, 16, v137
    v_and_b32 v115, s38, v137
    v_lshlrev_b32 v116, 16, v138
    v_and_b32 v117, s38, v138
    v_lshlrev_b32 v118, 16, v139
    v_and_b32 v119, s38, v139
    s_waitcnt lgkmcnt(12)
    v_lshlrev_b32 v120, 16, v140
    v_and_b32 v121, s38, v140
    v_lshlrev_b32 v122, 16, v141
    v_and_b32 v123, s38, v141
    v_lshlrev_b32 v124, 16, v142
    v_and_b32 v125, s38, v142
    v_lshlrev_b32 v126, 16, v143
    v_and_b32 v127, s38, v143
    v_pk_mul_f32 v[96:97], v[96:97], s[32:33]
    v_pk_mul_f32 v[98:99], v[98:99], s[32:33]
    v_pk_mul_f32 v[100:101], v[100:101], s[32:33]
    v_pk_mul_f32 v[102:103], v[102:103], s[32:33]
    v_pk_mul_f32 v[104:105], v[104:105], s[32:33]
    v_pk_mul_f32 v[106:107], v[106:107], s[32:33]
    v_pk_mul_f32 v[108:109], v[108:109], s[32:33]
    v_pk_mul_f32 v[110:111], v[110:111], s[32:33]
    v_pk_mul_f32 v[112:113], v[112:113], s[32:33]
    v_pk_mul_f32 v[114:115], v[114:115], s[32:33]
    v_pk_mul_f32 v[116:117], v[116:117], s[32:33]
    v_pk_mul_f32 v[118:119], v[118:119], s[32:33]
    v_pk_mul_f32 v[120:121], v[120:121], s[32:33]
    v_pk_mul_f32 v[122:123], v[122:123], s[32:33]
    v_pk_mul_f32 v[124:125], v[124:125], s[32:33]
    v_pk_mul_f32 v[126:127], v[126:127], s[32:33]
    v_cvt_pk_bf16_f32 v128, v96, v97
    v_cvt_pk_bf16_f32 v129, v98, v99
    v_cvt_pk_bf16_f32 v130, v100, v101
    v_cvt_pk_bf16_f32 v131, v102, v103
    v_accvgpr_write_b32 a0, v128
    v_accvgpr_write_b32 a1, v129
    v_accvgpr_write_b32 a2, v130
    v_accvgpr_write_b32 a3, v131
    v_cvt_pk_bf16_f32 v132, v104, v105
    v_cvt_pk_bf16_f32 v133, v106, v107
    v_cvt_pk_bf16_f32 v134, v108, v109
    v_cvt_pk_bf16_f32 v135, v110, v111
    v_accvgpr_write_b32 a4, v132
    v_accvgpr_write_b32 a5, v133
    v_accvgpr_write_b32 a6, v134
    v_accvgpr_write_b32 a7, v135
    v_cvt_pk_bf16_f32 v136, v112, v113
    v_cvt_pk_bf16_f32 v137, v114, v115
    v_cvt_pk_bf16_f32 v138, v116, v117
    v_cvt_pk_bf16_f32 v139, v118, v119
    v_accvgpr_write_b32 a8, v136
    v_accvgpr_write_b32 a9, v137
    v_accvgpr_write_b32 a10, v138
    v_accvgpr_write_b32 a11, v139
    v_cvt_pk_bf16_f32 v140, v120, v121
    v_cvt_pk_bf16_f32 v141, v122, v123
    v_cvt_pk_bf16_f32 v142, v124, v125
    v_cvt_pk_bf16_f32 v143, v126, v127
    v_accvgpr_write_b32 a12, v140
    v_accvgpr_write_b32 a13, v141
    v_accvgpr_write_b32 a14, v142
    v_accvgpr_write_b32 a15, v143
    s_nop 1
    v_mfma_f32_16x16x32_bf16 v[192:195], a[80:83], a[0:3], 0
    v_mfma_f32_16x16x32_bf16 v[192:195], a[84:87], a[4:7], v[192:195]
    v_mfma_f32_16x16x32_bf16 v[192:195], a[88:91], a[8:11], v[192:195]
    v_mfma_f32_16x16x32_bf16 v[192:195], a[92:95], a[12:15], v[192:195]
    s_nop 7
    v_max3_f32 v192, v192, v193, v194
    v_max_f32 v192, v192, v195
    v_mov_b32 v193, v192
    s_nop 1
    v_permlane16_swap_b32 v192, v193
    v_max_f32 v192, v192, v193
    v_mov_b32 v193, v192
    s_nop 1
    v_permlane32_swap_b32 v192, v193
    v_max_f32 v192, v192, v193
    v_sub_f32 v195, -4.0, v192
    v_sub_f32 v194, -4.0, v192
    v_sub_f32 v193, -4.0, v192
    v_sub_f32 v192, -4.0, v192
    s_nop 1
    s_waitcnt lgkmcnt(0)
    v_mfma_f32_16x16x32_bf16 v[160:163], a[80:83], a[0:3], v[192:195]
    s_waitcnt vmcnt(8)
    ds_read_b128 v[128:131], v230 offset:4096
    v_mfma_f32_16x16x32_bf16 v[160:163], a[84:87], a[4:7], v[160:163]
    s_add_u32 m0, s39, 12288
    ds_read_b128 v[132:135], v240 offset:4096
    v_mfma_f32_16x16x32_bf16 v[160:163], a[88:91], a[8:11], v[160:163]
    ds_read_b128 v[136:139], v241 offset:4096
    v_mfma_f32_16x16x32_bf16 v[160:163], a[92:95], a[12:15], v[160:163]
    ds_read_b128 v[140:143], v242 offset:4096
    s_nop 0
    v_mfma_f32_16x16x32_bf16 v[164:167], a[108:111], a[12:15], v[192:195]
    buffer_load_dwordx4 v227, s[20:23], s43 offen offset:0 nt lds
    v_mfma_f32_16x16x32_bf16 v[164:167], a[104:107], a[8:11], v[164:167]
    buffer_load_dwordx4 v227, s[20:23], s43 offen offset:1024 nt lds
    v_mfma_f32_16x16x32_bf16 v[164:167], a[100:103], a[4:7], v[164:167]
    buffer_load_dwordx4 v227, s[20:23], s43 offen offset:2048 nt lds
    v_mfma_f32_16x16x32_bf16 v[164:167], a[96:99], a[0:3], v[164:167]
    buffer_load_dwordx4 v227, s[20:23], s43 offen offset:3072 nt lds
    v_mfma_f32_16x16x32_bf16 v[168:171], a[112:115], a[0:3], v[192:195]
    s_waitcnt lgkmcnt(3)
    v_exp_f32 v160, v160
    v_lshlrev_b32 v96, 16, v128
    v_and_b32 v97, s38, v128
    v_lshlrev_b32 v98, 16, v129
    v_mfma_f32_16x16x32_bf16 v[168:171], a[116:119], a[4:7], v[168:171]
    v_and_b32 v99, s38, v129
    v_lshlrev_b32 v100, 16, v130
    v_and_b32 v101, s38, v130
    v_lshlrev_b32 v102, 16, v131
    v_and_b32 v103, s38, v131
    v_mfma_f32_16x16x32_bf16 v[168:171], a[120:123], a[8:11], v[168:171]
    s_waitcnt lgkmcnt(2)
    v_exp_f32 v161, v161
    v_lshlrev_b32 v104, 16, v132
    v_and_b32 v105, s38, v132
    v_lshlrev_b32 v106, 16, v133
    v_and_b32 v107, s38, v133
    v_mfma_f32_16x16x32_bf16 v[168:171], a[124:127], a[12:15], v[168:171]
    v_cvt_pk_bf16_f32 v176, v160, v161
    v_lshlrev_b32 v108, 16, v134
    v_and_b32 v109, s38, v134
    v_lshlrev_b32 v110, 16, v135
    v_and_b32 v111, s38, v135
    v_mfma_f32_16x16x32_bf16 v[172:175], a[140:143], a[12:15], v[192:195]
    s_waitcnt lgkmcnt(1)
    v_exp_f32 v162, v162
    v_lshlrev_b32 v112, 16, v136
    v_and_b32 v113, s38, v136
    v_lshlrev_b32 v114, 16, v137
    v_mfma_f32_16x16x32_bf16 v[172:175], a[136:139], a[8:11], v[172:175]
    v_and_b32 v115, s38, v137
    v_lshlrev_b32 v116, 16, v138
    v_and_b32 v117, s38, v138
    v_lshlrev_b32 v118, 16, v139
    v_and_b32 v119, s38, v139
    v_mfma_f32_16x16x32_bf16 v[172:175], a[132:135], a[4:7], v[172:175]
    s_waitcnt lgkmcnt(0)
    v_exp_f32 v163, v163
    v_lshlrev_b32 v120, 16, v140
    v_and_b32 v121, s38, v140
    v_lshlrev_b32 v122, 16, v141
    v_and_b32 v123, s38, v141
    v_mfma_f32_16x16x32_bf16 v[172:175], a[128:131], a[0:3], v[172:175]
    v_cvt_pk_bf16_f32 v177, v162, v163
    v_lshlrev_b32 v124, 16, v142
    v_and_b32 v125, s38, v142
    v_lshlrev_b32 v126, 16, v143
    v_and_b32 v127, s38, v143
    v_pk_mul_f32 v[96:97], v[96:97], s[32:33]
    v_pk_mul_f32 v[98:99], v[98:99], s[32:33]
    v_pk_mul_f32 v[100:101], v[100:101], s[32:33]
    v_pk_mul_f32 v[102:103], v[102:103], s[32:33]
    v_pk_mul_f32 v[104:105], v[104:105], s[32:33]
    v_pk_mul_f32 v[106:107], v[106:107], s[32:33]
    v_pk_mul_f32 v[108:109], v[108:109], s[32:33]
    v_pk_mul_f32 v[110:111], v[110:111], s[32:33]
    v_pk_mul_f32 v[112:113], v[112:113], s[32:33]
    v_pk_mul_f32 v[114:115], v[114:115], s[32:33]
    v_pk_mul_f32 v[116:117], v[116:117], s[32:33]
    v_pk_mul_f32 v[118:119], v[118:119], s[32:33]
    v_pk_mul_f32 v[120:121], v[120:121], s[32:33]
    v_pk_mul_f32 v[122:123], v[122:123], s[32:33]
    v_pk_mul_f32 v[124:125], v[124:125], s[32:33]
    v_pk_mul_f32 v[126:127], v[126:127], s[32:33]
    v_cvt_pk_bf16_f32 v128, v96, v97
    v_cvt_pk_bf16_f32 v129, v98, v99
    v_cvt_pk_bf16_f32 v130, v100, v101
    v_cvt_pk_bf16_f32 v131, v102, v103
    v_accvgpr_write_b32 a16, v128
    v_accvgpr_write_b32 a17, v129
    v_accvgpr_write_b32 a18, v130
    v_accvgpr_write_b32 a19, v131
    v_cvt_pk_bf16_f32 v132, v104, v105
    v_cvt_pk_bf16_f32 v133, v106, v107
    v_cvt_pk_bf16_f32 v134, v108, v109
    v_cvt_pk_bf16_f32 v135, v110, v111
    v_accvgpr_write_b32 a20, v132
    v_accvgpr_write_b32 a21, v133
    v_accvgpr_write_b32 a22, v134
    v_accvgpr_write_b32 a23, v135
    v_cvt_pk_bf16_f32 v136, v112, v113
    v_cvt_pk_bf16_f32 v137, v114, v115
    v_cvt_pk_bf16_f32 v138, v116, v117
    v_cvt_pk_bf16_f32 v139, v118, v119
    v_accvgpr_write_b32 a24, v136
    v_accvgpr_write_b32 a25, v137
    v_accvgpr_write_b32 a26, v138
    v_accvgpr_write_b32 a27, v139
    v_cvt_pk_bf16_f32 v140, v120, v121
    v_cvt_pk_bf16_f32 v141, v122, v123
    v_cvt_pk_bf16_f32 v142, v124, v125
    v_cvt_pk_bf16_f32 v143, v126, v127
    v_accvgpr_write_b32 a28, v140
    v_accvgpr_write_b32 a29, v141
    v_accvgpr_write_b32 a30, v142
    v_accvgpr_write_b32 a31, v143
    s_nop 1
    v_mfma_f32_16x16x32_bf16 v[196:199], a[80:83], a[16:19], 0
    v_mfma_f32_16x16x32_bf16 v[196:199], a[84:87], a[20:23], v[196:199]
    v_mfma_f32_16x16x32_bf16 v[196:199], a[88:91], a[24:27], v[196:199]
    v_mfma_f32_16x16x32_bf16 v[196:199], a[92:95], a[28:31], v[196:199]
    v_exp_f32 v164, v164
    v_exp_f32 v165, v165
    v_exp_f32 v166, v166
    v_exp_f32 v167, v167
    v_cvt_pk_bf16_f32 v178, v164, v165
    v_cvt_pk_bf16_f32 v179, v166, v167
    v_exp_f32 v168, v168
    v_exp_f32 v169, v169
    v_exp_f32 v170, v170
    v_exp_f32 v171, v171
    v_cvt_pk_bf16_f32 v180, v168, v169
    v_cvt_pk_bf16_f32 v181, v170, v171
    v_max3_f32 v196, v196, v197, v198
    v_max_f32 v196, v196, v199
    v_mov_b32 v197, v196
    s_nop 1
    v_permlane16_swap_b32 v196, v197
    v_max_f32 v196, v196, v197
    v_mov_b32 v197, v196
    s_nop 1
    v_permlane32_swap_b32 v196, v197
    v_max_f32 v196, v196, v197
    v_sub_f32 v199, -4.0, v196
    v_sub_f32 v198, -4.0, v196
    v_sub_f32 v197, -4.0, v196
    v_sub_f32 v196, -4.0, v196
    s_nop 1
    s_mov_b64 exec, 0
    s_cmp_eq_u32 s35, 0
    s_cbranch_scc1 L_page0
    s_cmp_eq_u32 s35, 1
    s_cbranch_scc1 L_page1
    s_cmp_eq_u32 s35, 2
    s_cbranch_scc1 L_page2
    s_branch L_page3
L_early_end:
.p2align 12
    s_endpgm
    s_endpgm
    s_endpgm
    s_endpgm
    s_endpgm
    s_endpgm
    s_endpgm
    s_endpgm
    s_endpgm
    s_endpgm
    s_endpgm
    s_endpgm
    s_endpgm
    s_endpgm
    s_endpgm
    s_endpgm
    s_endpgm
    s_endpgm
    s_endpgm
    s_endpgm
    s_endpgm
    s_endpgm
    s_endpgm
    s_endpgm
    s_endpgm
    s_endpgm
    s_endpgm
    s_endpgm
    s_endpgm
    s_endpgm
    s_endpgm
    s_endpgm
    s_endpgm
    s_endpgm
    s_endpgm
    s_endpgm
    s_endpgm
    s_endpgm
    s_endpgm
    s_endpgm
    s_endpgm
    s_endpgm
    s_endpgm
    s_endpgm
    s_endpgm
    s_endpgm
    s_endpgm
    s_endpgm
    s_endpgm
    s_endpgm
    s_endpgm
    s_endpgm
    s_endpgm
    s_endpgm
    s_endpgm
    s_endpgm
    s_endpgm
    s_endpgm
    s_endpgm
    s_endpgm
    s_endpgm
    s_endpgm
    s_endpgm
    s_endpgm
    s_endpgm
    s_endpgm
    s_endpgm
    s_endpgm
    s_endpgm
    s_endpgm
    s_endpgm
    s_endpgm
    s_endpgm
    s_endpgm
    s_endpgm
    s_endpgm
    s_endpgm
    s_endpgm
    s_endpgm
    s_endpgm
    s_endpgm
    s_endpgm
    s_endpgm
    s_endpgm
    s_endpgm
    s_endpgm
    s_endpgm
    s_endpgm
    s_endpgm
    s_endpgm
    s_endpgm
    s_endpgm
    s_endpgm
    s_endpgm
    s_endpgm
L_warm:
    s_mov_b64 exec, -1
    s_waitcnt vmcnt(8)
    s_add_u32 m0, s39, 16384
    s_nop 0
    buffer_load_dwordx4 v227, s[20:23], s44 offen offset:0 nt lds
    buffer_load_dwordx4 v227, s[20:23], s44 offen offset:1024 nt lds
    buffer_load_dwordx4 v227, s[20:23], s44 offen offset:2048 nt lds
    buffer_load_dwordx4 v227, s[20:23], s44 offen offset:3072 nt lds
    s_barrier
    ds_read_b64_tr_b16 a[144:145], v216 offset:32768
    ds_read_b64_tr_b16 a[146:147], v216 offset:36864
    ds_read_b64_tr_b16 a[176:177], v216 offset:40960
    ds_read_b64_tr_b16 a[178:179], v216 offset:45056
    ds_read_b64_tr_b16 a[148:149], v217 offset:32768
    ds_read_b64_tr_b16 a[150:151], v217 offset:36864
    ds_read_b64_tr_b16 a[180:181], v217 offset:40960
    ds_read_b64_tr_b16 a[182:183], v217 offset:45056
    ds_read_b64_tr_b16 a[152:153], v218 offset:32768
    ds_read_b64_tr_b16 a[154:155], v218 offset:36864
    ds_read_b64_tr_b16 a[184:185], v218 offset:40960
    ds_read_b64_tr_b16 a[186:187], v218 offset:45056
    ds_read_b64_tr_b16 a[156:157], v219 offset:32768
    ds_read_b64_tr_b16 a[158:159], v219 offset:36864
    ds_read_b64_tr_b16 a[188:189], v219 offset:40960
    ds_read_b64_tr_b16 a[190:191], v219 offset:45056
    v_mfma_f32_16x16x32_bf16 v[160:163], a[80:83], a[16:19], v[196:199]
    s_waitcnt vmcnt(8)
    ds_read_b128 v[128:131], v230 offset:8192
    v_exp_f32 v172, v172
    v_mfma_f32_16x16x32_bf16 v[160:163], a[84:87], a[20:23], v[160:163]
    ds_read_b128 v[132:135], v240 offset:8192
    v_mfma_f32_16x16x32_bf16 v[160:163], a[88:91], a[24:27], v[160:163]
    s_add_u32 m0, s29, 16384
    ds_read_b128 v[136:139], v241 offset:8192
    v_exp_f32 v173, v173
    v_mfma_f32_16x16x32_bf16 v[160:163], a[92:95], a[28:31], v[160:163]
    ds_read_b128 v[140:143], v242 offset:8192
    v_cvt_pk_bf16_f32 v182, v172, v173
    v_mfma_f32_16x16x32_bf16 v[164:167], a[108:111], a[28:31], v[196:199]
    ds_read_b64_tr_b16 a[160:161], v220 offset:32768
    ds_read_b64_tr_b16 a[162:163], v220 offset:36864
    ds_read_b64_tr_b16 a[192:193], v220 offset:40960
    v_exp_f32 v174, v174
    v_mfma_f32_16x16x32_bf16 v[164:167], a[104:107], a[24:27], v[164:167]
    buffer_load_dwordx4 v224, s[12:15], s28 offen lds
    ds_read_b64_tr_b16 a[194:195], v220 offset:45056
    ds_read_b64_tr_b16 a[164:165], v221 offset:32768
    ds_read_b64_tr_b16 a[166:167], v221 offset:36864
    v_mfma_f32_16x16x32_bf16 v[164:167], a[100:103], a[20:23], v[164:167]
    s_add_u32 s28, s28, 4096
    ds_read_b64_tr_b16 a[196:197], v221 offset:40960
    ds_read_b64_tr_b16 a[198:199], v221 offset:45056
    ds_read_b64_tr_b16 a[168:169], v222 offset:32768
    v_exp_f32 v175, v175
    v_mfma_f32_16x16x32_bf16 v[164:167], a[96:99], a[16:19], v[164:167]
    s_add_u32 m0, s29, 20480
    ds_read_b64_tr_b16 a[170:171], v222 offset:36864
    ds_read_b64_tr_b16 a[200:201], v222 offset:40960
    ds_read_b64_tr_b16 a[202:203], v222 offset:45056
    ds_read_b64_tr_b16 a[172:173], v223 offset:32768
    v_cvt_pk_bf16_f32 v183, v174, v175
    v_mfma_f32_16x16x32_bf16 v[168:171], a[112:115], a[16:19], v[196:199]
    ds_read_b64_tr_b16 a[174:175], v223 offset:36864
    ds_read_b64_tr_b16 a[204:205], v223 offset:40960
    ds_read_b64_tr_b16 a[206:207], v223 offset:45056
    v_exp_f32 v160, v160
    v_mfma_f32_16x16x32_bf16 v[168:171], a[116:119], a[20:23], v[168:171]
    s_waitcnt lgkmcnt(15)
    buffer_load_dwordx4 v224, s[12:15], s28 offen lds
    v_lshlrev_b32 v96, 16, v128
    v_and_b32 v97, s38, v128
    v_lshlrev_b32 v98, 16, v129
    v_mfma_f32_16x16x32_bf16 v[168:171], a[120:123], a[24:27], v[168:171]
    s_add_u32 s28, s28, 4096
    v_exp_f32 v161, v161
    v_and_b32 v99, s38, v129
    v_lshlrev_b32 v100, 16, v130
    v_mfma_f32_16x16x32_bf16 v[168:171], a[124:127], a[28:31], v[168:171]
    s_add_u32 m0, s29, 24576
    v_cvt_pk_bf16_f32 v184, v160, v161
    v_and_b32 v101, s38, v130
    v_lshlrev_b32 v102, 16, v131
    v_and_b32 v103, s38, v131
    v_mfma_f32_16x16x32_bf16 v[172:175], a[140:143], a[28:31], v[196:199]
    s_waitcnt lgkmcnt(15)
    v_exp_f32 v162, v162
    v_lshlrev_b32 v104, 16, v132
    v_and_b32 v105, s38, v132
    v_lshlrev_b32 v106, 16, v133
    v_mfma_f32_16x16x32_bf16 v[172:175], a[136:139], a[24:27], v[172:175]
    buffer_load_dwordx4 v224, s[12:15], s28 offen lds
    v_and_b32 v107, s38, v133
    v_lshlrev_b32 v108, 16, v134
    v_and_b32 v109, s38, v134
    v_mfma_f32_16x16x32_bf16 v[172:175], a[132:135], a[20:23], v[172:175]
    s_add_u32 s28, s28, 4096
    v_exp_f32 v163, v163
    v_lshlrev_b32 v110, 16, v135
    v_and_b32 v111, s38, v135
    v_mfma_f32_16x16x32_bf16 v[172:175], a[128:131], a[16:19], v[172:175]
    s_waitcnt lgkmcnt(15)
    v_cvt_pk_bf16_f32 v185, v162, v163
    v_lshlrev_b32 v112, 16, v136
    v_and_b32 v113, s38, v136
    v_lshlrev_b32 v114, 16, v137
    v_and_b32 v115, s38, v137
    v_smfmac_f32_16x16x64_bf16 a[228:231], a[208:211], v[176:183], v226
    s_waitcnt lgkmcnt(0)
    v_lshlrev_b32 v116, 16, v138
    v_and_b32 v117, s38, v138
    v_lshlrev_b32 v118, 16, v139
    v_and_b32 v119, s38, v139
    v_mfma_f32_16x16x32_bf16 v[0:3], v[176:179], a[144:147], 0
    s_waitcnt lgkmcnt(15)
    v_exp_f32 v164, v164
    v_lshlrev_b32 v120, 16, v140
    v_and_b32 v121, s38, v140
    v_lshlrev_b32 v122, 16, v141
    v_and_b32 v123, s38, v141
    v_lshlrev_b32 v124, 16, v142
    v_and_b32 v125, s38, v142
    v_lshlrev_b32 v126, 16, v143
    v_and_b32 v127, s38, v143
    v_pk_mul_f32 v[96:97], v[96:97], s[32:33]
    v_pk_mul_f32 v[98:99], v[98:99], s[32:33]
    v_pk_mul_f32 v[100:101], v[100:101], s[32:33]
    v_pk_mul_f32 v[102:103], v[102:103], s[32:33]
    v_pk_mul_f32 v[104:105], v[104:105], s[32:33]
    v_pk_mul_f32 v[106:107], v[106:107], s[32:33]
    v_pk_mul_f32 v[108:109], v[108:109], s[32:33]
    v_pk_mul_f32 v[110:111], v[110:111], s[32:33]
    v_pk_mul_f32 v[112:113], v[112:113], s[32:33]
    v_pk_mul_f32 v[114:115], v[114:115], s[32:33]
    v_pk_mul_f32 v[116:117], v[116:117], s[32:33]
    v_pk_mul_f32 v[118:119], v[118:119], s[32:33]
    v_pk_mul_f32 v[120:121], v[120:121], s[32:33]
    v_pk_mul_f32 v[122:123], v[122:123], s[32:33]
    v_pk_mul_f32 v[124:125], v[124:125], s[32:33]
    v_pk_mul_f32 v[126:127], v[126:127], s[32:33]
    v_mfma_f32_16x16x32_bf16 v[0:3], v[180:183], a[176:179], v[0:3]
    v_cvt_pk_bf16_f32 v128, v96, v97
    v_cvt_pk_bf16_f32 v129, v98, v99
    v_cvt_pk_bf16_f32 v130, v100, v101
    v_cvt_pk_bf16_f32 v131, v102, v103
    v_accvgpr_write_b32 a32, v128
    v_accvgpr_write_b32 a33, v129
    v_accvgpr_write_b32 a34, v130
    v_mfma_f32_16x16x32_bf16 v[4:7], v[176:179], a[148:151], 0
    v_exp_f32 v165, v165
    v_accvgpr_write_b32 a35, v131
    v_cvt_pk_bf16_f32 v132, v104, v105
    v_cvt_pk_bf16_f32 v133, v106, v107
    v_cvt_pk_bf16_f32 v134, v108, v109
    v_cvt_pk_bf16_f32 v135, v110, v111
    v_mfma_f32_16x16x32_bf16 v[4:7], v[180:183], a[180:183], v[4:7]
    v_cvt_pk_bf16_f32 v186, v164, v165
    v_accvgpr_write_b32 a36, v132
    v_accvgpr_write_b32 a37, v133
    v_accvgpr_write_b32 a38, v134
    v_accvgpr_write_b32 a39, v135
    v_cvt_pk_bf16_f32 v136, v112, v113
    v_cvt_pk_bf16_f32 v137, v114, v115
    v_mfma_f32_16x16x32_bf16 v[8:11], v[176:179], a[152:155], 0
    v_exp_f32 v166, v166
    v_cvt_pk_bf16_f32 v138, v116, v117
    v_cvt_pk_bf16_f32 v139, v118, v119
    v_accvgpr_write_b32 a40, v136
    v_accvgpr_write_b32 a41, v137
    v_mfma_f32_16x16x32_bf16 v[8:11], v[180:183], a[184:187], v[8:11]
    v_accvgpr_write_b32 a42, v138
    v_accvgpr_write_b32 a43, v139
    v_cvt_pk_bf16_f32 v140, v120, v121
    v_cvt_pk_bf16_f32 v141, v122, v123
    v_cvt_pk_bf16_f32 v142, v124, v125
    v_cvt_pk_bf16_f32 v143, v126, v127
    v_mfma_f32_16x16x32_bf16 v[12:15], v[176:179], a[156:159], 0
    s_add_u32 m0, s29, 28672
    v_exp_f32 v167, v167
    v_accvgpr_write_b32 a44, v140
    v_accvgpr_write_b32 a45, v141
    v_accvgpr_write_b32 a46, v142
    v_accvgpr_write_b32 a47, v143
    v_mfma_f32_16x16x32_bf16 v[12:15], v[180:183], a[188:191], v[12:15]
    v_cvt_pk_bf16_f32 v187, v166, v167
    v_mfma_f32_16x16x32_bf16 v[200:203], a[80:83], a[32:35], 0
    v_mfma_f32_16x16x32_bf16 v[200:203], a[84:87], a[36:39], v[200:203]
    v_mfma_f32_16x16x32_bf16 v[200:203], a[88:91], a[40:43], v[200:203]
    v_mfma_f32_16x16x32_bf16 v[200:203], a[92:95], a[44:47], v[200:203]
    v_mfma_f32_16x16x32_bf16 v[16:19], v[176:179], a[160:163], 0
    v_exp_f32 v168, v168
    v_mfma_f32_16x16x32_bf16 v[16:19], v[180:183], a[192:195], v[16:19]
    buffer_load_dwordx4 v224, s[12:15], s28 offen lds
    v_mfma_f32_16x16x32_bf16 v[20:23], v[176:179], a[164:167], 0
    s_add_u32 s28, s28, 4096
    v_exp_f32 v169, v169
    v_mfma_f32_16x16x32_bf16 v[20:23], v[180:183], a[196:199], v[20:23]
    v_cvt_pk_bf16_f32 v188, v168, v169
    v_mfma_f32_16x16x32_bf16 v[24:27], v[176:179], a[168:171], 0
    v_exp_f32 v170, v170
    v_max3_f32 v200, v200, v201, v202
    v_mfma_f32_16x16x32_bf16 v[24:27], v[180:183], a[200:203], v[24:27]
    v_max_f32 v200, v200, v203
    v_mov_b32 v201, v200
    v_mfma_f32_16x16x32_bf16 v[28:31], v[176:179], a[172:175], 0
    v_exp_f32 v171, v171
    v_mfma_f32_16x16x32_bf16 v[28:31], v[180:183], a[204:207], v[28:31]
    v_cvt_pk_bf16_f32 v189, v170, v171
    v_permlane16_swap_b32 v200, v201
    v_max_f32 v200, v200, v201
    v_mov_b32 v201, v200
    s_nop 1
    v_permlane32_swap_b32 v200, v201
    v_max_f32 v200, v200, v201
    v_sub_f32 v203, -4.0, v200
    v_sub_f32 v202, -4.0, v200
    v_sub_f32 v201, -4.0, v200
    v_sub_f32 v200, -4.0, v200
    s_nop 1
    v_mfma_f32_16x16x32_bf16 v[160:163], a[80:83], a[32:35], v[200:203]
    s_waitcnt vmcnt(8)
    ds_read_b128 v[128:131], v230 offset:12288
    v_exp_f32 v172, v172
    v_mfma_f32_16x16x32_bf16 v[160:163], a[84:87], a[36:39], v[160:163]
    s_xor_b32 s47, s36, 1
    s_mul_i32 s47, s47, 81920
    ds_read_b128 v[132:135], v240 offset:12288
    v_mfma_f32_16x16x32_bf16 v[160:163], a[88:91], a[40:43], v[160:163]
    s_add_u32 m0, s29, 49152
    ds_read_b128 v[136:139], v241 offset:12288
    v_exp_f32 v173, v173
    v_mfma_f32_16x16x32_bf16 v[160:163], a[92:95], a[44:47], v[160:163]
    s_mul_i32 s48, s35, 20480
    ds_read_b128 v[140:143], v242 offset:12288
    v_cvt_pk_bf16_f32 v190, v172, v173
    v_mfma_f32_16x16x32_bf16 v[164:167], a[108:111], a[44:47], v[200:203]
    s_add_u32 s47, s47, s48
    v_exp_f32 v174, v174
    v_mfma_f32_16x16x32_bf16 v[164:167], a[104:107], a[40:43], v[164:167]
    s_add_u32 s46, s37, 1
    buffer_load_dwordx4 v225, s[16:19], s66 offen lds
    v_mfma_f32_16x16x32_bf16 v[164:167], a[100:103], a[36:39], v[164:167]
    s_add_u32 s66, s66, 4096
    v_exp_f32 v175, v175
    v_mfma_f32_16x16x32_bf16 v[164:167], a[96:99], a[32:35], v[164:167]
    s_add_u32 m0, s29, 53248
    s_mul_i32 s46, s46, 159744
    v_cvt_pk_bf16_f32 v191, v174, v175
    v_mfma_f32_16x16x32_bf16 v[168:171], a[112:115], a[32:35], v[200:203]
    s_add_u32 s46, s46, s47
    v_exp_f32 v160, v160
    v_mfma_f32_16x16x32_bf16 v[168:171], a[116:119], a[36:39], v[168:171]
    s_waitcnt lgkmcnt(3)
    buffer_load_dwordx4 v225, s[16:19], s66 offen lds
    v_lshlrev_b32 v96, 16, v128
    v_and_b32 v97, s38, v128
    v_lshlrev_b32 v98, 16, v129
    v_mfma_f32_16x16x32_bf16 v[168:171], a[120:123], a[40:43], v[168:171]
    s_add_u32 s66, s66, 4096
    v_exp_f32 v161, v161
    v_and_b32 v99, s38, v129
    v_lshlrev_b32 v100, 16, v130
    v_mfma_f32_16x16x32_bf16 v[168:171], a[124:127], a[44:47], v[168:171]
    s_add_u32 m0, s29, 57344
    v_cvt_pk_bf16_f32 v176, v160, v161
    v_and_b32 v101, s38, v130
    v_lshlrev_b32 v102, 16, v131
    v_and_b32 v103, s38, v131
    v_mfma_f32_16x16x32_bf16 v[172:175], a[140:143], a[44:47], v[200:203]
    s_waitcnt lgkmcnt(2)
    v_exp_f32 v162, v162
    v_lshlrev_b32 v104, 16, v132
    v_and_b32 v105, s38, v132
    v_lshlrev_b32 v106, 16, v133
    v_mfma_f32_16x16x32_bf16 v[172:175], a[136:139], a[40:43], v[172:175]
    buffer_load_dwordx4 v225, s[16:19], s66 offen lds
    v_and_b32 v107, s38, v133
    v_lshlrev_b32 v108, 16, v134
    v_and_b32 v109, s38, v134
    v_mfma_f32_16x16x32_bf16 v[172:175], a[132:135], a[36:39], v[172:175]
    s_add_u32 s66, s66, 4096
    v_exp_f32 v163, v163
    v_lshlrev_b32 v110, 16, v135
    v_and_b32 v111, s38, v135
    v_mfma_f32_16x16x32_bf16 v[172:175], a[128:131], a[32:35], v[172:175]
    s_waitcnt lgkmcnt(1)
    v_cvt_pk_bf16_f32 v177, v162, v163
    v_lshlrev_b32 v112, 16, v136
    v_and_b32 v113, s38, v136
    v_lshlrev_b32 v114, 16, v137
    v_and_b32 v115, s38, v137
    v_smfmac_f32_16x16x64_bf16 a[228:231], a[212:215], v[184:191], v226
    v_lshlrev_b32 v116, 16, v138
    v_and_b32 v117, s38, v138
    v_lshlrev_b32 v118, 16, v139
    v_and_b32 v119, s38, v139
    v_mfma_f32_16x16x32_bf16 v[32:35], v[184:187], a[144:147], 0
    s_waitcnt lgkmcnt(0)
    v_exp_f32 v164, v164
    v_lshlrev_b32 v120, 16, v140
    v_and_b32 v121, s38, v140
    v_lshlrev_b32 v122, 16, v141
    v_and_b32 v123, s38, v141
    v_lshlrev_b32 v124, 16, v142
    v_and_b32 v125, s38, v142
    v_lshlrev_b32 v126, 16, v143
    v_and_b32 v127, s38, v143
    v_pk_mul_f32 v[96:97], v[96:97], s[32:33]
    v_pk_mul_f32 v[98:99], v[98:99], s[32:33]
    v_pk_mul_f32 v[100:101], v[100:101], s[32:33]
    v_pk_mul_f32 v[102:103], v[102:103], s[32:33]
    v_pk_mul_f32 v[104:105], v[104:105], s[32:33]
    v_pk_mul_f32 v[106:107], v[106:107], s[32:33]
    v_pk_mul_f32 v[108:109], v[108:109], s[32:33]
    v_pk_mul_f32 v[110:111], v[110:111], s[32:33]
    v_pk_mul_f32 v[112:113], v[112:113], s[32:33]
    v_pk_mul_f32 v[114:115], v[114:115], s[32:33]
    v_pk_mul_f32 v[116:117], v[116:117], s[32:33]
    v_pk_mul_f32 v[118:119], v[118:119], s[32:33]
    v_pk_mul_f32 v[120:121], v[120:121], s[32:33]
    v_pk_mul_f32 v[122:123], v[122:123], s[32:33]
    v_pk_mul_f32 v[124:125], v[124:125], s[32:33]
    v_pk_mul_f32 v[126:127], v[126:127], s[32:33]
    v_mfma_f32_16x16x32_bf16 v[32:35], v[188:191], a[176:179], v[32:35]
    v_cvt_pk_bf16_f32 v128, v96, v97
    v_cvt_pk_bf16_f32 v129, v98, v99
    v_cvt_pk_bf16_f32 v130, v100, v101
    v_cvt_pk_bf16_f32 v131, v102, v103
    v_accvgpr_write_b32 a48, v128
    v_accvgpr_write_b32 a49, v129
    v_accvgpr_write_b32 a50, v130
    v_mfma_f32_16x16x32_bf16 v[36:39], v[184:187], a[148:151], 0
    v_exp_f32 v165, v165
    v_accvgpr_write_b32 a51, v131
    v_cvt_pk_bf16_f32 v132, v104, v105
    v_cvt_pk_bf16_f32 v133, v106, v107
    v_cvt_pk_bf16_f32 v134, v108, v109
    v_cvt_pk_bf16_f32 v135, v110, v111
    v_mfma_f32_16x16x32_bf16 v[36:39], v[188:191], a[180:183], v[36:39]
    v_cvt_pk_bf16_f32 v178, v164, v165
    v_accvgpr_write_b32 a52, v132
    v_accvgpr_write_b32 a53, v133
    v_accvgpr_write_b32 a54, v134
    v_accvgpr_write_b32 a55, v135
    v_cvt_pk_bf16_f32 v136, v112, v113
    v_cvt_pk_bf16_f32 v137, v114, v115
    v_mfma_f32_16x16x32_bf16 v[40:43], v[184:187], a[152:155], 0
    v_exp_f32 v166, v166
    v_cvt_pk_bf16_f32 v138, v116, v117
    v_cvt_pk_bf16_f32 v139, v118, v119
    v_accvgpr_write_b32 a56, v136
    v_accvgpr_write_b32 a57, v137
    v_mfma_f32_16x16x32_bf16 v[40:43], v[188:191], a[184:187], v[40:43]
    v_accvgpr_write_b32 a58, v138
    v_accvgpr_write_b32 a59, v139
    v_cvt_pk_bf16_f32 v140, v120, v121
    v_cvt_pk_bf16_f32 v141, v122, v123
    v_cvt_pk_bf16_f32 v142, v124, v125
    v_cvt_pk_bf16_f32 v143, v126, v127
    v_mfma_f32_16x16x32_bf16 v[44:47], v[184:187], a[156:159], 0
    s_add_u32 m0, s29, 61440
    v_exp_f32 v167, v167
    v_accvgpr_write_b32 a60, v140
    v_accvgpr_write_b32 a61, v141
    v_accvgpr_write_b32 a62, v142
    v_accvgpr_write_b32 a63, v143
    v_mfma_f32_16x16x32_bf16 v[44:47], v[188:191], a[188:191], v[44:47]
    s_add_u32 s20, s4, s46
    s_addc_u32 s21, s5, 0
    v_cvt_pk_bf16_f32 v179, v166, v167
    v_mfma_f32_16x16x32_bf16 v[204:207], a[80:83], a[48:51], 0
    s_sub_u32 s47, 159744, s47
    s_min_u32 s22, s47, 20480
    s_mov_b32 s23, 0x20000
    v_mfma_f32_16x16x32_bf16 v[204:207], a[84:87], a[52:55], v[204:207]
    v_mfma_f32_16x16x32_bf16 v[204:207], a[88:91], a[56:59], v[204:207]
    v_mfma_f32_16x16x32_bf16 v[204:207], a[92:95], a[60:63], v[204:207]
    v_mfma_f32_16x16x32_bf16 v[48:51], v[184:187], a[160:163], 0
    v_exp_f32 v168, v168
    v_mfma_f32_16x16x32_bf16 v[48:51], v[188:191], a[192:195], v[48:51]
    buffer_load_dwordx4 v225, s[16:19], s66 offen lds
    v_mfma_f32_16x16x32_bf16 v[52:55], v[184:187], a[164:167], 0
    s_add_u32 s66, s66, 4096
    v_exp_f32 v169, v169
    v_mfma_f32_16x16x32_bf16 v[52:55], v[188:191], a[196:199], v[52:55]
    v_cvt_pk_bf16_f32 v180, v168, v169
    v_mfma_f32_16x16x32_bf16 v[56:59], v[184:187], a[168:171], 0
    v_exp_f32 v170, v170
    v_max3_f32 v204, v204, v205, v206
    v_mfma_f32_16x16x32_bf16 v[56:59], v[188:191], a[200:203], v[56:59]
    v_max_f32 v204, v204, v207
    v_mov_b32 v205, v204
    v_mfma_f32_16x16x32_bf16 v[60:63], v[184:187], a[172:175], 0
    v_exp_f32 v171, v171
    v_mfma_f32_16x16x32_bf16 v[60:63], v[188:191], a[204:207], v[60:63]
    v_cvt_pk_bf16_f32 v181, v170, v171
    v_permlane16_swap_b32 v204, v205
    v_max_f32 v204, v204, v205
    v_mov_b32 v205, v204
    s_nop 1
    v_permlane32_swap_b32 v204, v205
    v_max_f32 v204, v204, v205
    v_sub_f32 v207, -4.0, v204
    v_sub_f32 v206, -4.0, v204
    v_sub_f32 v205, -4.0, v204
    v_sub_f32 v204, -4.0, v204
    s_nop 1
    v_mfma_f32_16x16x32_bf16 v[160:163], a[80:83], a[48:51], v[204:207]
    s_waitcnt vmcnt(8)
    ds_read_b128 v[128:131], v230 offset:16384
    v_exp_f32 v172, v172
    v_mfma_f32_16x16x32_bf16 v[160:163], a[84:87], a[52:55], v[160:163]
    ds_read_b128 v[132:135], v240 offset:16384
    v_mfma_f32_16x16x32_bf16 v[160:163], a[88:91], a[56:59], v[160:163]
    s_add_u32 m0, s29, 0
    ds_read_b128 v[136:139], v241 offset:16384
    v_exp_f32 v173, v173
    v_mfma_f32_16x16x32_bf16 v[160:163], a[92:95], a[60:63], v[160:163]
    ds_read_b128 v[140:143], v242 offset:16384
    v_cvt_pk_bf16_f32 v182, v172, v173
    v_mfma_f32_16x16x32_bf16 v[164:167], a[108:111], a[60:63], v[204:207]
    v_exp_f32 v174, v174
    v_mfma_f32_16x16x32_bf16 v[164:167], a[104:107], a[56:59], v[164:167]
    buffer_load_dwordx4 v224, s[12:15], s28 offen lds
    v_mfma_f32_16x16x32_bf16 v[164:167], a[100:103], a[52:55], v[164:167]
    s_add_u32 s28, s28, 4096
    v_exp_f32 v175, v175
    v_mfma_f32_16x16x32_bf16 v[164:167], a[96:99], a[48:51], v[164:167]
    s_add_u32 m0, s29, 4096
    v_cvt_pk_bf16_f32 v183, v174, v175
    v_mfma_f32_16x16x32_bf16 v[168:171], a[112:115], a[48:51], v[204:207]
    v_exp_f32 v160, v160
    v_mfma_f32_16x16x32_bf16 v[168:171], a[116:119], a[52:55], v[168:171]
    s_waitcnt lgkmcnt(3)
    buffer_load_dwordx4 v224, s[12:15], s28 offen lds
    v_lshlrev_b32 v96, 16, v128
    v_and_b32 v97, s38, v128
    v_lshlrev_b32 v98, 16, v129
    v_mfma_f32_16x16x32_bf16 v[168:171], a[120:123], a[56:59], v[168:171]
    s_add_u32 s28, s28, 4096
    v_exp_f32 v161, v161
    v_and_b32 v99, s38, v129
    v_lshlrev_b32 v100, 16, v130
    v_mfma_f32_16x16x32_bf16 v[168:171], a[124:127], a[60:63], v[168:171]
    s_add_u32 m0, s29, 8192
    v_cvt_pk_bf16_f32 v184, v160, v161
    v_and_b32 v101, s38, v130
    v_lshlrev_b32 v102, 16, v131
    v_and_b32 v103, s38, v131
    v_mfma_f32_16x16x32_bf16 v[172:175], a[140:143], a[60:63], v[204:207]
    s_waitcnt lgkmcnt(2)
    v_exp_f32 v162, v162
    v_lshlrev_b32 v104, 16, v132
    v_and_b32 v105, s38, v132
    v_lshlrev_b32 v106, 16, v133
    v_mfma_f32_16x16x32_bf16 v[172:175], a[136:139], a[56:59], v[172:175]
    buffer_load_dwordx4 v224, s[12:15], s28 offen lds
    v_and_b32 v107, s38, v133
    v_lshlrev_b32 v108, 16, v134
    v_and_b32 v109, s38, v134
    v_mfma_f32_16x16x32_bf16 v[172:175], a[132:135], a[52:55], v[172:175]
    s_add_u32 s28, s28, 4096
    v_exp_f32 v163, v163
    v_lshlrev_b32 v110, 16, v135
    v_and_b32 v111, s38, v135
    v_mfma_f32_16x16x32_bf16 v[172:175], a[128:131], a[48:51], v[172:175]
    s_waitcnt lgkmcnt(1)
    v_cvt_pk_bf16_f32 v185, v162, v163
    v_lshlrev_b32 v112, 16, v136
    v_and_b32 v113, s38, v136
    v_lshlrev_b32 v114, 16, v137
    v_and_b32 v115, s38, v137
    v_smfmac_f32_16x16x64_bf16 a[228:231], a[216:219], v[176:183], v226
    v_lshlrev_b32 v116, 16, v138
    v_and_b32 v117, s38, v138
    v_lshlrev_b32 v118, 16, v139
    v_and_b32 v119, s38, v139
    v_mfma_f32_16x16x32_bf16 v[64:67], v[176:179], a[144:147], 0
    s_waitcnt lgkmcnt(0)
    v_exp_f32 v164, v164
    v_lshlrev_b32 v120, 16, v140
    v_and_b32 v121, s38, v140
    v_lshlrev_b32 v122, 16, v141
    v_and_b32 v123, s38, v141
    v_lshlrev_b32 v124, 16, v142
    v_and_b32 v125, s38, v142
    v_lshlrev_b32 v126, 16, v143
    v_and_b32 v127, s38, v143
    v_pk_mul_f32 v[96:97], v[96:97], s[32:33]
    v_pk_mul_f32 v[98:99], v[98:99], s[32:33]
    v_pk_mul_f32 v[100:101], v[100:101], s[32:33]
    v_pk_mul_f32 v[102:103], v[102:103], s[32:33]
    v_pk_mul_f32 v[104:105], v[104:105], s[32:33]
    v_pk_mul_f32 v[106:107], v[106:107], s[32:33]
    v_pk_mul_f32 v[108:109], v[108:109], s[32:33]
    v_pk_mul_f32 v[110:111], v[110:111], s[32:33]
    v_pk_mul_f32 v[112:113], v[112:113], s[32:33]
    v_pk_mul_f32 v[114:115], v[114:115], s[32:33]
    v_pk_mul_f32 v[116:117], v[116:117], s[32:33]
    v_pk_mul_f32 v[118:119], v[118:119], s[32:33]
    v_pk_mul_f32 v[120:121], v[120:121], s[32:33]
    v_pk_mul_f32 v[122:123], v[122:123], s[32:33]
    v_pk_mul_f32 v[124:125], v[124:125], s[32:33]
    v_pk_mul_f32 v[126:127], v[126:127], s[32:33]
    v_mfma_f32_16x16x32_bf16 v[64:67], v[180:183], a[176:179], v[64:67]
    v_cvt_pk_bf16_f32 v128, v96, v97
    v_cvt_pk_bf16_f32 v129, v98, v99
    v_cvt_pk_bf16_f32 v130, v100, v101
    v_cvt_pk_bf16_f32 v131, v102, v103
    v_accvgpr_write_b32 a64, v128
    v_accvgpr_write_b32 a65, v129
    v_accvgpr_write_b32 a66, v130
    v_mfma_f32_16x16x32_bf16 v[68:71], v[176:179], a[148:151], 0
    v_exp_f32 v165, v165
    v_accvgpr_write_b32 a67, v131
    v_cvt_pk_bf16_f32 v132, v104, v105
    v_cvt_pk_bf16_f32 v133, v106, v107
    v_cvt_pk_bf16_f32 v134, v108, v109
    v_cvt_pk_bf16_f32 v135, v110, v111
    v_mfma_f32_16x16x32_bf16 v[68:71], v[180:183], a[180:183], v[68:71]
    v_cvt_pk_bf16_f32 v186, v164, v165
    v_accvgpr_write_b32 a68, v132
    v_accvgpr_write_b32 a69, v133
    v_accvgpr_write_b32 a70, v134
    v_accvgpr_write_b32 a71, v135
    v_cvt_pk_bf16_f32 v136, v112, v113
    v_cvt_pk_bf16_f32 v137, v114, v115
    v_mfma_f32_16x16x32_bf16 v[72:75], v[176:179], a[152:155], 0
    v_exp_f32 v166, v166
    v_cvt_pk_bf16_f32 v138, v116, v117
    v_cvt_pk_bf16_f32 v139, v118, v119
    v_accvgpr_write_b32 a72, v136
    v_accvgpr_write_b32 a73, v137
    v_mfma_f32_16x16x32_bf16 v[72:75], v[180:183], a[184:187], v[72:75]
    v_accvgpr_write_b32 a74, v138
    v_accvgpr_write_b32 a75, v139
    v_cvt_pk_bf16_f32 v140, v120, v121
    v_cvt_pk_bf16_f32 v141, v122, v123
    v_cvt_pk_bf16_f32 v142, v124, v125
    v_cvt_pk_bf16_f32 v143, v126, v127
    v_mfma_f32_16x16x32_bf16 v[76:79], v[176:179], a[156:159], 0
    s_add_u32 m0, s29, 12288
    v_exp_f32 v167, v167
    v_accvgpr_write_b32 a76, v140
    v_accvgpr_write_b32 a77, v141
    v_accvgpr_write_b32 a78, v142
    v_accvgpr_write_b32 a79, v143
    v_mfma_f32_16x16x32_bf16 v[76:79], v[180:183], a[188:191], v[76:79]
    v_cvt_pk_bf16_f32 v187, v166, v167
    v_mfma_f32_16x16x32_bf16 v[208:211], a[80:83], a[64:67], 0
    v_mfma_f32_16x16x32_bf16 v[208:211], a[84:87], a[68:71], v[208:211]
    v_mfma_f32_16x16x32_bf16 v[208:211], a[88:91], a[72:75], v[208:211]
    v_mfma_f32_16x16x32_bf16 v[208:211], a[92:95], a[76:79], v[208:211]
    v_mfma_f32_16x16x32_bf16 v[80:83], v[176:179], a[160:163], 0
    v_exp_f32 v168, v168
    v_mfma_f32_16x16x32_bf16 v[80:83], v[180:183], a[192:195], v[80:83]
    buffer_load_dwordx4 v224, s[12:15], s28 offen lds
    v_mfma_f32_16x16x32_bf16 v[84:87], v[176:179], a[164:167], 0
    s_add_u32 s28, s28, 4096
    v_exp_f32 v169, v169
    v_mfma_f32_16x16x32_bf16 v[84:87], v[180:183], a[196:199], v[84:87]
    v_cvt_pk_bf16_f32 v188, v168, v169
    v_mfma_f32_16x16x32_bf16 v[88:91], v[176:179], a[168:171], 0
L_page0:
    s_cbranch_execz L_page4
    v_exp_f32 v170, v170
    v_max3_f32 v208, v208, v209, v210
    v_mfma_f32_16x16x32_bf16 v[88:91], v[180:183], a[200:203], v[88:91]
    v_max_f32 v208, v208, v211
    v_mov_b32 v209, v208
    v_mfma_f32_16x16x32_bf16 v[92:95], v[176:179], a[172:175], 0
    v_exp_f32 v171, v171
    v_mfma_f32_16x16x32_bf16 v[92:95], v[180:183], a[204:207], v[92:95]
    v_cvt_pk_bf16_f32 v189, v170, v171
    v_permlane16_swap_b32 v208, v209
    v_max_f32 v208, v208, v209
    v_mov_b32 v209, v208
    s_nop 1
    v_permlane32_swap_b32 v208, v209
    v_max_f32 v208, v208, v209
    v_sub_f32 v211, s54, v208
    v_sub_f32 v210, s54, v208
    v_sub_f32 v209, s54, v208
    v_sub_f32 v208, s54, v208
    s_nop 1
    s_waitcnt vmcnt(8)
    s_barrier
    v_mfma_f32_16x16x32_bf16 v[160:163], a[80:83], a[64:67], v[208:211]
    v_exp_f32 v172, v172
    v_mfma_f32_16x16x32_bf16 v[160:163], a[84:87], a[68:71], v[160:163]
    ds_read_b128 a[80:83], v212 offset:16384
    ds_read_b128 a[84:87], v213 offset:16384
    v_mfma_f32_16x16x32_bf16 v[160:163], a[88:91], a[72:75], v[160:163]
    v_exp_f32 v173, v173
    v_mfma_f32_16x16x32_bf16 v[160:163], a[92:95], a[76:79], v[160:163]
    ds_read_b128 a[88:91], v214 offset:16384
    v_cvt_pk_bf16_f32 v190, v172, v173
    v_mfma_f32_16x16x32_bf16 v[164:167], a[108:111], a[76:79], v[208:211]
    v_exp_f32 v174, v174
    v_mfma_f32_16x16x32_bf16 v[164:167], a[104:107], a[72:75], v[164:167]
    ds_read_b128 a[92:95], v215 offset:16384
    ds_read_b128 a[108:111], v215 offset:20480
    v_mfma_f32_16x16x32_bf16 v[164:167], a[100:103], a[68:71], v[164:167]
    v_exp_f32 v175, v175
    v_mfma_f32_16x16x32_bf16 v[164:167], a[96:99], a[64:67], v[164:167]
    ds_read_b128 a[104:107], v214 offset:20480
    v_cvt_pk_bf16_f32 v191, v174, v175
    v_mfma_f32_16x16x32_bf16 v[168:171], a[112:115], a[64:67], v[208:211]
    v_exp_f32 v160, v160
    v_mfma_f32_16x16x32_bf16 v[168:171], a[116:119], a[68:71], v[168:171]
    ds_read_b128 a[100:103], v213 offset:20480
    ds_read_b128 a[96:99], v212 offset:20480
    v_mfma_f32_16x16x32_bf16 v[168:171], a[120:123], a[72:75], v[168:171]
    s_add_u32 m0, s29, 32768
    v_exp_f32 v161, v161
    v_mfma_f32_16x16x32_bf16 v[168:171], a[124:127], a[76:79], v[168:171]
    ds_read_b128 a[112:115], v212 offset:24576
    v_cvt_pk_bf16_f32 v176, v160, v161
    v_mfma_f32_16x16x32_bf16 v[172:175], a[140:143], a[76:79], v[208:211]
    v_exp_f32 v162, v162
    v_mfma_f32_16x16x32_bf16 v[172:175], a[136:139], a[72:75], v[172:175]
    buffer_load_dwordx4 v225, s[16:19], s66 offen lds
    v_mfma_f32_16x16x32_bf16 v[172:175], a[132:135], a[68:71], v[172:175]
    s_add_u32 s66, s66, 4096
    v_exp_f32 v163, v163
    v_mfma_f32_16x16x32_bf16 v[172:175], a[128:131], a[64:67], v[172:175]
    ds_read_b128 a[116:119], v213 offset:24576
    v_cvt_pk_bf16_f32 v177, v162, v163
    v_smfmac_f32_16x16x64_bf16 a[228:231], a[220:223], v[184:191], v226
    ds_read_b128 a[120:123], v214 offset:24576
    ds_read_b128 a[124:127], v215 offset:24576
    v_mfma_f32_16x16x32_bf16 v[96:99], v[184:187], a[144:147], 0
    v_exp_f32 v164, v164
    v_mfma_f32_16x16x32_bf16 v[96:99], v[188:191], a[176:179], v[96:99]
    ds_read_b128 a[140:143], v215 offset:28672
    ds_read_b128 a[136:139], v214 offset:28672
    v_mfma_f32_16x16x32_bf16 v[100:103], v[184:187], a[148:151], 0
    v_exp_f32 v165, v165
    v_mfma_f32_16x16x32_bf16 v[100:103], v[188:191], a[180:183], v[100:103]
    ds_read_b128 a[132:135], v213 offset:28672
    v_cvt_pk_bf16_f32 v178, v164, v165
    v_mfma_f32_16x16x32_bf16 v[104:107], v[184:187], a[152:155], 0
    v_exp_f32 v166, v166
    v_mfma_f32_16x16x32_bf16 v[104:107], v[188:191], a[184:187], v[104:107]
    ds_read_b128 a[128:131], v212 offset:28672
    v_mfma_f32_16x16x32_bf16 v[108:111], v[184:187], a[156:159], 0
    s_add_u32 m0, s29, 36864
    v_exp_f32 v167, v167
    v_mfma_f32_16x16x32_bf16 v[108:111], v[188:191], a[188:191], v[108:111]
    v_cvt_pk_bf16_f32 v179, v166, v167
    v_mfma_f32_16x16x32_bf16 v[112:115], v[184:187], a[160:163], 0
    v_exp_f32 v168, v168
    v_mfma_f32_16x16x32_bf16 v[112:115], v[188:191], a[192:195], v[112:115]
    buffer_load_dwordx4 v225, s[16:19], s66 offen lds
    v_mfma_f32_16x16x32_bf16 v[116:119], v[184:187], a[164:167], 0
    s_add_u32 s66, s66, 4096
    v_exp_f32 v169, v169
    v_mfma_f32_16x16x32_bf16 v[116:119], v[188:191], a[196:199], v[116:119]
    v_cvt_pk_bf16_f32 v180, v168, v169
    v_mfma_f32_16x16x32_bf16 v[120:123], v[184:187], a[168:171], 0
    s_waitcnt vmcnt(6) lgkmcnt(0)
    v_exp_f32 v170, v170
    v_mfma_f32_16x16x32_bf16 v[120:123], v[188:191], a[200:203], v[120:123]
    ds_inc_u32 v248, v248
    v_mfma_f32_16x16x32_bf16 v[124:127], v[184:187], a[172:175], 0
    s_add_u32 s69, s69, 4
    v_exp_f32 v171, v171
    v_mfma_f32_16x16x32_bf16 v[124:127], v[188:191], a[204:207], v[124:127]
    s_add_u32 m0, s29, 40960
    v_cvt_pk_bf16_f32 v181, v170, v171
    v_mfma_f32_16x16x32_bf16 v[160:163], a[80:83], a[0:3], v[192:195]
    v_exp_f32 v172, v172
    v_mfma_f32_16x16x32_bf16 v[160:163], a[84:87], a[4:7], v[160:163]
    buffer_load_dwordx4 v225, s[16:19], s66 offen lds
    v_mfma_f32_16x16x32_bf16 v[160:163], a[88:91], a[8:11], v[160:163]
    s_add_u32 s66, s66, 4096
    v_exp_f32 v173, v173
    v_mfma_f32_16x16x32_bf16 v[160:163], a[92:95], a[12:15], v[160:163]
    ds_read_b32 v249, v248
    v_cvt_pk_bf16_f32 v182, v172, v173
    v_mfma_f32_16x16x32_bf16 v[164:167], a[108:111], a[12:15], v[192:195]
    v_exp_f32 v174, v174
    v_mfma_f32_16x16x32_bf16 v[164:167], a[104:107], a[8:11], v[164:167]
    v_mfma_f32_16x16x32_bf16 v[164:167], a[100:103], a[4:7], v[164:167]
    s_add_u32 m0, s29, 45056
    v_exp_f32 v175, v175
    v_mfma_f32_16x16x32_bf16 v[164:167], a[96:99], a[0:3], v[164:167]
    v_cvt_pk_bf16_f32 v183, v174, v175
    v_mfma_f32_16x16x32_bf16 v[168:171], a[112:115], a[0:3], v[192:195]
    v_exp_f32 v160, v160
    v_mfma_f32_16x16x32_bf16 v[168:171], a[116:119], a[4:7], v[168:171]
    buffer_load_dwordx4 v225, s[16:19], s66 offen lds
    v_mfma_f32_16x16x32_bf16 v[168:171], a[120:123], a[8:11], v[168:171]
    s_add_u32 s66, s66, 4096
    v_exp_f32 v161, v161
    v_mfma_f32_16x16x32_bf16 v[168:171], a[124:127], a[12:15], v[168:171]
    s_waitcnt lgkmcnt(0)
    v_cvt_pk_bf16_f32 v184, v160, v161
    v_cmp_gt_u32 vcc, s69, v249
    v_mfma_f32_16x16x32_bf16 v[172:175], a[140:143], a[12:15], v[192:195]
    s_mov_b32 m0, s74
    v_exp_f32 v162, v162
    v_mfma_f32_16x16x32_bf16 v[172:175], a[136:139], a[8:11], v[172:175]
    v_mfma_f32_16x16x32_bf16 v[172:175], a[132:135], a[4:7], v[172:175]
    s_cbranch_vccnz L_wait_peel
L_go_peel:
    v_exp_f32 v163, v163
    v_mfma_f32_16x16x32_bf16 v[172:175], a[128:131], a[0:3], v[172:175]
    v_cvt_pk_bf16_f32 v185, v162, v163
    v_smfmac_f32_16x16x64_bf16 a[228:231], a[224:227], v[176:183], v226
    buffer_load_dwordx4 v227, s[20:23], s31 offen nt lds
    v_mfma_f32_16x16x32_bf16 v[128:131], v[176:179], a[144:147], 0
    s_add_u32 s31, s31, 1024
    ds_read_b64_tr_b16 a[144:145], v216 offset:49152
    v_exp_f32 v164, v164
    v_mfma_f32_16x16x32_bf16 v[128:131], v[180:183], a[176:179], v[128:131]
    s_add_u32 s74, s74, 1024
    s_min_u32 s74, s74, s75
    ds_read_b64_tr_b16 a[146:147], v216 offset:53248
    v_mfma_f32_16x16x32_bf16 v[132:135], v[176:179], a[148:151], 0
    v_exp_f32 v165, v165
    v_mfma_f32_16x16x32_bf16 v[132:135], v[180:183], a[180:183], v[132:135]
    ds_read_b64_tr_b16 a[176:177], v216 offset:57344
    v_cvt_pk_bf16_f32 v186, v164, v165
    v_mfma_f32_16x16x32_bf16 v[136:139], v[176:179], a[152:155], 0
    v_exp_f32 v166, v166
    v_mfma_f32_16x16x32_bf16 v[136:139], v[180:183], a[184:187], v[136:139]
    ds_read_b64_tr_b16 a[178:179], v216 offset:61440
    ds_read_b64_tr_b16 a[148:149], v217 offset:49152
    v_mfma_f32_16x16x32_bf16 v[140:143], v[176:179], a[156:159], 0
    v_exp_f32 v167, v167
    v_mfma_f32_16x16x32_bf16 v[140:143], v[180:183], a[188:191], v[140:143]
    ds_read_b64_tr_b16 a[150:151], v217 offset:53248
    v_cvt_pk_bf16_f32 v187, v166, v167
    v_mfma_f32_16x16x32_bf16 v[144:147], v[176:179], a[160:163], 0
    v_exp_f32 v168, v168
    v_mfma_f32_16x16x32_bf16 v[144:147], v[180:183], a[192:195], v[144:147]
    ds_read_b64_tr_b16 a[180:181], v217 offset:57344
    ds_read_b64_tr_b16 a[182:183], v217 offset:61440
    v_mfma_f32_16x16x32_bf16 v[148:151], v[176:179], a[164:167], 0
    v_exp_f32 v169, v169
    v_mfma_f32_16x16x32_bf16 v[148:151], v[180:183], a[196:199], v[148:151]
    ds_read_b64_tr_b16 a[152:153], v218 offset:49152
    v_cvt_pk_bf16_f32 v188, v168, v169
    v_mfma_f32_16x16x32_bf16 v[152:155], v[176:179], a[168:171], 0
    v_exp_f32 v170, v170
    v_mfma_f32_16x16x32_bf16 v[152:155], v[180:183], a[200:203], v[152:155]
    ds_read_b64_tr_b16 a[154:155], v218 offset:53248
    ds_read_b64_tr_b16 a[184:185], v218 offset:57344
    v_mfma_f32_16x16x32_bf16 v[156:159], v[176:179], a[172:175], 0
    v_exp_f32 v171, v171
    v_mfma_f32_16x16x32_bf16 v[156:159], v[180:183], a[204:207], v[156:159]
    ds_read_b64_tr_b16 a[186:187], v218 offset:61440
    v_cvt_pk_bf16_f32 v189, v170, v171
    v_mfma_f32_16x16x32_bf16 v[160:163], a[80:83], a[16:19], v[196:199]
    v_exp_f32 v172, v172
    v_mfma_f32_16x16x32_bf16 v[160:163], a[84:87], a[20:23], v[160:163]
    ds_read_b64_tr_b16 a[156:157], v219 offset:49152
    ds_read_b64_tr_b16 a[158:159], v219 offset:53248
    v_mfma_f32_16x16x32_bf16 v[160:163], a[88:91], a[24:27], v[160:163]
    v_exp_f32 v173, v173
    v_mfma_f32_16x16x32_bf16 v[160:163], a[92:95], a[28:31], v[160:163]
    ds_read_b64_tr_b16 a[188:189], v219 offset:57344
    v_cvt_pk_bf16_f32 v190, v172, v173
    v_mfma_f32_16x16x32_bf16 v[164:167], a[108:111], a[28:31], v[196:199]
    v_exp_f32 v174, v174
    v_mfma_f32_16x16x32_bf16 v[164:167], a[104:107], a[24:27], v[164:167]
    ds_read_b64_tr_b16 a[190:191], v219 offset:61440
    ds_read_b64_tr_b16 a[160:161], v220 offset:49152
    v_mfma_f32_16x16x32_bf16 v[164:167], a[100:103], a[20:23], v[164:167]
    v_exp_f32 v175, v175
    v_mfma_f32_16x16x32_bf16 v[164:167], a[96:99], a[16:19], v[164:167]
    ds_read_b64_tr_b16 a[162:163], v220 offset:53248
    v_cvt_pk_bf16_f32 v191, v174, v175
    v_mfma_f32_16x16x32_bf16 v[168:171], a[112:115], a[16:19], v[196:199]
    v_exp_f32 v160, v160
    v_mfma_f32_16x16x32_bf16 v[168:171], a[116:119], a[20:23], v[168:171]
    ds_read_b64_tr_b16 a[192:193], v220 offset:57344
    ds_read_b64_tr_b16 a[194:195], v220 offset:61440
    v_mfma_f32_16x16x32_bf16 v[168:171], a[120:123], a[24:27], v[168:171]
    v_exp_f32 v161, v161
    v_mfma_f32_16x16x32_bf16 v[168:171], a[124:127], a[28:31], v[168:171]
    ds_read_b64_tr_b16 a[164:165], v221 offset:49152
    v_cvt_pk_bf16_f32 v176, v160, v161
    v_mfma_f32_16x16x32_bf16 v[172:175], a[140:143], a[28:31], v[196:199]
    v_exp_f32 v162, v162
    v_mfma_f32_16x16x32_bf16 v[172:175], a[136:139], a[24:27], v[172:175]
    ds_read_b64_tr_b16 a[166:167], v221 offset:53248
    ds_read_b64_tr_b16 a[196:197], v221 offset:57344
    v_mfma_f32_16x16x32_bf16 v[172:175], a[132:135], a[20:23], v[172:175]
    v_exp_f32 v163, v163
    v_mfma_f32_16x16x32_bf16 v[172:175], a[128:131], a[16:19], v[172:175]
    s_waitcnt lgkmcnt(7)
    ds_read_b64_tr_b16 a[198:199], v221 offset:61440
    v_cvt_pk_bf16_f32 v177, v162, v163
    v_smfmac_f32_16x16x64_bf16 a[228:231], a[208:211], v[184:191], v226
    ds_read_b64_tr_b16 a[168:169], v222 offset:49152
    ds_read_b64_tr_b16 a[170:171], v222 offset:53248
    v_mfma_f32_16x16x32_bf16 v[0:3], v[184:187], a[144:147], v[0:3]
    v_exp_f32 v164, v164
    v_mfma_f32_16x16x32_bf16 v[0:3], v[188:191], a[176:179], v[0:3]
    ds_read_b64_tr_b16 a[200:201], v222 offset:57344
    ds_read_b64_tr_b16 a[202:203], v222 offset:61440
    v_mfma_f32_16x16x32_bf16 v[4:7], v[184:187], a[148:151], v[4:7]
    v_exp_f32 v165, v165
    v_mfma_f32_16x16x32_bf16 v[4:7], v[188:191], a[180:183], v[4:7]
    ds_read_b64_tr_b16 a[172:173], v223 offset:49152
    v_cvt_pk_bf16_f32 v178, v164, v165
    v_mfma_f32_16x16x32_bf16 v[8:11], v[184:187], a[152:155], v[8:11]
    v_exp_f32 v166, v166
    v_mfma_f32_16x16x32_bf16 v[8:11], v[188:191], a[184:187], v[8:11]
    ds_read_b64_tr_b16 a[174:175], v223 offset:53248
    ds_read_b64_tr_b16 a[204:205], v223 offset:57344
    v_mfma_f32_16x16x32_bf16 v[12:15], v[184:187], a[156:159], v[12:15]
    s_add_u32 m0, s29, 16384
    v_exp_f32 v167, v167
    v_mfma_f32_16x16x32_bf16 v[12:15], v[188:191], a[188:191], v[12:15]
    s_waitcnt lgkmcnt(7)
    ds_read_b64_tr_b16 a[206:207], v223 offset:61440
    v_cvt_pk_bf16_f32 v179, v166, v167
    v_mfma_f32_16x16x32_bf16 v[16:19], v[184:187], a[160:163], v[16:19]
    v_exp_f32 v168, v168
    v_mfma_f32_16x16x32_bf16 v[16:19], v[188:191], a[192:195], v[16:19]
    buffer_load_dwordx4 v224, s[12:15], s28 offen lds
    v_mfma_f32_16x16x32_bf16 v[20:23], v[184:187], a[164:167], v[20:23]
    s_add_u32 s28, s28, 4096
    v_exp_f32 v169, v169
    v_mfma_f32_16x16x32_bf16 v[20:23], v[188:191], a[196:199], v[20:23]
    s_waitcnt lgkmcnt(4)
    v_cvt_pk_bf16_f32 v180, v168, v169
    v_mfma_f32_16x16x32_bf16 v[24:27], v[184:187], a[168:171], v[24:27]
    v_exp_f32 v170, v170
    v_mfma_f32_16x16x32_bf16 v[24:27], v[188:191], a[200:203], v[24:27]
    s_waitcnt lgkmcnt(0)
    v_mfma_f32_16x16x32_bf16 v[28:31], v[184:187], a[172:175], v[28:31]
    s_add_u32 m0, s29, 20480
    v_exp_f32 v171, v171
    v_mfma_f32_16x16x32_bf16 v[28:31], v[188:191], a[204:207], v[28:31]
    v_cvt_pk_bf16_f32 v181, v170, v171
    v_mfma_f32_16x16x32_bf16 v[160:163], a[80:83], a[32:35], v[200:203]
    v_exp_f32 v172, v172
    v_mfma_f32_16x16x32_bf16 v[160:163], a[84:87], a[36:39], v[160:163]
    buffer_load_dwordx4 v224, s[12:15], s28 offen lds
    v_mfma_f32_16x16x32_bf16 v[160:163], a[88:91], a[40:43], v[160:163]
    s_add_u32 s28, s28, 4096
    v_exp_f32 v173, v173
    v_mfma_f32_16x16x32_bf16 v[160:163], a[92:95], a[44:47], v[160:163]
    v_cvt_pk_bf16_f32 v182, v172, v173
    v_mfma_f32_16x16x32_bf16 v[164:167], a[108:111], a[44:47], v[200:203]
    v_exp_f32 v174, v174
    v_mfma_f32_16x16x32_bf16 v[164:167], a[104:107], a[40:43], v[164:167]
    v_mfma_f32_16x16x32_bf16 v[164:167], a[100:103], a[36:39], v[164:167]
    s_add_u32 m0, s29, 24576
    v_exp_f32 v175, v175
    v_mfma_f32_16x16x32_bf16 v[164:167], a[96:99], a[32:35], v[164:167]
    v_cvt_pk_bf16_f32 v183, v174, v175
    v_mfma_f32_16x16x32_bf16 v[168:171], a[112:115], a[32:35], v[200:203]
    v_exp_f32 v160, v160
    v_mfma_f32_16x16x32_bf16 v[168:171], a[116:119], a[36:39], v[168:171]
    buffer_load_dwordx4 v224, s[12:15], s28 offen lds
    v_mfma_f32_16x16x32_bf16 v[168:171], a[120:123], a[40:43], v[168:171]
    s_add_u32 s28, s28, 4096
    v_exp_f32 v161, v161
    v_mfma_f32_16x16x32_bf16 v[168:171], a[124:127], a[44:47], v[168:171]
    v_cvt_pk_bf16_f32 v184, v160, v161
    v_mfma_f32_16x16x32_bf16 v[172:175], a[140:143], a[44:47], v[200:203]
    v_exp_f32 v162, v162
    v_mfma_f32_16x16x32_bf16 v[172:175], a[136:139], a[40:43], v[172:175]
    v_mfma_f32_16x16x32_bf16 v[172:175], a[132:135], a[36:39], v[172:175]
    s_add_u32 m0, s29, 28672
    v_exp_f32 v163, v163
    v_mfma_f32_16x16x32_bf16 v[172:175], a[128:131], a[32:35], v[172:175]
    v_cvt_pk_bf16_f32 v185, v162, v163
    v_smfmac_f32_16x16x64_bf16 a[228:231], a[212:215], v[176:183], v226
    v_mfma_f32_16x16x32_bf16 v[32:35], v[176:179], a[144:147], v[32:35]
    v_exp_f32 v164, v164
    v_mfma_f32_16x16x32_bf16 v[32:35], v[180:183], a[176:179], v[32:35]
    buffer_load_dwordx4 v224, s[12:15], s28 offen lds
    v_mfma_f32_16x16x32_bf16 v[36:39], v[176:179], a[148:151], v[36:39]
    s_add_u32 s28, s28, 4096
    v_exp_f32 v165, v165
    v_mfma_f32_16x16x32_bf16 v[36:39], v[180:183], a[180:183], v[36:39]
    v_cvt_pk_bf16_f32 v186, v164, v165
    v_mfma_f32_16x16x32_bf16 v[40:43], v[176:179], a[152:155], v[40:43]
    v_exp_f32 v166, v166
    v_mfma_f32_16x16x32_bf16 v[40:43], v[180:183], a[184:187], v[40:43]
    v_mfma_f32_16x16x32_bf16 v[44:47], v[176:179], a[156:159], v[44:47]
    s_mov_b32 m0, s74
    v_exp_f32 v167, v167
    v_mfma_f32_16x16x32_bf16 v[44:47], v[180:183], a[188:191], v[44:47]
    v_cvt_pk_bf16_f32 v187, v166, v167
    v_mfma_f32_16x16x32_bf16 v[48:51], v[176:179], a[160:163], v[48:51]
    v_exp_f32 v168, v168
    v_mfma_f32_16x16x32_bf16 v[48:51], v[180:183], a[192:195], v[48:51]
    buffer_load_dwordx4 v227, s[20:23], s31 offen nt lds
    v_mfma_f32_16x16x32_bf16 v[52:55], v[176:179], a[164:167], v[52:55]
    v_exp_f32 v169, v169
    v_mfma_f32_16x16x32_bf16 v[52:55], v[180:183], a[196:199], v[52:55]
    v_cvt_pk_bf16_f32 v188, v168, v169
    v_mfma_f32_16x16x32_bf16 v[56:59], v[176:179], a[168:171], v[56:59]
    v_exp_f32 v170, v170
    v_mfma_f32_16x16x32_bf16 v[56:59], v[180:183], a[200:203], v[56:59]
    v_mfma_f32_16x16x32_bf16 v[60:63], v[176:179], a[172:175], v[60:63]
    v_exp_f32 v171, v171
    v_mfma_f32_16x16x32_bf16 v[60:63], v[180:183], a[204:207], v[60:63]
L_A:
    v_mfma_f32_16x16x32_bf16 v[160:163], a[80:83], a[48:51], v[204:207]
    s_waitcnt vmcnt(10)
    v_exp_f32 v172, v172
    v_mfma_f32_16x16x32_bf16 v[160:163], a[84:87], a[52:55], v[160:163]
    ds_inc_u32 v248, v248
    v_mfma_f32_16x16x32_bf16 v[160:163], a[88:91], a[56:59], v[160:163]
    s_add_u32 s69, s69, 4
    v_exp_f32 v173, v173
    v_mfma_f32_16x16x32_bf16 v[160:163], a[92:95], a[60:63], v[160:163]
    v_cvt_pk_bf16_f32 v189, v170, v171
    v_cvt_pk_bf16_f32 v190, v172, v173
    v_mfma_f32_16x16x32_bf16 v[164:167], a[108:111], a[60:63], v[204:207]
    v_exp_f32 v174, v174
    v_mfma_f32_16x16x32_bf16 v[164:167], a[104:107], a[56:59], v[164:167]
    s_waitcnt vmcnt(10)
    ds_read_b64 v[232:233], v228 offset:0
    ds_read_b64 v[234:235], v228 offset:512
    v_mfma_f32_16x16x32_bf16 v[164:167], a[100:103], a[52:55], v[164:167]
    v_exp_f32 v175, v175
    v_mfma_f32_16x16x32_bf16 v[164:167], a[96:99], a[48:51], v[164:167]
    ds_read_b32 v249, v248
    v_cvt_pk_bf16_f32 v191, v174, v175
    v_mfma_f32_16x16x32_bf16 v[168:171], a[112:115], a[48:51], v[204:207]
    v_exp_f32 v160, v160
    v_mfma_f32_16x16x32_bf16 v[168:171], a[116:119], a[52:55], v[168:171]
    v_mfma_f32_16x16x32_bf16 v[168:171], a[120:123], a[56:59], v[168:171]
    v_exp_f32 v161, v161
    v_mfma_f32_16x16x32_bf16 v[168:171], a[124:127], a[60:63], v[168:171]
    v_cvt_pk_bf16_f32 v176, v160, v161
    v_mfma_f32_16x16x32_bf16 v[172:175], a[140:143], a[60:63], v[204:207]
    v_exp_f32 v162, v162
    v_mfma_f32_16x16x32_bf16 v[172:175], a[136:139], a[56:59], v[172:175]
    global_load_dword a255, v252, s[58:59]
    v_mfma_f32_16x16x32_bf16 v[172:175], a[132:135], a[52:55], v[172:175]
    v_exp_f32 v163, v163
    v_mfma_f32_16x16x32_bf16 v[172:175], a[128:131], a[48:51], v[172:175]
    s_waitcnt lgkmcnt(0)
    v_cvt_pk_bf16_f32 v177, v162, v163
    v_cmp_gt_u32 vcc, s69, v249
    v_smfmac_f32_16x16x64_bf16 a[228:231], a[216:219], v[184:191], v226
    s_waitcnt lgkmcnt(1)
    v_lshlrev_b32 v240, 16, v232
    v_mfma_f32_16x16x32_bf16 v[64:67], v[184:187], a[144:147], v[64:67]
    v_exp_f32_e64 v164, v164
    v_mfma_f32_16x16x32_bf16 v[64:67], v[188:191], a[176:179], v[64:67]
    v_and_b32 v241, s38, v232
    v_mfma_f32_16x16x32_bf16 v[68:71], v[184:187], a[148:151], v[68:71]
    s_cbranch_vccnz L_wait_A_0_a
L_go_A_0_a:
    v_exp_f32 v165, v165
    v_mfma_f32_16x16x32_bf16 v[68:71], v[188:191], a[180:183], v[68:71]
    s_add_u32 m0, s29, 49152
    v_cvt_pk_bf16_f32 v178, v164, v165
    v_lshlrev_b32 v242, 16, v233
    v_mfma_f32_16x16x32_bf16 v[72:75], v[184:187], a[152:155], v[72:75]
    v_exp_f32 v166, v166
    v_mfma_f32_16x16x32_bf16 v[72:75], v[188:191], a[184:187], v[72:75]
    buffer_load_dwordx4 v225, s[16:19], s66 offen lds
    v_mfma_f32_16x16x32_bf16 v[76:79], v[184:187], a[156:159], v[76:79]
    s_add_u32 s66, s66, 4096
    v_exp_f32 v167, v167
    v_mfma_f32_16x16x32_bf16 v[76:79], v[188:191], a[188:191], v[76:79]
    v_cvt_pk_bf16_f32 v179, v166, v167
    v_and_b32 v243, s38, v233
    v_mfma_f32_16x16x32_bf16 v[80:83], v[184:187], a[160:163], v[80:83]
    v_exp_f32 v168, v168
    v_mfma_f32_16x16x32_bf16 v[80:83], v[188:191], a[192:195], v[80:83]
    v_mul_f32 v240, s32, v240
    v_mul_f32 v241, s32, v241
    v_mfma_f32_16x16x32_bf16 v[84:87], v[184:187], a[164:167], v[84:87]
    s_add_u32 m0, s29, 53248
    v_exp_f32 v169, v169
    v_mfma_f32_16x16x32_bf16 v[84:87], v[188:191], a[196:199], v[84:87]
    v_cvt_pk_bf16_f32 v180, v168, v169
    v_mul_f32 v242, s32, v242
    v_mfma_f32_16x16x32_bf16 v[88:91], v[184:187], a[168:171], v[88:91]
    v_exp_f32 v170, v170
    v_mfma_f32_16x16x32_bf16 v[88:91], v[188:191], a[200:203], v[88:91]
    buffer_load_dwordx4 v225, s[16:19], s66 offen lds
    v_mfma_f32_16x16x32_bf16 v[92:95], v[184:187], a[172:175], v[92:95]
    s_add_u32 s66, s66, 4096
    v_exp_f32 v171, v171
    v_mfma_f32_16x16x32_bf16 v[92:95], v[188:191], a[204:207], v[92:95]
    v_cvt_pk_bf16_f32 v181, v170, v171
    v_mul_f32 v243, s32, v243
    v_mfma_f32_16x16x32_bf16 v[160:163], a[80:83], a[64:67], v[208:211]
    v_exp_f32 v172, v172
    v_mfma_f32_16x16x32_bf16 v[160:163], a[84:87], a[68:71], v[160:163]
    ds_read_b128 a[80:83], v212 offset:0
    ds_read_b128 a[84:87], v213 offset:0
    v_mfma_f32_16x16x32_bf16 v[160:163], a[88:91], a[72:75], v[160:163]
    v_exp_f32 v173, v173
    v_mfma_f32_16x16x32_bf16 v[160:163], a[92:95], a[76:79], v[160:163]
    ds_read_b128 a[88:91], v214 offset:0
    v_cvt_pk_bf16_f32 v182, v172, v173
    v_mfma_f32_16x16x32_bf16 v[164:167], a[108:111], a[76:79], v[208:211]
    v_exp_f32 v174, v174
    v_mfma_f32_16x16x32_bf16 v[164:167], a[104:107], a[72:75], v[164:167]
    ds_read_b128 a[92:95], v215 offset:0
    ds_read_b128 a[108:111], v215 offset:4096
    v_mfma_f32_16x16x32_bf16 v[164:167], a[100:103], a[68:71], v[164:167]
    v_exp_f32 v175, v175
    v_mfma_f32_16x16x32_bf16 v[164:167], a[96:99], a[64:67], v[164:167]
    ds_read_b128 a[104:107], v214 offset:4096
    v_cvt_pk_bf16_f32 v183, v174, v175
    v_mfma_f32_16x16x32_bf16 v[168:171], a[112:115], a[64:67], v[208:211]
    v_exp_f32 v160, v160
    v_mfma_f32_16x16x32_bf16 v[168:171], a[116:119], a[68:71], v[168:171]
    ds_read_b128 a[100:103], v213 offset:4096
    ds_read_b128 a[96:99], v212 offset:4096
    v_mfma_f32_16x16x32_bf16 v[168:171], a[120:123], a[72:75], v[168:171]
    v_exp_f32 v161, v161
    v_mfma_f32_16x16x32_bf16 v[168:171], a[124:127], a[76:79], v[168:171]
    ds_read_b128 a[112:115], v212 offset:8192
    v_cvt_pk_bf16_f32 v184, v160, v161
    v_mfma_f32_16x16x32_bf16 v[172:175], a[140:143], a[76:79], v[208:211]
    v_exp_f32 v162, v162
    v_mfma_f32_16x16x32_bf16 v[172:175], a[136:139], a[72:75], v[172:175]
    ds_read_b128 a[116:119], v213 offset:8192
    ds_read_b128 a[120:123], v214 offset:8192
    v_mfma_f32_16x16x32_bf16 v[172:175], a[132:135], a[68:71], v[172:175]
    v_exp_f32 v163, v163
    v_mfma_f32_16x16x32_bf16 v[172:175], a[128:131], a[64:67], v[172:175]
    ds_read_b128 a[124:127], v215 offset:8192
    v_cvt_pk_bf16_f32 v185, v162, v163
    v_smfmac_f32_16x16x64_bf16 a[228:231], a[220:223], v[176:183], v226
    ds_read_b128 a[140:143], v215 offset:12288
    ds_read_b128 a[136:139], v214 offset:12288
    v_cvt_pk_bf16_f32 v232, v240, v241
    v_mfma_f32_16x16x32_bf16 v[96:99], v[176:179], a[144:147], v[96:99]
    v_exp_f32 v164, v164
    v_mfma_f32_16x16x32_bf16 v[96:99], v[180:183], a[176:179], v[96:99]
    ds_read_b128 a[132:135], v213 offset:12288
    ds_read_b128 a[128:131], v212 offset:12288
    v_mfma_f32_16x16x32_bf16 v[100:103], v[176:179], a[148:151], v[100:103]
    v_exp_f32 v165, v165
    v_mfma_f32_16x16x32_bf16 v[100:103], v[180:183], a[180:183], v[100:103]
    v_cvt_pk_bf16_f32 v186, v164, v165
    v_cvt_pk_bf16_f32 v233, v242, v243
    v_mfma_f32_16x16x32_bf16 v[104:107], v[176:179], a[152:155], v[104:107]
    v_exp_f32 v166, v166
    v_mfma_f32_16x16x32_bf16 v[104:107], v[180:183], a[184:187], v[104:107]
    ds_write_b64 v228, v[232:233] offset:0
    v_mfma_f32_16x16x32_bf16 v[108:111], v[176:179], a[156:159], v[108:111]
    s_add_u32 m0, s29, 57344
    v_exp_f32 v167, v167
    v_mfma_f32_16x16x32_bf16 v[108:111], v[180:183], a[188:191], v[108:111]
    v_cvt_pk_bf16_f32 v187, v166, v167
    v_mfma_f32_16x16x32_bf16 v[112:115], v[176:179], a[160:163], v[112:115]
    v_exp_f32 v168, v168
    v_mfma_f32_16x16x32_bf16 v[112:115], v[180:183], a[192:195], v[112:115]
    buffer_load_dwordx4 v225, s[16:19], s66 offen lds
    v_mfma_f32_16x16x32_bf16 v[116:119], v[176:179], a[164:167], v[116:119]
    s_add_u32 s66, s66, 4096
    v_exp_f32 v169, v169
    v_mfma_f32_16x16x32_bf16 v[116:119], v[180:183], a[196:199], v[116:119]
    v_cvt_pk_bf16_f32 v188, v168, v169
    v_mfma_f32_16x16x32_bf16 v[120:123], v[176:179], a[168:171], v[120:123]
    s_waitcnt vmcnt(9) lgkmcnt(1)
    v_exp_f32 v170, v170
    v_mfma_f32_16x16x32_bf16 v[120:123], v[180:183], a[200:203], v[120:123]
    ds_inc_u32 v248, v248
    v_mfma_f32_16x16x32_bf16 v[124:127], v[176:179], a[172:175], v[124:127]
    s_add_u32 s69, s69, 4
    v_exp_f32 v171, v171
    v_mfma_f32_16x16x32_bf16 v[124:127], v[180:183], a[204:207], v[124:127]
    v_cvt_pk_bf16_f32 v189, v170, v171
    v_lshlrev_b32 v240, 16, v234
    v_mfma_f32_16x16x32_bf16 v[160:163], a[80:83], a[0:3], v[192:195]
    v_exp_f32 v172, v172
    v_mfma_f32_16x16x32_bf16 v[160:163], a[84:87], a[4:7], v[160:163]
    v_and_b32 v241, s38, v234
    v_lshlrev_b32 v242, 16, v235
    v_mfma_f32_16x16x32_bf16 v[160:163], a[88:91], a[8:11], v[160:163]
    s_add_u32 m0, s29, 61440
    v_exp_f32 v173, v173
    v_mfma_f32_16x16x32_bf16 v[160:163], a[92:95], a[12:15], v[160:163]
    ds_read_b32 v249, v248
    v_cvt_pk_bf16_f32 v190, v172, v173
    v_mfma_f32_16x16x32_bf16 v[164:167], a[108:111], a[12:15], v[192:195]
    v_exp_f32 v174, v174
    v_mfma_f32_16x16x32_bf16 v[164:167], a[104:107], a[8:11], v[164:167]
    buffer_load_dwordx4 v225, s[16:19], s66 offen lds
    v_mfma_f32_16x16x32_bf16 v[164:167], a[100:103], a[4:7], v[164:167]
    s_add_u32 s66, s66, 4096
    v_exp_f32 v175, v175
    v_mfma_f32_16x16x32_bf16 v[164:167], a[96:99], a[0:3], v[164:167]
    v_cvt_pk_bf16_f32 v191, v174, v175
    v_and_b32 v243, s38, v235
    v_mfma_f32_16x16x32_bf16 v[168:171], a[112:115], a[0:3], v[192:195]
    v_exp_f32 v160, v160
    v_mfma_f32_16x16x32_bf16 v[168:171], a[116:119], a[4:7], v[168:171]
    v_mul_f32 v240, s32, v240
    v_mul_f32 v241, s32, v241
    v_mfma_f32_16x16x32_bf16 v[168:171], a[120:123], a[8:11], v[168:171]
    v_exp_f32 v161, v161
    v_mfma_f32_16x16x32_bf16 v[168:171], a[124:127], a[12:15], v[168:171]
    s_waitcnt lgkmcnt(0)
    v_cvt_pk_bf16_f32 v176, v160, v161
    v_cmp_gt_u32 vcc, s69, v249
    v_mfma_f32_16x16x32_bf16 v[172:175], a[140:143], a[12:15], v[192:195]
    v_exp_f32 v162, v162
    v_mfma_f32_16x16x32_bf16 v[172:175], a[136:139], a[8:11], v[172:175]
    v_mul_f32 v242, s32, v242
    v_mfma_f32_16x16x32_bf16 v[172:175], a[132:135], a[4:7], v[172:175]
    s_cbranch_vccnz L_wait_A_0_b
L_go_A_0_b:
    v_exp_f32 v163, v163
    v_mfma_f32_16x16x32_bf16 v[172:175], a[128:131], a[0:3], v[172:175]
    v_cvt_pk_bf16_f32 v177, v162, v163
    v_mul_f32 v243, s32, v243
    v_smfmac_f32_16x16x64_bf16 a[228:231], a[224:227], v[184:191], v226
    v_cvt_pk_bf16_f32 v234, v240, v241
    v_mfma_f32_16x16x32_bf16 v[128:131], v[184:187], a[144:147], v[128:131]
    v_exp_f32 v164, v164
    v_mfma_f32_16x16x32_bf16 v[128:131], v[188:191], a[176:179], v[128:131]
    ds_read_b64_tr_b16 a[144:145], v216 offset:32768
    ds_read_b64_tr_b16 a[146:147], v216 offset:36864
    v_mfma_f32_16x16x32_bf16 v[132:135], v[184:187], a[148:151], v[132:135]
    v_exp_f32 v165, v165
    v_mfma_f32_16x16x32_bf16 v[132:135], v[188:191], a[180:183], v[132:135]
    ds_read_b64_tr_b16 a[176:177], v216 offset:40960
    v_cvt_pk_bf16_f32 v178, v164, v165
    v_mfma_f32_16x16x32_bf16 v[136:139], v[184:187], a[152:155], v[136:139]
    v_exp_f32 v166, v166
    v_mfma_f32_16x16x32_bf16 v[136:139], v[188:191], a[184:187], v[136:139]
    ds_read_b64_tr_b16 a[178:179], v216 offset:45056
    ds_read_b64_tr_b16 a[148:149], v217 offset:32768
    v_mfma_f32_16x16x32_bf16 v[140:143], v[184:187], a[156:159], v[140:143]
    v_exp_f32 v167, v167
    v_mfma_f32_16x16x32_bf16 v[140:143], v[188:191], a[188:191], v[140:143]
    ds_read_b64_tr_b16 a[150:151], v217 offset:36864
    v_cvt_pk_bf16_f32 v179, v166, v167
    v_mfma_f32_16x16x32_bf16 v[144:147], v[184:187], a[160:163], v[144:147]
    v_exp_f32 v168, v168
    v_mfma_f32_16x16x32_bf16 v[144:147], v[188:191], a[192:195], v[144:147]
    ds_read_b64_tr_b16 a[180:181], v217 offset:40960
    ds_read_b64_tr_b16 a[182:183], v217 offset:45056
    v_mfma_f32_16x16x32_bf16 v[148:151], v[184:187], a[164:167], v[148:151]
    v_exp_f32 v169, v169
    v_mfma_f32_16x16x32_bf16 v[148:151], v[188:191], a[196:199], v[148:151]
    ds_read_b64_tr_b16 a[152:153], v218 offset:32768
    v_cvt_pk_bf16_f32 v180, v168, v169
    v_mfma_f32_16x16x32_bf16 v[152:155], v[184:187], a[168:171], v[152:155]
    v_exp_f32 v170, v170
    v_mfma_f32_16x16x32_bf16 v[152:155], v[188:191], a[200:203], v[152:155]
    ds_read_b64_tr_b16 a[154:155], v218 offset:36864
    ds_read_b64_tr_b16 a[184:185], v218 offset:40960
    v_mfma_f32_16x16x32_bf16 v[156:159], v[184:187], a[172:175], v[156:159]
    v_exp_f32 v171, v171
    v_mfma_f32_16x16x32_bf16 v[156:159], v[188:191], a[204:207], v[156:159]
    ds_read_b64_tr_b16 a[186:187], v218 offset:45056
    v_cvt_pk_bf16_f32 v181, v170, v171
    v_mfma_f32_16x16x32_bf16 v[160:163], a[80:83], a[16:19], v[196:199]
    v_exp_f32 v172, v172
    v_mfma_f32_16x16x32_bf16 v[160:163], a[84:87], a[20:23], v[160:163]
    ds_read_b64_tr_b16 a[156:157], v219 offset:32768
    ds_read_b64_tr_b16 a[158:159], v219 offset:36864
    v_mfma_f32_16x16x32_bf16 v[160:163], a[88:91], a[24:27], v[160:163]
L_page1:
    s_cbranch_execz L_page5
    v_exp_f32 v173, v173
    v_mfma_f32_16x16x32_bf16 v[160:163], a[92:95], a[28:31], v[160:163]
    ds_read_b64_tr_b16 a[188:189], v219 offset:40960
    v_cvt_pk_bf16_f32 v182, v172, v173
    v_mfma_f32_16x16x32_bf16 v[164:167], a[108:111], a[28:31], v[196:199]
    v_exp_f32 v174, v174
    v_mfma_f32_16x16x32_bf16 v[164:167], a[104:107], a[24:27], v[164:167]
    ds_read_b64_tr_b16 a[190:191], v219 offset:45056
    ds_read_b64_tr_b16 a[160:161], v220 offset:32768
    v_mfma_f32_16x16x32_bf16 v[164:167], a[100:103], a[20:23], v[164:167]
    v_exp_f32 v175, v175
    v_mfma_f32_16x16x32_bf16 v[164:167], a[96:99], a[16:19], v[164:167]
    ds_read_b64_tr_b16 a[162:163], v220 offset:36864
    v_cvt_pk_bf16_f32 v183, v174, v175
    v_mfma_f32_16x16x32_bf16 v[168:171], a[112:115], a[16:19], v[196:199]
    v_exp_f32 v160, v160
    v_mfma_f32_16x16x32_bf16 v[168:171], a[116:119], a[20:23], v[168:171]
    ds_read_b64_tr_b16 a[192:193], v220 offset:40960
    ds_read_b64_tr_b16 a[194:195], v220 offset:45056
    v_mfma_f32_16x16x32_bf16 v[168:171], a[120:123], a[24:27], v[168:171]
    v_exp_f32 v161, v161
    v_mfma_f32_16x16x32_bf16 v[168:171], a[124:127], a[28:31], v[168:171]
    ds_read_b64_tr_b16 a[164:165], v221 offset:32768
    v_cvt_pk_bf16_f32 v184, v160, v161
    v_mfma_f32_16x16x32_bf16 v[172:175], a[140:143], a[28:31], v[196:199]
    v_exp_f32 v162, v162
    v_mfma_f32_16x16x32_bf16 v[172:175], a[136:139], a[24:27], v[172:175]
    ds_read_b64_tr_b16 a[166:167], v221 offset:36864
    ds_read_b64_tr_b16 a[196:197], v221 offset:40960
    v_mfma_f32_16x16x32_bf16 v[172:175], a[132:135], a[20:23], v[172:175]
    v_exp_f32 v163, v163
    v_mfma_f32_16x16x32_bf16 v[172:175], a[128:131], a[16:19], v[172:175]
    s_waitcnt lgkmcnt(7)
    ds_read_b64_tr_b16 a[198:199], v221 offset:45056
    v_cvt_pk_bf16_f32 v185, v162, v163
    v_smfmac_f32_16x16x64_bf16 a[228:231], a[208:211], v[176:183], v226
    ds_read_b64_tr_b16 a[168:169], v222 offset:32768
    ds_read_b64_tr_b16 a[170:171], v222 offset:36864
    v_mfma_f32_16x16x32_bf16 v[0:3], v[176:179], a[144:147], v[0:3]
    v_exp_f32 v164, v164
    v_mfma_f32_16x16x32_bf16 v[0:3], v[180:183], a[176:179], v[0:3]
    ds_read_b64_tr_b16 a[200:201], v222 offset:40960
    ds_read_b64_tr_b16 a[202:203], v222 offset:45056
    v_mfma_f32_16x16x32_bf16 v[4:7], v[176:179], a[148:151], v[4:7]
    v_exp_f32 v165, v165
    v_mfma_f32_16x16x32_bf16 v[4:7], v[180:183], a[180:183], v[4:7]
    ds_read_b64_tr_b16 a[172:173], v223 offset:32768
    v_cvt_pk_bf16_f32 v186, v164, v165
    v_mfma_f32_16x16x32_bf16 v[8:11], v[176:179], a[152:155], v[8:11]
    v_exp_f32 v166, v166
    v_mfma_f32_16x16x32_bf16 v[8:11], v[180:183], a[184:187], v[8:11]
    ds_read_b64_tr_b16 a[174:175], v223 offset:36864
    ds_read_b64_tr_b16 a[204:205], v223 offset:40960
    v_mfma_f32_16x16x32_bf16 v[12:15], v[176:179], a[156:159], v[12:15]
    s_add_u32 m0, s29, 0
    v_exp_f32 v167, v167
    v_mfma_f32_16x16x32_bf16 v[12:15], v[180:183], a[188:191], v[12:15]
    s_waitcnt lgkmcnt(7)
    ds_read_b64_tr_b16 a[206:207], v223 offset:45056
    v_cvt_pk_bf16_f32 v187, v166, v167
    v_mfma_f32_16x16x32_bf16 v[16:19], v[176:179], a[160:163], v[16:19]
    v_exp_f32 v168, v168
    v_mfma_f32_16x16x32_bf16 v[16:19], v[180:183], a[192:195], v[16:19]
    buffer_load_dwordx4 v224, s[12:15], s28 offen lds
    v_mfma_f32_16x16x32_bf16 v[20:23], v[176:179], a[164:167], v[20:23]
    s_add_u32 s28, s28, 4096
    v_exp_f32 v169, v169
    v_mfma_f32_16x16x32_bf16 v[20:23], v[180:183], a[196:199], v[20:23]
    s_waitcnt lgkmcnt(4)
    v_cvt_pk_bf16_f32 v188, v168, v169
    v_cvt_pk_bf16_f32 v235, v242, v243
    v_mfma_f32_16x16x32_bf16 v[24:27], v[176:179], a[168:171], v[24:27]
    v_exp_f32 v170, v170
    v_mfma_f32_16x16x32_bf16 v[24:27], v[180:183], a[200:203], v[24:27]
    s_waitcnt lgkmcnt(0)
    ds_write_b64 v228, v[234:235] offset:512
    v_mfma_f32_16x16x32_bf16 v[28:31], v[176:179], a[172:175], v[28:31]
    s_add_u32 m0, s29, 4096
    v_exp_f32 v171, v171
    v_mfma_f32_16x16x32_bf16 v[28:31], v[180:183], a[204:207], v[28:31]
    s_waitcnt vmcnt(11)
    ds_read_b64 v[236:237], v228 offset:1024
    v_cvt_pk_bf16_f32 v189, v170, v171
    v_mfma_f32_16x16x32_bf16 v[160:163], a[80:83], a[32:35], v[200:203]
    s_add_u32 s31, s31, 1024
    v_exp_f32 v172, v172
    v_mfma_f32_16x16x32_bf16 v[160:163], a[84:87], a[36:39], v[160:163]
    s_add_u32 s74, s74, 1024
    buffer_load_dwordx4 v224, s[12:15], s28 offen lds
    v_mfma_f32_16x16x32_bf16 v[160:163], a[88:91], a[40:43], v[160:163]
    s_add_u32 s28, s28, 4096
    v_exp_f32 v173, v173
    v_mfma_f32_16x16x32_bf16 v[160:163], a[92:95], a[44:47], v[160:163]
    s_min_u32 s74, s74, s75
    ds_read_b64 v[238:239], v228 offset:1536
    v_cvt_pk_bf16_f32 v190, v172, v173
    v_mfma_f32_16x16x32_bf16 v[164:167], a[108:111], a[44:47], v[200:203]
    v_exp_f32 v174, v174
    v_mfma_f32_16x16x32_bf16 v[164:167], a[104:107], a[40:43], v[164:167]
    v_mfma_f32_16x16x32_bf16 v[164:167], a[100:103], a[36:39], v[164:167]
    s_add_u32 m0, s29, 8192
    v_exp_f32 v175, v175
    v_mfma_f32_16x16x32_bf16 v[164:167], a[96:99], a[32:35], v[164:167]
    v_cvt_pk_bf16_f32 v191, v174, v175
    v_mfma_f32_16x16x32_bf16 v[168:171], a[112:115], a[32:35], v[200:203]
    v_exp_f32 v160, v160
    v_mfma_f32_16x16x32_bf16 v[168:171], a[116:119], a[36:39], v[168:171]
    buffer_load_dwordx4 v224, s[12:15], s28 offen lds
    v_mfma_f32_16x16x32_bf16 v[168:171], a[120:123], a[40:43], v[168:171]
    s_add_u32 s28, s28, 4096
    v_exp_f32 v161, v161
    v_mfma_f32_16x16x32_bf16 v[168:171], a[124:127], a[44:47], v[168:171]
    s_waitcnt lgkmcnt(0)
    v_cvt_pk_bf16_f32 v176, v160, v161
    v_lshlrev_b32 v240, 16, v236
    v_mfma_f32_16x16x32_bf16 v[172:175], a[140:143], a[44:47], v[200:203]
    v_exp_f32 v162, v162
    v_mfma_f32_16x16x32_bf16 v[172:175], a[136:139], a[40:43], v[172:175]
    v_and_b32 v241, s38, v236
    v_lshlrev_b32 v242, 16, v237
    v_mfma_f32_16x16x32_bf16 v[172:175], a[132:135], a[36:39], v[172:175]
    s_add_u32 m0, s29, 12288
    v_exp_f32 v163, v163
    v_mfma_f32_16x16x32_bf16 v[172:175], a[128:131], a[32:35], v[172:175]
    v_cvt_pk_bf16_f32 v177, v162, v163
    v_and_b32 v243, s38, v237
    v_smfmac_f32_16x16x64_bf16 a[228:231], a[212:215], v[184:191], v226
    v_mul_f32 v240, s32, v240
    v_mfma_f32_16x16x32_bf16 v[32:35], v[184:187], a[144:147], v[32:35]
    v_exp_f32 v164, v164
    v_mfma_f32_16x16x32_bf16 v[32:35], v[188:191], a[176:179], v[32:35]
    buffer_load_dwordx4 v224, s[12:15], s28 offen lds
    v_mfma_f32_16x16x32_bf16 v[36:39], v[184:187], a[148:151], v[36:39]
    s_add_u32 s28, s28, 4096
    v_exp_f32 v165, v165
    v_mfma_f32_16x16x32_bf16 v[36:39], v[188:191], a[180:183], v[36:39]
    v_cvt_pk_bf16_f32 v178, v164, v165
    v_mul_f32 v241, s32, v241
    v_mfma_f32_16x16x32_bf16 v[40:43], v[184:187], a[152:155], v[40:43]
    v_exp_f32 v166, v166
    v_mfma_f32_16x16x32_bf16 v[40:43], v[188:191], a[184:187], v[40:43]
    v_mul_f32 v242, s32, v242
    v_mul_f32 v243, s32, v243
    v_mfma_f32_16x16x32_bf16 v[44:47], v[184:187], a[156:159], v[44:47]
    s_mov_b32 m0, s74
    v_exp_f32 v167, v167
    v_mfma_f32_16x16x32_bf16 v[44:47], v[188:191], a[188:191], v[44:47]
    v_cvt_pk_bf16_f32 v179, v166, v167
    v_cvt_pk_bf16_f32 v236, v240, v241
    v_mfma_f32_16x16x32_bf16 v[48:51], v[184:187], a[160:163], v[48:51]
    v_exp_f32 v168, v168
    v_mfma_f32_16x16x32_bf16 v[48:51], v[188:191], a[192:195], v[48:51]
    buffer_load_dwordx4 v227, s[20:23], s31 offen nt lds
    v_mfma_f32_16x16x32_bf16 v[52:55], v[184:187], a[164:167], v[52:55]
    v_exp_f32 v169, v169
    v_mfma_f32_16x16x32_bf16 v[52:55], v[188:191], a[196:199], v[52:55]
    v_cvt_pk_bf16_f32 v180, v168, v169
    v_cvt_pk_bf16_f32 v237, v242, v243
    v_mfma_f32_16x16x32_bf16 v[56:59], v[184:187], a[168:171], v[56:59]
    v_exp_f32 v170, v170
    v_mfma_f32_16x16x32_bf16 v[56:59], v[188:191], a[200:203], v[56:59]
    ds_write_b64 v228, v[236:237] offset:1024
    v_mfma_f32_16x16x32_bf16 v[60:63], v[184:187], a[172:175], v[60:63]
    v_exp_f32 v171, v171
    v_mfma_f32_16x16x32_bf16 v[60:63], v[188:191], a[204:207], v[60:63]
    v_cvt_pk_bf16_f32 v181, v170, v171
    v_lshlrev_b32 v240, 16, v238
    v_mfma_f32_16x16x32_bf16 v[160:163], a[80:83], a[48:51], v[204:207]
    s_waitcnt vmcnt(11)
    v_exp_f32 v172, v172
    v_mfma_f32_16x16x32_bf16 v[160:163], a[84:87], a[52:55], v[160:163]
    s_add_u32 s31, s31, 1024
    ds_inc_u32 v248, v248
    v_mfma_f32_16x16x32_bf16 v[160:163], a[88:91], a[56:59], v[160:163]
    s_add_u32 s69, s69, 4
    v_exp_f32 v173, v173
    v_mfma_f32_16x16x32_bf16 v[160:163], a[92:95], a[60:63], v[160:163]
    s_add_u32 s74, s74, 1024
    s_min_u32 s74, s74, s75
    v_cvt_pk_bf16_f32 v182, v172, v173
    v_mfma_f32_16x16x32_bf16 v[164:167], a[108:111], a[60:63], v[204:207]
    v_exp_f32 v174, v174
    v_mfma_f32_16x16x32_bf16 v[164:167], a[104:107], a[56:59], v[164:167]
    v_and_b32 v241, s38, v238
    v_lshlrev_b32 v242, 16, v239
    v_mfma_f32_16x16x32_bf16 v[164:167], a[100:103], a[52:55], v[164:167]
    v_exp_f32 v175, v175
    v_mfma_f32_16x16x32_bf16 v[164:167], a[96:99], a[48:51], v[164:167]
    ds_read_b32 v249, v248
    v_cvt_pk_bf16_f32 v183, v174, v175
    v_mfma_f32_16x16x32_bf16 v[168:171], a[112:115], a[48:51], v[204:207]
    v_exp_f32 v160, v160
    v_mfma_f32_16x16x32_bf16 v[168:171], a[116:119], a[52:55], v[168:171]
    v_and_b32 v243, s38, v239
    v_mul_f32 v240, s32, v240
    v_mfma_f32_16x16x32_bf16 v[168:171], a[120:123], a[56:59], v[168:171]
    s_mov_b32 m0, s74
    v_exp_f32 v161, v161
    v_mfma_f32_16x16x32_bf16 v[168:171], a[124:127], a[60:63], v[168:171]
    v_cvt_pk_bf16_f32 v184, v160, v161
    v_mul_f32 v241, s32, v241
    v_mfma_f32_16x16x32_bf16 v[172:175], a[140:143], a[60:63], v[204:207]
    v_exp_f32 v162, v162
    v_mfma_f32_16x16x32_bf16 v[172:175], a[136:139], a[56:59], v[172:175]
    buffer_load_dwordx4 v227, s[20:23], s31 offen nt lds
    v_mfma_f32_16x16x32_bf16 v[172:175], a[132:135], a[52:55], v[172:175]
    v_exp_f32_e64 v163, v163
    v_mfma_f32_16x16x32_bf16 v[172:175], a[128:131], a[48:51], v[172:175]
    s_waitcnt lgkmcnt(0)
    v_cvt_pk_bf16_f32 v185, v162, v163
    v_cmp_gt_u32 vcc, s69, v249
    v_smfmac_f32_16x16x64_bf16 a[228:231], a[216:219], v[176:183], v226
    v_mul_f32 v242, s32, v242
    v_mfma_f32_16x16x32_bf16 v[64:67], v[176:179], a[144:147], v[64:67]
    v_exp_f32_e64 v164, v164
    v_mfma_f32_16x16x32_bf16 v[64:67], v[180:183], a[176:179], v[64:67]
    v_mul_f32 v243, s32, v243
    v_mfma_f32_16x16x32_bf16 v[68:71], v[176:179], a[148:151], v[68:71]
    s_cbranch_vccnz L_wait_A_1_a
L_go_A_1_a:
    v_exp_f32 v165, v165
    v_mfma_f32_16x16x32_bf16 v[68:71], v[180:183], a[180:183], v[68:71]
    s_add_u32 m0, s29, 32768
    v_cvt_pk_bf16_f32 v186, v164, v165
    v_cvt_pk_bf16_f32 v238, v240, v241
    v_mfma_f32_16x16x32_bf16 v[72:75], v[176:179], a[152:155], v[72:75]
    v_exp_f32 v166, v166
    v_mfma_f32_16x16x32_bf16 v[72:75], v[180:183], a[184:187], v[72:75]
    buffer_load_dwordx4 v225, s[16:19], s66 offen lds
    v_mfma_f32_16x16x32_bf16 v[76:79], v[176:179], a[156:159], v[76:79]
    s_add_u32 s66, s66, 4096
    v_exp_f32 v167, v167
    v_mfma_f32_16x16x32_bf16 v[76:79], v[180:183], a[188:191], v[76:79]
    v_cvt_pk_bf16_f32 v187, v166, v167
    v_cvt_pk_bf16_f32 v239, v242, v243
    v_mfma_f32_16x16x32_bf16 v[80:83], v[176:179], a[160:163], v[80:83]
    v_exp_f32 v168, v168
    v_mfma_f32_16x16x32_bf16 v[80:83], v[180:183], a[192:195], v[80:83]
    ds_write_b64 v228, v[238:239] offset:1536
    v_mfma_f32_16x16x32_bf16 v[84:87], v[176:179], a[164:167], v[84:87]
    s_add_u32 m0, s29, 36864
    v_exp_f32 v169, v169
    v_mfma_f32_16x16x32_bf16 v[84:87], v[180:183], a[196:199], v[84:87]
    v_cvt_pk_bf16_f32 v188, v168, v169
    v_mfma_f32_16x16x32_bf16 v[88:91], v[176:179], a[168:171], v[88:91]
    v_exp_f32 v170, v170
    v_mfma_f32_16x16x32_bf16 v[88:91], v[180:183], a[200:203], v[88:91]
    buffer_load_dwordx4 v225, s[16:19], s66 offen lds
    v_mfma_f32_16x16x32_bf16 v[92:95], v[176:179], a[172:175], v[92:95]
    s_add_u32 s66, s66, 4096
    v_exp_f32 v171, v171
    v_mfma_f32_16x16x32_bf16 v[92:95], v[180:183], a[204:207], v[92:95]
    v_cvt_pk_bf16_f32 v189, v170, v171
    v_mfma_f32_16x16x32_bf16 v[160:163], a[80:83], a[64:67], v[208:211]
    v_exp_f32 v172, v172
    v_mfma_f32_16x16x32_bf16 v[160:163], a[84:87], a[68:71], v[160:163]
    ds_read_b128 a[80:83], v212 offset:16384
    ds_read_b128 a[84:87], v213 offset:16384
    v_mfma_f32_16x16x32_bf16 v[160:163], a[88:91], a[72:75], v[160:163]
    v_exp_f32 v173, v173
    v_mfma_f32_16x16x32_bf16 v[160:163], a[92:95], a[76:79], v[160:163]
    ds_read_b128 a[88:91], v214 offset:16384
    v_cvt_pk_bf16_f32 v190, v172, v173
    v_mfma_f32_16x16x32_bf16 v[164:167], a[108:111], a[76:79], v[208:211]
    v_exp_f32 v174, v174
    v_mfma_f32_16x16x32_bf16 v[164:167], a[104:107], a[72:75], v[164:167]
    ds_read_b128 a[92:95], v215 offset:16384
    ds_read_b128 a[108:111], v215 offset:20480
    v_mfma_f32_16x16x32_bf16 v[164:167], a[100:103], a[68:71], v[164:167]
    v_exp_f32 v175, v175
    v_mfma_f32_16x16x32_bf16 v[164:167], a[96:99], a[64:67], v[164:167]
    ds_read_b128 a[104:107], v214 offset:20480
    v_cvt_pk_bf16_f32 v191, v174, v175
    v_mfma_f32_16x16x32_bf16 v[168:171], a[112:115], a[64:67], v[208:211]
    v_exp_f32 v160, v160
    v_mfma_f32_16x16x32_bf16 v[168:171], a[116:119], a[68:71], v[168:171]
    ds_read_b128 a[100:103], v213 offset:20480
    ds_read_b128 a[96:99], v212 offset:20480
    v_mfma_f32_16x16x32_bf16 v[168:171], a[120:123], a[72:75], v[168:171]
    v_exp_f32 v161, v161
    v_mfma_f32_16x16x32_bf16 v[168:171], a[124:127], a[76:79], v[168:171]
    ds_read_b128 a[112:115], v212 offset:24576
    v_cvt_pk_bf16_f32 v176, v160, v161
    v_mfma_f32_16x16x32_bf16 v[172:175], a[140:143], a[76:79], v[208:211]
    v_exp_f32 v162, v162
    v_mfma_f32_16x16x32_bf16 v[172:175], a[136:139], a[72:75], v[172:175]
    ds_read_b128 a[116:119], v213 offset:24576
    ds_read_b128 a[120:123], v214 offset:24576
    v_mfma_f32_16x16x32_bf16 v[172:175], a[132:135], a[68:71], v[172:175]
    v_exp_f32 v163, v163
    v_mfma_f32_16x16x32_bf16 v[172:175], a[128:131], a[64:67], v[172:175]
    ds_read_b128 a[124:127], v215 offset:24576
    v_cvt_pk_bf16_f32 v177, v162, v163
    v_smfmac_f32_16x16x64_bf16 a[228:231], a[220:223], v[184:191], v226
    ds_read_b128 a[140:143], v215 offset:28672
    ds_read_b128 a[136:139], v214 offset:28672
    v_mfma_f32_16x16x32_bf16 v[96:99], v[184:187], a[144:147], v[96:99]
    v_exp_f32 v164, v164
    v_mfma_f32_16x16x32_bf16 v[96:99], v[188:191], a[176:179], v[96:99]
    ds_read_b128 a[132:135], v213 offset:28672
    ds_read_b128 a[128:131], v212 offset:28672
    v_mfma_f32_16x16x32_bf16 v[100:103], v[184:187], a[148:151], v[100:103]
    v_exp_f32 v165, v165
    v_mfma_f32_16x16x32_bf16 v[100:103], v[188:191], a[180:183], v[100:103]
    v_cvt_pk_bf16_f32 v178, v164, v165
    v_mfma_f32_16x16x32_bf16 v[104:107], v[184:187], a[152:155], v[104:107]
    v_exp_f32 v166, v166
    v_mfma_f32_16x16x32_bf16 v[104:107], v[188:191], a[184:187], v[104:107]
    s_waitcnt vmcnt(13)
    ds_read_b64 v[232:233], v228 offset:2048
    v_mfma_f32_16x16x32_bf16 v[108:111], v[184:187], a[156:159], v[108:111]
    s_add_u32 m0, s29, 40960
    v_exp_f32 v167, v167
    v_mfma_f32_16x16x32_bf16 v[108:111], v[188:191], a[188:191], v[108:111]
    ds_read_b64 v[234:235], v228 offset:2560
    v_cvt_pk_bf16_f32 v179, v166, v167
    v_mfma_f32_16x16x32_bf16 v[112:115], v[184:187], a[160:163], v[112:115]
    v_exp_f32 v168, v168
    v_mfma_f32_16x16x32_bf16 v[112:115], v[188:191], a[192:195], v[112:115]
    buffer_load_dwordx4 v225, s[16:19], s66 offen lds
    v_mfma_f32_16x16x32_bf16 v[116:119], v[184:187], a[164:167], v[116:119]
    s_add_u32 s66, s66, 4096
    v_exp_f32 v169, v169
    v_mfma_f32_16x16x32_bf16 v[116:119], v[188:191], a[196:199], v[116:119]
    v_cvt_pk_bf16_f32 v180, v168, v169
    v_mfma_f32_16x16x32_bf16 v[120:123], v[184:187], a[168:171], v[120:123]
    s_waitcnt vmcnt(9) lgkmcnt(2)
    v_exp_f32 v170, v170
    v_mfma_f32_16x16x32_bf16 v[120:123], v[188:191], a[200:203], v[120:123]
    ds_inc_u32 v248, v248
    v_mfma_f32_16x16x32_bf16 v[124:127], v[184:187], a[172:175], v[124:127]
    s_add_u32 s69, s69, 4
    v_exp_f32 v171, v171
    v_mfma_f32_16x16x32_bf16 v[124:127], v[188:191], a[204:207], v[124:127]
    s_waitcnt lgkmcnt(1)
    v_cvt_pk_bf16_f32 v181, v170, v171
    v_lshlrev_b32 v240, 16, v232
    v_mfma_f32_16x16x32_bf16 v[160:163], a[80:83], a[0:3], v[192:195]
    v_exp_f32 v172, v172
    v_mfma_f32_16x16x32_bf16 v[160:163], a[84:87], a[4:7], v[160:163]
    v_and_b32 v241, s38, v232
    v_lshlrev_b32 v242, 16, v233
    v_mfma_f32_16x16x32_bf16 v[160:163], a[88:91], a[8:11], v[160:163]
    s_add_u32 m0, s29, 45056
    v_exp_f32 v173, v173
    v_mfma_f32_16x16x32_bf16 v[160:163], a[92:95], a[12:15], v[160:163]
    ds_read_b32 v249, v248
    v_cvt_pk_bf16_f32 v182, v172, v173
    v_mfma_f32_16x16x32_bf16 v[164:167], a[108:111], a[12:15], v[192:195]
    v_exp_f32 v174, v174
    v_mfma_f32_16x16x32_bf16 v[164:167], a[104:107], a[8:11], v[164:167]
    buffer_load_dwordx4 v225, s[16:19], s66 offen lds
    v_mfma_f32_16x16x32_bf16 v[164:167], a[100:103], a[4:7], v[164:167]
    s_add_u32 s66, s66, 4096
    v_exp_f32 v175, v175
    v_mfma_f32_16x16x32_bf16 v[164:167], a[96:99], a[0:3], v[164:167]
    v_cvt_pk_bf16_f32 v183, v174, v175
    v_and_b32 v243, s38, v233
    v_mfma_f32_16x16x32_bf16 v[168:171], a[112:115], a[0:3], v[192:195]
    v_exp_f32 v160, v160
    v_mfma_f32_16x16x32_bf16 v[168:171], a[116:119], a[4:7], v[168:171]
    v_mul_f32 v240, s32, v240
    v_mul_f32 v241, s32, v241
    v_mfma_f32_16x16x32_bf16 v[168:171], a[120:123], a[8:11], v[168:171]
    v_exp_f32 v161, v161
    v_mfma_f32_16x16x32_bf16 v[168:171], a[124:127], a[12:15], v[168:171]
    s_waitcnt lgkmcnt(0)
    v_cvt_pk_bf16_f32 v184, v160, v161
    v_cmp_gt_u32 vcc, s69, v249
    v_mfma_f32_16x16x32_bf16 v[172:175], a[140:143], a[12:15], v[192:195]
    v_exp_f32 v162, v162
    v_mfma_f32_16x16x32_bf16 v[172:175], a[136:139], a[8:11], v[172:175]
    v_mul_f32 v242, s32, v242
    v_mfma_f32_16x16x32_bf16 v[172:175], a[132:135], a[4:7], v[172:175]
    s_cbranch_vccnz L_wait_A_1_b
L_go_A_1_b:
    v_exp_f32 v163, v163
    v_mfma_f32_16x16x32_bf16 v[172:175], a[128:131], a[0:3], v[172:175]
    v_cvt_pk_bf16_f32 v185, v162, v163
    v_mul_f32 v243, s32, v243
    v_smfmac_f32_16x16x64_bf16 a[228:231], a[224:227], v[176:183], v226
    v_cvt_pk_bf16_f32 v232, v240, v241
    v_mfma_f32_16x16x32_bf16 v[128:131], v[176:179], a[144:147], v[128:131]
    v_exp_f32 v164, v164
    v_mfma_f32_16x16x32_bf16 v[128:131], v[180:183], a[176:179], v[128:131]
    ds_read_b64_tr_b16 a[144:145], v216 offset:49152
    ds_read_b64_tr_b16 a[146:147], v216 offset:53248
    v_mfma_f32_16x16x32_bf16 v[132:135], v[176:179], a[148:151], v[132:135]
    v_exp_f32 v165, v165
    v_mfma_f32_16x16x32_bf16 v[132:135], v[180:183], a[180:183], v[132:135]
    ds_read_b64_tr_b16 a[176:177], v216 offset:57344
    v_cvt_pk_bf16_f32 v186, v164, v165
    v_mfma_f32_16x16x32_bf16 v[136:139], v[176:179], a[152:155], v[136:139]
    v_exp_f32 v166, v166
    v_mfma_f32_16x16x32_bf16 v[136:139], v[180:183], a[184:187], v[136:139]
    ds_read_b64_tr_b16 a[178:179], v216 offset:61440
    ds_read_b64_tr_b16 a[148:149], v217 offset:49152
    v_mfma_f32_16x16x32_bf16 v[140:143], v[176:179], a[156:159], v[140:143]
    v_exp_f32 v167, v167
    v_mfma_f32_16x16x32_bf16 v[140:143], v[180:183], a[188:191], v[140:143]
    ds_read_b64_tr_b16 a[150:151], v217 offset:53248
    v_cvt_pk_bf16_f32 v187, v166, v167
    v_mfma_f32_16x16x32_bf16 v[144:147], v[176:179], a[160:163], v[144:147]
    v_exp_f32 v168, v168
    v_mfma_f32_16x16x32_bf16 v[144:147], v[180:183], a[192:195], v[144:147]
    ds_read_b64_tr_b16 a[180:181], v217 offset:57344
    ds_read_b64_tr_b16 a[182:183], v217 offset:61440
    v_mfma_f32_16x16x32_bf16 v[148:151], v[176:179], a[164:167], v[148:151]
    v_exp_f32 v169, v169
    v_mfma_f32_16x16x32_bf16 v[148:151], v[180:183], a[196:199], v[148:151]
    ds_read_b64_tr_b16 a[152:153], v218 offset:49152
    v_cvt_pk_bf16_f32 v188, v168, v169
    v_mfma_f32_16x16x32_bf16 v[152:155], v[176:179], a[168:171], v[152:155]
    v_exp_f32 v170, v170
    v_mfma_f32_16x16x32_bf16 v[152:155], v[180:183], a[200:203], v[152:155]
    ds_read_b64_tr_b16 a[154:155], v218 offset:53248
    ds_read_b64_tr_b16 a[184:185], v218 offset:57344
    v_mfma_f32_16x16x32_bf16 v[156:159], v[176:179], a[172:175], v[156:159]
    v_exp_f32 v171, v171
    v_mfma_f32_16x16x32_bf16 v[156:159], v[180:183], a[204:207], v[156:159]
    ds_read_b64_tr_b16 a[186:187], v218 offset:61440
    v_cvt_pk_bf16_f32 v189, v170, v171
    v_mfma_f32_16x16x32_bf16 v[160:163], a[80:83], a[16:19], v[196:199]
    v_exp_f32 v172, v172
    v_mfma_f32_16x16x32_bf16 v[160:163], a[84:87], a[20:23], v[160:163]
    ds_read_b64_tr_b16 a[156:157], v219 offset:49152
    ds_read_b64_tr_b16 a[158:159], v219 offset:53248
    v_mfma_f32_16x16x32_bf16 v[160:163], a[88:91], a[24:27], v[160:163]
    v_exp_f32 v173, v173
    v_mfma_f32_16x16x32_bf16 v[160:163], a[92:95], a[28:31], v[160:163]
    ds_read_b64_tr_b16 a[188:189], v219 offset:57344
    v_cvt_pk_bf16_f32 v190, v172, v173
    v_mfma_f32_16x16x32_bf16 v[164:167], a[108:111], a[28:31], v[196:199]
    v_exp_f32 v174, v174
    v_mfma_f32_16x16x32_bf16 v[164:167], a[104:107], a[24:27], v[164:167]
    ds_read_b64_tr_b16 a[190:191], v219 offset:61440
    ds_read_b64_tr_b16 a[160:161], v220 offset:49152
    v_mfma_f32_16x16x32_bf16 v[164:167], a[100:103], a[20:23], v[164:167]
    v_exp_f32 v175, v175
    v_mfma_f32_16x16x32_bf16 v[164:167], a[96:99], a[16:19], v[164:167]
    ds_read_b64_tr_b16 a[162:163], v220 offset:53248
    v_cvt_pk_bf16_f32 v191, v174, v175
    v_mfma_f32_16x16x32_bf16 v[168:171], a[112:115], a[16:19], v[196:199]
    v_exp_f32 v160, v160
    v_mfma_f32_16x16x32_bf16 v[168:171], a[116:119], a[20:23], v[168:171]
    ds_read_b64_tr_b16 a[192:193], v220 offset:57344
    ds_read_b64_tr_b16 a[194:195], v220 offset:61440
    v_mfma_f32_16x16x32_bf16 v[168:171], a[120:123], a[24:27], v[168:171]
    v_exp_f32 v161, v161
    v_mfma_f32_16x16x32_bf16 v[168:171], a[124:127], a[28:31], v[168:171]
    ds_read_b64_tr_b16 a[164:165], v221 offset:49152
    v_cvt_pk_bf16_f32 v176, v160, v161
    v_mfma_f32_16x16x32_bf16 v[172:175], a[140:143], a[28:31], v[196:199]
    v_exp_f32 v162, v162
    v_mfma_f32_16x16x32_bf16 v[172:175], a[136:139], a[24:27], v[172:175]
    ds_read_b64_tr_b16 a[166:167], v221 offset:53248
    ds_read_b64_tr_b16 a[196:197], v221 offset:57344
    v_mfma_f32_16x16x32_bf16 v[172:175], a[132:135], a[20:23], v[172:175]
    v_exp_f32 v163, v163
    v_mfma_f32_16x16x32_bf16 v[172:175], a[128:131], a[16:19], v[172:175]
    s_waitcnt lgkmcnt(7)
    ds_read_b64_tr_b16 a[198:199], v221 offset:61440
    v_cvt_pk_bf16_f32 v177, v162, v163
    v_smfmac_f32_16x16x64_bf16 a[228:231], a[208:211], v[184:191], v226
    ds_read_b64_tr_b16 a[168:169], v222 offset:49152
    ds_read_b64_tr_b16 a[170:171], v222 offset:53248
    v_mfma_f32_16x16x32_bf16 v[0:3], v[184:187], a[144:147], v[0:3]
    v_exp_f32 v164, v164
    v_mfma_f32_16x16x32_bf16 v[0:3], v[188:191], a[176:179], v[0:3]
    ds_read_b64_tr_b16 a[200:201], v222 offset:57344
    ds_read_b64_tr_b16 a[202:203], v222 offset:61440
    v_mfma_f32_16x16x32_bf16 v[4:7], v[184:187], a[148:151], v[4:7]
    v_exp_f32 v165, v165
    v_mfma_f32_16x16x32_bf16 v[4:7], v[188:191], a[180:183], v[4:7]
    ds_read_b64_tr_b16 a[172:173], v223 offset:49152
    v_cvt_pk_bf16_f32 v178, v164, v165
    v_mfma_f32_16x16x32_bf16 v[8:11], v[184:187], a[152:155], v[8:11]
    v_exp_f32 v166, v166
    v_mfma_f32_16x16x32_bf16 v[8:11], v[188:191], a[184:187], v[8:11]
    ds_read_b64_tr_b16 a[174:175], v223 offset:53248
    ds_read_b64_tr_b16 a[204:205], v223 offset:57344
    v_mfma_f32_16x16x32_bf16 v[12:15], v[184:187], a[156:159], v[12:15]
    s_add_u32 m0, s29, 16384
    v_exp_f32 v167, v167
    v_mfma_f32_16x16x32_bf16 v[12:15], v[188:191], a[188:191], v[12:15]
    s_waitcnt lgkmcnt(7)
    ds_read_b64_tr_b16 a[206:207], v223 offset:61440
    v_cvt_pk_bf16_f32 v179, v166, v167
    v_mfma_f32_16x16x32_bf16 v[16:19], v[184:187], a[160:163], v[16:19]
    v_exp_f32 v168, v168
    v_mfma_f32_16x16x32_bf16 v[16:19], v[188:191], a[192:195], v[16:19]
    buffer_load_dwordx4 v224, s[12:15], s28 offen lds
    v_mfma_f32_16x16x32_bf16 v[20:23], v[184:187], a[164:167], v[20:23]
    s_add_u32 s28, s28, 4096
    v_exp_f32 v169, v169
    v_mfma_f32_16x16x32_bf16 v[20:23], v[188:191], a[196:199], v[20:23]
    s_waitcnt lgkmcnt(4)
    v_cvt_pk_bf16_f32 v180, v168, v169
    v_cvt_pk_bf16_f32 v233, v242, v243
    v_mfma_f32_16x16x32_bf16 v[24:27], v[184:187], a[168:171], v[24:27]
    v_exp_f32 v170, v170
    v_mfma_f32_16x16x32_bf16 v[24:27], v[188:191], a[200:203], v[24:27]
    s_waitcnt lgkmcnt(0)
    ds_write_b64 v228, v[232:233] offset:2048
    v_mfma_f32_16x16x32_bf16 v[28:31], v[184:187], a[172:175], v[28:31]
    s_add_u32 m0, s29, 20480
    v_exp_f32 v171, v171
    v_mfma_f32_16x16x32_bf16 v[28:31], v[188:191], a[204:207], v[28:31]
    v_cvt_pk_bf16_f32 v181, v170, v171
    v_mfma_f32_16x16x32_bf16 v[160:163], a[80:83], a[32:35], v[200:203]
    s_add_u32 s31, s31, 1024
    v_exp_f32 v172, v172
    v_mfma_f32_16x16x32_bf16 v[160:163], a[84:87], a[36:39], v[160:163]
    s_add_u32 s74, s74, 1024
    buffer_load_dwordx4 v224, s[12:15], s28 offen lds
    v_mfma_f32_16x16x32_bf16 v[160:163], a[88:91], a[40:43], v[160:163]
    s_add_u32 s28, s28, 4096
    v_exp_f32 v173, v173
    v_mfma_f32_16x16x32_bf16 v[160:163], a[92:95], a[44:47], v[160:163]
    s_min_u32 s74, s74, s75
    v_cvt_pk_bf16_f32 v182, v172, v173
    v_lshlrev_b32 v240, 16, v234
    v_mfma_f32_16x16x32_bf16 v[164:167], a[108:111], a[44:47], v[200:203]
    v_exp_f32 v174, v174
    v_mfma_f32_16x16x32_bf16 v[164:167], a[104:107], a[40:43], v[164:167]
    v_and_b32 v241, s38, v234
    v_lshlrev_b32 v242, 16, v235
    v_mfma_f32_16x16x32_bf16 v[164:167], a[100:103], a[36:39], v[164:167]
    s_add_u32 m0, s29, 24576
    v_exp_f32 v175, v175
    v_mfma_f32_16x16x32_bf16 v[164:167], a[96:99], a[32:35], v[164:167]
    v_cvt_pk_bf16_f32 v183, v174, v175
    v_and_b32 v243, s38, v235
    v_mfma_f32_16x16x32_bf16 v[168:171], a[112:115], a[32:35], v[200:203]
    v_exp_f32 v160, v160
    v_mfma_f32_16x16x32_bf16 v[168:171], a[116:119], a[36:39], v[168:171]
    buffer_load_dwordx4 v224, s[12:15], s28 offen lds
    v_mfma_f32_16x16x32_bf16 v[168:171], a[120:123], a[40:43], v[168:171]
    s_add_u32 s28, s28, 4096
    v_exp_f32 v161, v161
    v_mfma_f32_16x16x32_bf16 v[168:171], a[124:127], a[44:47], v[168:171]
    v_cvt_pk_bf16_f32 v184, v160, v161
    v_mul_f32 v240, s32, v240
    v_mfma_f32_16x16x32_bf16 v[172:175], a[140:143], a[44:47], v[200:203]
    v_exp_f32 v162, v162
    v_mfma_f32_16x16x32_bf16 v[172:175], a[136:139], a[40:43], v[172:175]
    v_mul_f32 v241, s32, v241
    v_mul_f32 v242, s32, v242
    v_mfma_f32_16x16x32_bf16 v[172:175], a[132:135], a[36:39], v[172:175]
    s_add_u32 m0, s29, 28672
    v_exp_f32 v163, v163
    v_mfma_f32_16x16x32_bf16 v[172:175], a[128:131], a[32:35], v[172:175]
    v_cvt_pk_bf16_f32 v185, v162, v163
    v_mul_f32 v243, s32, v243
    v_smfmac_f32_16x16x64_bf16 a[228:231], a[212:215], v[176:183], v226
    v_cvt_pk_bf16_f32 v234, v240, v241
    v_mfma_f32_16x16x32_bf16 v[32:35], v[176:179], a[144:147], v[32:35]
    v_exp_f32 v164, v164
    v_mfma_f32_16x16x32_bf16 v[32:35], v[180:183], a[176:179], v[32:35]
    buffer_load_dwordx4 v224, s[12:15], s28 offen lds
    v_mfma_f32_16x16x32_bf16 v[36:39], v[176:179], a[148:151], v[36:39]
    s_add_u32 s28, s28, 4096
    v_exp_f32 v165, v165
    v_mfma_f32_16x16x32_bf16 v[36:39], v[180:183], a[180:183], v[36:39]
    v_cvt_pk_bf16_f32 v186, v164, v165
    v_cvt_pk_bf16_f32 v235, v242, v243
    v_mfma_f32_16x16x32_bf16 v[40:43], v[176:179], a[152:155], v[40:43]
    v_exp_f32 v166, v166
    v_mfma_f32_16x16x32_bf16 v[40:43], v[180:183], a[184:187], v[40:43]
    ds_write_b64 v228, v[234:235] offset:2560
    v_mfma_f32_16x16x32_bf16 v[44:47], v[176:179], a[156:159], v[44:47]
    s_mov_b32 m0, s74
    v_exp_f32 v167, v167
    v_mfma_f32_16x16x32_bf16 v[44:47], v[180:183], a[188:191], v[44:47]
    v_cvt_pk_bf16_f32 v187, v166, v167
    v_mfma_f32_16x16x32_bf16 v[48:51], v[176:179], a[160:163], v[48:51]
    v_exp_f32 v168, v168
    v_mfma_f32_16x16x32_bf16 v[48:51], v[180:183], a[192:195], v[48:51]
    buffer_load_dwordx4 v227, s[20:23], s31 offen nt lds
    v_mfma_f32_16x16x32_bf16 v[52:55], v[176:179], a[164:167], v[52:55]
    v_exp_f32 v169, v169
    v_mfma_f32_16x16x32_bf16 v[52:55], v[180:183], a[196:199], v[52:55]
    s_sub_u32 s30, s30, 1
    v_cvt_pk_bf16_f32 v188, v168, v169
    v_mfma_f32_16x16x32_bf16 v[56:59], v[176:179], a[168:171], v[56:59]
    v_exp_f32 v170, v170
    v_mfma_f32_16x16x32_bf16 v[56:59], v[180:183], a[200:203], v[56:59]
    s_cmp_lg_u32 s30, 0
    v_add_u32 v228, 3072, v228
    v_mfma_f32_16x16x32_bf16 v[60:63], v[176:179], a[172:175], v[60:63]
    v_exp_f32 v171, v171
    v_mfma_f32_16x16x32_bf16 v[60:63], v[180:183], a[204:207], v[60:63]
    s_cbranch_scc1 L_A
L_trans:
    v_mfma_f32_16x16x32_bf16 v[160:163], a[80:83], a[48:51], v[204:207]
    s_waitcnt vmcnt(11)
    v_exp_f32 v172, v172
    v_xor_b32 v240, 64, v230
    v_mfma_f32_16x16x32_bf16 v[160:163], a[84:87], a[52:55], v[160:163]
    ds_inc_u32 v248, v248
    v_accvgpr_read_b32 v250, a228
    v_mfma_f32_16x16x32_bf16 v[160:163], a[88:91], a[56:59], v[160:163]
    s_add_u32 s69, s69, 4
    v_exp_f32 v173, v173
    v_accvgpr_read_b32 v243, a229
    v_mfma_f32_16x16x32_bf16 v[160:163], a[92:95], a[60:63], v[160:163]
    v_cvt_pk_bf16_f32 v189, v170, v171
    v_cvt_pk_bf16_f32 v190, v172, v173
    v_add_f32 v250, v250, v243
    v_mfma_f32_16x16x32_bf16 v[164:167], a[108:111], a[60:63], v[204:207]
L_page2:
    s_cbranch_execz L_page6
    v_exp_f32 v174, v174
    v_rcp_f32 v243, v250
    v_mfma_f32_16x16x32_bf16 v[164:167], a[104:107], a[56:59], v[164:167]
    ds_write_b32 v244, v243
    v_xor_b32 v241, 128, v230
    v_xor_b32 v242, 192, v230
    v_mfma_f32_16x16x32_bf16 v[164:167], a[100:103], a[52:55], v[164:167]
    ds_read_b128 v[232:235], v245 offset:0
    v_exp_f32 v175, v175
    v_mfma_f32_16x16x32_bf16 v[164:167], a[96:99], a[48:51], v[164:167]
    ds_read_b32 v249, v248
    v_cvt_pk_bf16_f32 v191, v174, v175
    v_mfma_f32_16x16x32_bf16 v[168:171], a[112:115], a[48:51], v[204:207]
    v_exp_f32 v160, v160
    v_mfma_f32_16x16x32_bf16 v[168:171], a[116:119], a[52:55], v[168:171]
    ds_read_b128 a[0:3], v230 offset:0
    v_max3_f32 v228, abs(v192), abs(v196), abs(v200)
    v_mfma_f32_16x16x32_bf16 v[168:171], a[120:123], a[56:59], v[168:171]
    v_exp_f32 v161, v161
    v_mfma_f32_16x16x32_bf16 v[168:171], a[124:127], a[60:63], v[168:171]
    ds_read_b128 a[4:7], v240 offset:0
    v_cvt_pk_bf16_f32 v176, v160, v161
    v_mfma_f32_16x16x32_bf16 v[172:175], a[140:143], a[60:63], v[204:207]
    v_exp_f32 v162, v162
    v_mfma_f32_16x16x32_bf16 v[172:175], a[136:139], a[56:59], v[172:175]
    ds_read_b128 a[8:11], v241 offset:0
    v_max3_f32 v228, v228, abs(v204), abs(v208)
    v_mfma_f32_16x16x32_bf16 v[172:175], a[132:135], a[52:55], v[172:175]
    v_exp_f32_e64 v163, v163
    v_mfma_f32_16x16x32_bf16 v[172:175], a[128:131], a[48:51], v[172:175]
    s_waitcnt lgkmcnt(3)
    v_cvt_pk_bf16_f32 v177, v162, v163
    v_cmp_gt_u32 vcc, s69, v249
    v_smfmac_f32_16x16x64_bf16 a[228:231], a[216:219], v[184:191], v226
    ds_read_b128 a[12:15], v242 offset:0
    v_mfma_f32_16x16x32_bf16 v[64:67], v[184:187], a[144:147], v[64:67]
    s_waitcnt lgkmcnt(5)
    v_exp_f32_e64 v164, v164
    v_pk_mul_f32 v[0:1], v[0:1], v[232:233]
    v_pk_mul_f32 v[2:3], v[2:3], v[234:235]
    v_pk_mul_f32 v[4:5], v[4:5], v[232:233]
    v_pk_mul_f32 v[6:7], v[6:7], v[234:235]
    v_pk_mul_f32 v[8:9], v[8:9], v[232:233]
    v_pk_mul_f32 v[10:11], v[10:11], v[234:235]
    v_pk_mul_f32 v[12:13], v[12:13], v[232:233]
    v_pk_mul_f32 v[14:15], v[14:15], v[234:235]
    v_pk_mul_f32 v[16:17], v[16:17], v[232:233]
    v_pk_mul_f32 v[18:19], v[18:19], v[234:235]
    v_pk_mul_f32 v[20:21], v[20:21], v[232:233]
    v_pk_mul_f32 v[22:23], v[22:23], v[234:235]
    v_pk_mul_f32 v[24:25], v[24:25], v[232:233]
    v_pk_mul_f32 v[26:27], v[26:27], v[234:235]
    v_pk_mul_f32 v[28:29], v[28:29], v[232:233]
    v_pk_mul_f32 v[30:31], v[30:31], v[234:235]
    v_mfma_f32_16x16x32_bf16 v[64:67], v[188:191], a[176:179], v[64:67]
    ds_read_b128 a[16:19], v230 offset:4096
    v_cvt_pk_bf16_f32 v0, v0, v4
    v_mfma_f32_16x16x32_bf16 v[68:71], v[184:187], a[148:151], v[68:71]
    s_cbranch_vccnz L_wait_tr_0_a
L_go_tr_0_a:
    v_exp_f32 v165, v165
    v_mfma_f32_16x16x32_bf16 v[68:71], v[188:191], a[180:183], v[68:71]
    s_add_u32 m0, s29, 49152
    ds_read_b128 a[20:23], v240 offset:4096
    v_cvt_pk_bf16_f32 v178, v164, v165
    v_mfma_f32_16x16x32_bf16 v[72:75], v[184:187], a[152:155], v[72:75]
    v_exp_f32 v166, v166
    v_mfma_f32_16x16x32_bf16 v[72:75], v[188:191], a[184:187], v[72:75]
    buffer_load_dwordx4 v225, s[16:19], s66 offen lds
    v_mfma_f32_16x16x32_bf16 v[76:79], v[184:187], a[156:159], v[76:79]
    s_add_u32 s66, s66, 4096
    v_exp_f32 v167, v167
    v_accvgpr_read_b32 v250, a230
    v_mfma_f32_16x16x32_bf16 v[76:79], v[188:191], a[188:191], v[76:79]
    ds_read_b128 a[24:27], v241 offset:4096
    v_cvt_pk_bf16_f32 v179, v166, v167
    v_accvgpr_read_b32 v243, a231
    v_mfma_f32_16x16x32_bf16 v[80:83], v[184:187], a[160:163], v[80:83]
    v_exp_f32 v168, v168
    v_add_f32 v250, v250, v243
    v_mfma_f32_16x16x32_bf16 v[80:83], v[188:191], a[192:195], v[80:83]
    ds_read_b128 a[28:31], v242 offset:4096
    v_rcp_f32 v243, v250
    v_mfma_f32_16x16x32_bf16 v[84:87], v[184:187], a[164:167], v[84:87]
    s_add_u32 m0, s29, 53248
    v_exp_f32 v169, v169
    v_mfma_f32_16x16x32_bf16 v[84:87], v[188:191], a[196:199], v[84:87]
    ds_write_b32 v244, v243
    v_cvt_pk_bf16_f32 v180, v168, v169
    v_mfma_f32_16x16x32_bf16 v[88:91], v[184:187], a[168:171], v[88:91]
    v_exp_f32 v170, v170
    v_mfma_f32_16x16x32_bf16 v[88:91], v[188:191], a[200:203], v[88:91]
    buffer_load_dwordx4 v225, s[16:19], s66 offen lds
    v_mfma_f32_16x16x32_bf16 v[92:95], v[184:187], a[172:175], v[92:95]
    s_add_u32 s66, s66, 4096
    v_exp_f32 v171, v171
    v_mfma_f32_16x16x32_bf16 v[92:95], v[188:191], a[204:207], v[92:95]
    ds_read_b128 v[236:239], v245 offset:0
    v_cvt_pk_bf16_f32 v181, v170, v171
    v_mfma_f32_16x16x32_bf16 v[160:163], a[80:83], a[64:67], v[208:211]
    v_exp_f32 v172, v172
    v_mfma_f32_16x16x32_bf16 v[160:163], a[84:87], a[68:71], v[160:163]
    ds_read_b128 a[80:83], v212 offset:0
    ds_read_b128 a[84:87], v213 offset:0
    v_mfma_f32_16x16x32_bf16 v[160:163], a[88:91], a[72:75], v[160:163]
    v_exp_f32 v173, v173
    v_mfma_f32_16x16x32_bf16 v[160:163], a[92:95], a[76:79], v[160:163]
    ds_read_b128 a[88:91], v214 offset:0
    v_cvt_pk_bf16_f32 v182, v172, v173
    v_mfma_f32_16x16x32_bf16 v[164:167], a[108:111], a[76:79], v[208:211]
    v_exp_f32 v174, v174
    v_mfma_f32_16x16x32_bf16 v[164:167], a[104:107], a[72:75], v[164:167]
    ds_read_b128 a[92:95], v215 offset:0
    ds_read_b128 a[108:111], v215 offset:4096
    v_mfma_f32_16x16x32_bf16 v[164:167], a[100:103], a[68:71], v[164:167]
    v_exp_f32 v175, v175
    v_mfma_f32_16x16x32_bf16 v[164:167], a[96:99], a[64:67], v[164:167]
    ds_read_b128 a[104:107], v214 offset:4096
    v_cvt_pk_bf16_f32 v183, v174, v175
    v_mfma_f32_16x16x32_bf16 v[168:171], a[112:115], a[64:67], v[208:211]
    v_exp_f32 v160, v160
    v_mfma_f32_16x16x32_bf16 v[168:171], a[116:119], a[68:71], v[168:171]
    ds_read_b128 a[100:103], v213 offset:4096
    ds_read_b128 a[96:99], v212 offset:4096
    v_mfma_f32_16x16x32_bf16 v[168:171], a[120:123], a[72:75], v[168:171]
    v_exp_f32 v161, v161
    v_mfma_f32_16x16x32_bf16 v[168:171], a[124:127], a[76:79], v[168:171]
    ds_read_b128 a[112:115], v212 offset:8192
    v_cvt_pk_bf16_f32 v184, v160, v161
    v_mfma_f32_16x16x32_bf16 v[172:175], a[140:143], a[76:79], v[208:211]
    v_exp_f32 v162, v162
    v_mfma_f32_16x16x32_bf16 v[172:175], a[136:139], a[72:75], v[172:175]
    ds_read_b128 a[116:119], v213 offset:8192
    ds_read_b128 a[120:123], v214 offset:8192
    v_mfma_f32_16x16x32_bf16 v[172:175], a[132:135], a[68:71], v[172:175]
    s_waitcnt lgkmcnt(7)
    v_exp_f32 v163, v163
    v_mfma_f32_16x16x32_bf16 v[172:175], a[128:131], a[64:67], v[172:175]
    ds_read_b128 a[124:127], v215 offset:8192
    v_cvt_pk_bf16_f32 v185, v162, v163
    v_mfma_f32_16x16x32_bf16 v[192:195], a[80:83], a[0:3], 0
    v_cvt_pk_bf16_f32 v4, v1, v5
    v_cvt_pk_bf16_f32 v1, v8, v12
    v_mfma_f32_16x16x32_bf16 v[192:195], a[84:87], a[4:7], v[192:195]
    ds_write_b64 v246, v[0:1] offset:0
    v_cvt_pk_bf16_f32 v5, v9, v13
    v_mfma_f32_16x16x32_bf16 v[192:195], a[88:91], a[8:11], v[192:195]
    ds_write_b64 v246, v[4:5] offset:256
    v_mfma_f32_16x16x32_bf16 v[192:195], a[92:95], a[12:15], v[192:195]
    v_cvt_pk_bf16_f32 v2, v2, v6
    v_cvt_pk_bf16_f32 v6, v3, v7
    v_cvt_pk_bf16_f32 v3, v10, v14
    v_smfmac_f32_16x16x64_bf16 a[228:231], a[220:223], v[176:183], v226
    ds_read_b128 a[140:143], v215 offset:12288
    ds_read_b128 a[136:139], v214 offset:12288
    v_mfma_f32_16x16x32_bf16 v[96:99], v[176:179], a[144:147], v[96:99]
    v_exp_f32 v164, v164
    v_mfma_f32_16x16x32_bf16 v[96:99], v[180:183], a[176:179], v[96:99]
    ds_read_b128 a[132:135], v213 offset:12288
    ds_read_b128 a[128:131], v212 offset:12288
    v_mfma_f32_16x16x32_bf16 v[100:103], v[176:179], a[148:151], v[100:103]
    v_exp_f32 v165, v165
    v_mfma_f32_16x16x32_bf16 v[100:103], v[180:183], a[180:183], v[100:103]
    v_cvt_pk_bf16_f32 v186, v164, v165
    v_max3_f32 v192, v192, v193, v194
    v_max_f32 v192, v192, v195
    v_mov_b32 v193, v192
    v_mfma_f32_16x16x32_bf16 v[104:107], v[176:179], a[152:155], v[104:107]
    v_exp_f32 v166, v166
    v_mfma_f32_16x16x32_bf16 v[104:107], v[180:183], a[184:187], v[104:107]
    ds_read_b128 a[32:35], v230 offset:8192
    v_permlane16_swap_b32 v192, v193
    v_mfma_f32_16x16x32_bf16 v[108:111], v[176:179], a[156:159], v[108:111]
    s_add_u32 m0, s29, 57344
    v_exp_f32 v167, v167
    v_max_f32 v192, v192, v193
    v_mfma_f32_16x16x32_bf16 v[108:111], v[180:183], a[188:191], v[108:111]
    ds_read_b128 a[36:39], v240 offset:8192
    v_cvt_pk_bf16_f32 v187, v166, v167
    v_mov_b32 v193, v192
    v_mfma_f32_16x16x32_bf16 v[112:115], v[176:179], a[160:163], v[112:115]
    v_exp_f32 v168, v168
    v_mfma_f32_16x16x32_bf16 v[112:115], v[180:183], a[192:195], v[112:115]
    buffer_load_dwordx4 v225, s[16:19], s66 offen lds
    v_permlane32_swap_b32 v192, v193
    v_mfma_f32_16x16x32_bf16 v[116:119], v[176:179], a[164:167], v[116:119]
    s_add_u32 s66, s66, 4096
    v_exp_f32 v169, v169
    v_max_f32 v192, v192, v193
    v_mfma_f32_16x16x32_bf16 v[116:119], v[180:183], a[196:199], v[116:119]
    ds_read_b128 a[40:43], v241 offset:8192
    v_cvt_pk_bf16_f32 v188, v168, v169
    v_sub_f32 v195, -4.0, v192
    v_mfma_f32_16x16x32_bf16 v[120:123], v[176:179], a[168:171], v[120:123]
    s_waitcnt vmcnt(8) lgkmcnt(3)
    v_exp_f32 v170, v170
    v_sub_f32 v194, -4.0, v192
    v_mfma_f32_16x16x32_bf16 v[120:123], v[180:183], a[200:203], v[120:123]
    ds_inc_u32 v248, v248
    v_sub_f32 v193, -4.0, v192
    v_mfma_f32_16x16x32_bf16 v[124:127], v[176:179], a[172:175], v[124:127]
    s_add_u32 s69, s69, 4
    v_exp_f32 v171, v171
    v_sub_f32 v192, -4.0, v192
    v_mfma_f32_16x16x32_bf16 v[124:127], v[180:183], a[204:207], v[124:127]
    ds_read_b128 a[44:47], v242 offset:8192
    v_cvt_pk_bf16_f32 v189, v170, v171
    v_mfma_f32_16x16x32_bf16 v[160:163], a[80:83], a[0:3], v[192:195]
    v_exp_f32 v172, v172
    v_accvgpr_read_b32 v250, a228
    v_mfma_f32_16x16x32_bf16 v[160:163], a[84:87], a[4:7], v[160:163]
    ds_read_b128 a[48:51], v230 offset:12288
    v_accvgpr_read_b32 v243, a229
    v_mfma_f32_16x16x32_bf16 v[160:163], a[88:91], a[8:11], v[160:163]
    s_add_u32 m0, s29, 61440
    s_waitcnt lgkmcnt(15)
    v_exp_f32 v173, v173
    v_add_f32 v250, v250, v243
    v_pk_mul_f32 v[32:33], v[32:33], v[236:237]
    v_pk_mul_f32 v[34:35], v[34:35], v[238:239]
    v_pk_mul_f32 v[36:37], v[36:37], v[236:237]
    v_pk_mul_f32 v[38:39], v[38:39], v[238:239]
    v_pk_mul_f32 v[40:41], v[40:41], v[236:237]
    v_pk_mul_f32 v[42:43], v[42:43], v[238:239]
    v_pk_mul_f32 v[44:45], v[44:45], v[236:237]
    v_pk_mul_f32 v[46:47], v[46:47], v[238:239]
    v_pk_mul_f32 v[48:49], v[48:49], v[236:237]
    v_pk_mul_f32 v[50:51], v[50:51], v[238:239]
    v_pk_mul_f32 v[52:53], v[52:53], v[236:237]
    v_pk_mul_f32 v[54:55], v[54:55], v[238:239]
    v_pk_mul_f32 v[56:57], v[56:57], v[236:237]
    v_pk_mul_f32 v[58:59], v[58:59], v[238:239]
    v_pk_mul_f32 v[60:61], v[60:61], v[236:237]
    v_pk_mul_f32 v[62:63], v[62:63], v[238:239]
    v_mfma_f32_16x16x32_bf16 v[160:163], a[92:95], a[12:15], v[160:163]
    ds_read_b32 v249, v248
    ds_write_b64 v246, v[2:3] offset:512
    v_cvt_pk_bf16_f32 v190, v172, v173
    v_mfma_f32_16x16x32_bf16 v[164:167], a[108:111], a[12:15], v[192:195]
    v_exp_f32 v174, v174
    v_cvt_pk_bf16_f32 v7, v11, v15
    v_mfma_f32_16x16x32_bf16 v[164:167], a[104:107], a[8:11], v[164:167]
    buffer_load_dwordx4 v225, s[16:19], s66 offen lds
    ds_write_b64 v246, v[6:7] offset:768
    v_mfma_f32_16x16x32_bf16 v[164:167], a[100:103], a[4:7], v[164:167]
    s_add_u32 s66, s66, 4096
    v_exp_f32 v175, v175
    v_mfma_f32_16x16x32_bf16 v[164:167], a[96:99], a[0:3], v[164:167]
    ds_read_b128 a[52:55], v240 offset:12288
    v_cvt_pk_bf16_f32 v191, v174, v175
    v_mfma_f32_16x16x32_bf16 v[168:171], a[112:115], a[0:3], v[192:195]
    v_exp_f32 v160, v160
    v_mfma_f32_16x16x32_bf16 v[168:171], a[116:119], a[4:7], v[168:171]
    ds_read_b128 a[56:59], v241 offset:12288
    v_rcp_f32 v243, v250
    v_cvt_pk_bf16_f32 v16, v16, v20
    v_mfma_f32_16x16x32_bf16 v[168:171], a[120:123], a[8:11], v[168:171]
    ds_write_b32 v244, v243
    v_exp_f32 v161, v161
    v_cvt_pk_bf16_f32 v20, v17, v21
    v_mfma_f32_16x16x32_bf16 v[168:171], a[124:127], a[12:15], v[168:171]
    s_waitcnt lgkmcnt(5)
    ds_read_b128 v[232:235], v245 offset:64
    v_cvt_pk_bf16_f32 v176, v160, v161
    v_cmp_gt_u32 vcc, s69, v249
    v_mfma_f32_16x16x32_bf16 v[172:175], a[140:143], a[12:15], v[192:195]
    v_exp_f32 v162, v162
    v_mfma_f32_16x16x32_bf16 v[172:175], a[136:139], a[8:11], v[172:175]
    ds_read_b128 a[60:63], v242 offset:12288
    v_mfma_f32_16x16x32_bf16 v[172:175], a[132:135], a[4:7], v[172:175]
    s_cbranch_vccnz L_wait_tr_0_b
L_go_tr_0_b:
    s_waitcnt lgkmcnt(15)
    v_exp_f32 v163, v163
    v_mfma_f32_16x16x32_bf16 v[172:175], a[128:131], a[0:3], v[172:175]
    v_cvt_pk_bf16_f32 v177, v162, v163
    v_cvt_pk_bf16_f32 v17, v24, v28
    v_mfma_f32_16x16x32_bf16 v[196:199], a[80:83], a[16:19], 0
    ds_write_b64 v246, v[16:17] offset:128
    v_cvt_pk_bf16_f32 v21, v25, v29
    v_mfma_f32_16x16x32_bf16 v[196:199], a[84:87], a[20:23], v[196:199]
    ds_write_b64 v246, v[20:21] offset:384
    v_cvt_pk_bf16_f32 v32, v32, v36
    v_mfma_f32_16x16x32_bf16 v[196:199], a[88:91], a[24:27], v[196:199]
    v_cvt_pk_bf16_f32 v18, v18, v22
    v_cvt_pk_bf16_f32 v22, v19, v23
    v_cvt_pk_bf16_f32 v19, v26, v30
    v_mfma_f32_16x16x32_bf16 v[196:199], a[92:95], a[28:31], v[196:199]
    ds_write_b64 v246, v[18:19] offset:640
    v_cvt_pk_bf16_f32 v23, v27, v31
    v_cvt_pk_bf16_f32 v36, v33, v37
    v_smfmac_f32_16x16x64_bf16 a[228:231], a[224:227], v[184:191], v226
    ds_write_b64 v246, v[22:23] offset:896
    v_cvt_pk_bf16_f32 v33, v40, v44
    v_mfma_f32_16x16x32_bf16 v[128:131], v[184:187], a[144:147], v[128:131]
    v_exp_f32 v164, v164
    v_mfma_f32_16x16x32_bf16 v[128:131], v[188:191], a[176:179], v[128:131]
    ds_read_b64_tr_b16 a[144:145], v216 offset:32768
    ds_read_b64_tr_b16 a[146:147], v216 offset:36864
    v_mfma_f32_16x16x32_bf16 v[132:135], v[184:187], a[148:151], v[132:135]
    v_exp_f32 v165, v165
    v_mfma_f32_16x16x32_bf16 v[132:135], v[188:191], a[180:183], v[132:135]
    ds_read_b64_tr_b16 a[176:177], v216 offset:40960
    v_cvt_pk_bf16_f32 v178, v164, v165
    v_max3_f32 v196, v196, v197, v198
    v_max_f32 v196, v196, v199
    v_mfma_f32_16x16x32_bf16 v[136:139], v[184:187], a[152:155], v[136:139]
    v_exp_f32 v166, v166
    v_mov_b32 v197, v196
    v_mfma_f32_16x16x32_bf16 v[136:139], v[188:191], a[184:187], v[136:139]
    ds_read_b64_tr_b16 a[178:179], v216 offset:45056
    ds_read_b64_tr_b16 a[148:149], v217 offset:32768
    v_mfma_f32_16x16x32_bf16 v[140:143], v[184:187], a[156:159], v[140:143]
    v_exp_f32 v167, v167
    v_permlane16_swap_b32 v196, v197
    v_mfma_f32_16x16x32_bf16 v[140:143], v[188:191], a[188:191], v[140:143]
    ds_read_b64_tr_b16 a[150:151], v217 offset:36864
    v_cvt_pk_bf16_f32 v179, v166, v167
    v_max_f32 v196, v196, v197
    v_mov_b32 v197, v196
    v_mfma_f32_16x16x32_bf16 v[144:147], v[184:187], a[160:163], v[144:147]
    v_exp_f32 v168, v168
    v_mfma_f32_16x16x32_bf16 v[144:147], v[188:191], a[192:195], v[144:147]
    ds_read_b64_tr_b16 a[180:181], v217 offset:40960
    ds_read_b64_tr_b16 a[182:183], v217 offset:45056
    v_permlane32_swap_b32 v196, v197
    v_mfma_f32_16x16x32_bf16 v[148:151], v[184:187], a[164:167], v[148:151]
    v_exp_f32 v169, v169
    v_max_f32 v196, v196, v197
    v_mfma_f32_16x16x32_bf16 v[148:151], v[188:191], a[196:199], v[148:151]
    ds_read_b64_tr_b16 a[152:153], v218 offset:32768
    v_cvt_pk_bf16_f32 v180, v168, v169
    v_sub_f32 v199, -4.0, v196
    v_mfma_f32_16x16x32_bf16 v[152:155], v[184:187], a[168:171], v[152:155]
    v_exp_f32 v170, v170
    v_sub_f32 v198, -4.0, v196
    v_mfma_f32_16x16x32_bf16 v[152:155], v[188:191], a[200:203], v[152:155]
    ds_read_b64_tr_b16 a[154:155], v218 offset:36864
    ds_read_b64_tr_b16 a[184:185], v218 offset:40960
    v_sub_f32 v197, -4.0, v196
    v_mfma_f32_16x16x32_bf16 v[156:159], v[184:187], a[172:175], v[156:159]
    v_exp_f32 v171, v171
    v_sub_f32 v196, -4.0, v196
    v_mfma_f32_16x16x32_bf16 v[156:159], v[188:191], a[204:207], v[156:159]
    ds_read_b64_tr_b16 a[186:187], v218 offset:45056
    v_cvt_pk_bf16_f32 v181, v170, v171
    v_mfma_f32_16x16x32_bf16 v[160:163], a[80:83], a[16:19], v[196:199]
    v_exp_f32 v172, v172
    v_mfma_f32_16x16x32_bf16 v[160:163], a[84:87], a[20:23], v[160:163]
    ds_read_b64_tr_b16 a[156:157], v219 offset:32768
    ds_read_b64_tr_b16 a[158:159], v219 offset:36864
    v_mfma_f32_16x16x32_bf16 v[160:163], a[88:91], a[24:27], v[160:163]
    v_exp_f32 v173, v173
    v_mfma_f32_16x16x32_bf16 v[160:163], a[92:95], a[28:31], v[160:163]
    ds_read_b64_tr_b16 a[188:189], v219 offset:40960
    v_cvt_pk_bf16_f32 v182, v172, v173
    v_mfma_f32_16x16x32_bf16 v[164:167], a[108:111], a[28:31], v[196:199]
    v_exp_f32 v174, v174
    v_mfma_f32_16x16x32_bf16 v[164:167], a[104:107], a[24:27], v[164:167]
    ds_read_b64_tr_b16 a[190:191], v219 offset:45056
    ds_read_b64_tr_b16 a[160:161], v220 offset:32768
    v_mfma_f32_16x16x32_bf16 v[164:167], a[100:103], a[20:23], v[164:167]
    v_exp_f32 v175, v175
    v_mfma_f32_16x16x32_bf16 v[164:167], a[96:99], a[16:19], v[164:167]
    ds_read_b64_tr_b16 a[162:163], v220 offset:36864
    ds_write_b64 v246, v[32:33] offset:4096
    v_cvt_pk_bf16_f32 v183, v174, v175
    v_mfma_f32_16x16x32_bf16 v[168:171], a[112:115], a[16:19], v[196:199]
    v_exp_f32 v160, v160
    v_cvt_pk_bf16_f32 v37, v41, v45
    v_mfma_f32_16x16x32_bf16 v[168:171], a[116:119], a[20:23], v[168:171]
    ds_read_b64_tr_b16 a[192:193], v220 offset:40960
    ds_read_b64_tr_b16 a[194:195], v220 offset:45056
    ds_write_b64 v246, v[36:37] offset:4352
    v_mfma_f32_16x16x32_bf16 v[168:171], a[120:123], a[24:27], v[168:171]
    v_exp_f32 v161, v161
    v_cvt_pk_bf16_f32 v34, v34, v38
    v_mfma_f32_16x16x32_bf16 v[168:171], a[124:127], a[28:31], v[168:171]
    ds_read_b64_tr_b16 a[164:165], v221 offset:32768
    v_cvt_pk_bf16_f32 v184, v160, v161
    v_cvt_pk_bf16_f32 v38, v35, v39
    v_mfma_f32_16x16x32_bf16 v[172:175], a[140:143], a[28:31], v[196:199]
    v_exp_f32 v162, v162
    v_cvt_pk_bf16_f32 v35, v42, v46
    v_mfma_f32_16x16x32_bf16 v[172:175], a[136:139], a[24:27], v[172:175]
    ds_read_b64_tr_b16 a[166:167], v221 offset:36864
    ds_read_b64_tr_b16 a[196:197], v221 offset:40960
    ds_write_b64 v246, v[34:35] offset:4608
    v_mfma_f32_16x16x32_bf16 v[172:175], a[132:135], a[20:23], v[172:175]
    s_waitcnt lgkmcnt(15)
    v_exp_f32 v163, v163
    v_cvt_pk_bf16_f32 v39, v43, v47
    v_mfma_f32_16x16x32_bf16 v[172:175], a[128:131], a[16:19], v[172:175]
    s_waitcnt lgkmcnt(10)
    ds_read_b64_tr_b16 a[198:199], v221 offset:45056
    ds_write_b64 v246, v[38:39] offset:4864
    v_cvt_pk_bf16_f32 v185, v162, v163
    v_mfma_f32_16x16x32_bf16 v[200:203], a[80:83], a[32:35], 0
    v_cvt_pk_bf16_f32 v48, v48, v52
    v_cvt_pk_bf16_f32 v52, v49, v53
    v_mfma_f32_16x16x32_bf16 v[200:203], a[84:87], a[36:39], v[200:203]
    ds_read_b128 a[64:67], v230 offset:16384
    v_cvt_pk_bf16_f32 v49, v56, v60
    v_mfma_f32_16x16x32_bf16 v[200:203], a[88:91], a[40:43], v[200:203]
    ds_write_b64 v246, v[48:49] offset:4224
    v_cvt_pk_bf16_f32 v53, v57, v61
    v_mfma_f32_16x16x32_bf16 v[200:203], a[92:95], a[44:47], v[200:203]
    ds_write_b64 v246, v[52:53] offset:4480
    v_cvt_pk_bf16_f32 v50, v50, v54
    v_smfmac_f32_16x16x64_bf16 a[232:235], a[208:211], v[176:183], v226
    ds_read_b64_tr_b16 a[168:169], v222 offset:32768
    ds_read_b64_tr_b16 a[170:171], v222 offset:36864
    v_cvt_pk_bf16_f32 v54, v51, v55
    v_cvt_pk_bf16_f32 v51, v58, v62
    v_mfma_f32_16x16x32_bf16 v[0:3], v[176:179], a[144:147], 0
    ds_write_b64 v246, v[50:51] offset:4736
    v_exp_f32 v164, v164
    v_mfma_f32_16x16x32_bf16 v[0:3], v[180:183], a[176:179], v[0:3]
    ds_read_b64_tr_b16 a[200:201], v222 offset:40960
    ds_read_b64_tr_b16 a[202:203], v222 offset:45056
    v_cvt_pk_bf16_f32 v55, v59, v63
    v_mfma_f32_16x16x32_bf16 v[4:7], v[176:179], a[148:151], 0
    ds_write_b64 v246, v[54:55] offset:4992
    v_exp_f32 v165, v165
    v_mfma_f32_16x16x32_bf16 v[4:7], v[180:183], a[180:183], v[4:7]
    ds_read_b64_tr_b16 a[172:173], v223 offset:32768
    v_cvt_pk_bf16_f32 v186, v164, v165
    v_max3_f32 v200, v200, v201, v202
    v_mfma_f32_16x16x32_bf16 v[8:11], v[176:179], a[152:155], 0
    v_exp_f32 v166, v166
    v_max_f32 v200, v200, v203
    v_mfma_f32_16x16x32_bf16 v[8:11], v[180:183], a[184:187], v[8:11]
    ds_read_b64_tr_b16 a[174:175], v223 offset:36864
    ds_read_b64_tr_b16 a[204:205], v223 offset:40960
    v_mov_b32 v201, v200
    v_mfma_f32_16x16x32_bf16 v[12:15], v[176:179], a[156:159], 0
    s_add_u32 m0, s29, 0
    v_exp_f32 v167, v167
    v_mfma_f32_16x16x32_bf16 v[12:15], v[180:183], a[188:191], v[12:15]
    s_waitcnt lgkmcnt(13)
    ds_read_b64_tr_b16 a[206:207], v223 offset:45056
    v_cvt_pk_bf16_f32 v187, v166, v167
    v_permlane16_swap_b32 v200, v201
    v_mfma_f32_16x16x32_bf16 v[16:19], v[176:179], a[160:163], 0
    s_waitcnt lgkmcnt(15)
    v_exp_f32 v168, v168
    v_max_f32 v200, v200, v201
    v_mov_b32 v201, v200
    v_pk_mul_f32 v[64:65], v[64:65], v[232:233]
    v_pk_mul_f32 v[66:67], v[66:67], v[234:235]
    v_pk_mul_f32 v[68:69], v[68:69], v[232:233]
    v_pk_mul_f32 v[70:71], v[70:71], v[234:235]
    v_pk_mul_f32 v[72:73], v[72:73], v[232:233]
    v_pk_mul_f32 v[74:75], v[74:75], v[234:235]
    v_pk_mul_f32 v[76:77], v[76:77], v[232:233]
    v_pk_mul_f32 v[78:79], v[78:79], v[234:235]
    v_pk_mul_f32 v[80:81], v[80:81], v[232:233]
    v_pk_mul_f32 v[82:83], v[82:83], v[234:235]
    v_pk_mul_f32 v[84:85], v[84:85], v[232:233]
    v_pk_mul_f32 v[86:87], v[86:87], v[234:235]
    v_pk_mul_f32 v[88:89], v[88:89], v[232:233]
    v_pk_mul_f32 v[90:91], v[90:91], v[234:235]
    v_pk_mul_f32 v[92:93], v[92:93], v[232:233]
    v_pk_mul_f32 v[94:95], v[94:95], v[234:235]
    v_mfma_f32_16x16x32_bf16 v[16:19], v[180:183], a[192:195], v[16:19]
    buffer_load_dwordx4 v224, s[12:15], s28 offen lds
    v_cvt_pk_bf16_f32 v64, v64, v68
    v_mfma_f32_16x16x32_bf16 v[20:23], v[176:179], a[164:167], 0
    s_add_u32 s28, s28, 4096
    v_exp_f32 v169, v169
    v_permlane32_swap_b32 v200, v201
    v_mfma_f32_16x16x32_bf16 v[20:23], v[180:183], a[196:199], v[20:23]
    s_waitcnt lgkmcnt(5)
    ds_read_b128 a[68:71], v240 offset:16384
    v_cvt_pk_bf16_f32 v188, v168, v169
    v_max_f32 v200, v200, v201
    v_mfma_f32_16x16x32_bf16 v[24:27], v[176:179], a[168:171], 0
    v_exp_f32 v170, v170
    v_sub_f32 v203, -4.0, v200
    v_mfma_f32_16x16x32_bf16 v[24:27], v[180:183], a[200:203], v[24:27]
    s_waitcnt lgkmcnt(1)
    ds_read_b128 a[72:75], v241 offset:16384
    v_sub_f32 v202, -4.0, v200
    v_sub_f32 v201, -4.0, v200
    v_mfma_f32_16x16x32_bf16 v[28:31], v[176:179], a[172:175], 0
    s_add_u32 m0, s29, 4096
    v_exp_f32 v171, v171
    v_sub_f32 v200, -4.0, v200
    v_mfma_f32_16x16x32_bf16 v[28:31], v[180:183], a[204:207], v[28:31]
    ds_read_b128 a[76:79], v242 offset:16384
    v_cvt_pk_bf16_f32 v189, v170, v171
    v_cvt_pk_bf16_f32 v68, v65, v69
    v_mfma_f32_16x16x32_bf16 v[160:163], a[80:83], a[32:35], v[200:203]
    v_exp_f32 v172, v172
    v_cvt_pk_bf16_f32 v65, v72, v76
    v_mfma_f32_16x16x32_bf16 v[160:163], a[84:87], a[36:39], v[160:163]
    buffer_load_dwordx4 v224, s[12:15], s28 offen lds
    v_mfma_f32_16x16x32_bf16 v[160:163], a[88:91], a[40:43], v[160:163]
    s_add_u32 s28, s28, 4096
    v_exp_f32 v173, v173
    v_mfma_f32_16x16x32_bf16 v[160:163], a[92:95], a[44:47], v[160:163]
    ds_write_b64 v246, v[64:65] offset:8192
    v_cvt_pk_bf16_f32 v190, v172, v173
    v_mfma_f32_16x16x32_bf16 v[164:167], a[108:111], a[44:47], v[200:203]
    v_exp_f32 v174, v174
    v_cvt_pk_bf16_f32 v69, v73, v77
    v_mfma_f32_16x16x32_bf16 v[164:167], a[104:107], a[40:43], v[164:167]
    ds_write_b64 v246, v[68:69] offset:8448
    v_mfma_f32_16x16x32_bf16 v[164:167], a[100:103], a[36:39], v[164:167]
    s_add_u32 m0, s29, 8192
    v_exp_f32 v175, v175
    v_cvt_pk_bf16_f32 v66, v66, v70
    v_mfma_f32_16x16x32_bf16 v[164:167], a[96:99], a[32:35], v[164:167]
    v_cvt_pk_bf16_f32 v191, v174, v175
    v_cvt_pk_bf16_f32 v70, v67, v71
    v_cvt_pk_bf16_f32 v67, v74, v78
    v_mfma_f32_16x16x32_bf16 v[168:171], a[112:115], a[32:35], v[200:203]
    ds_write_b64 v246, v[66:67] offset:8704
    v_exp_f32 v160, v160
    v_mfma_f32_16x16x32_bf16 v[168:171], a[116:119], a[36:39], v[168:171]
    buffer_load_dwordx4 v224, s[12:15], s28 offen lds
    v_cvt_pk_bf16_f32 v71, v75, v79
    v_mfma_f32_16x16x32_bf16 v[168:171], a[120:123], a[40:43], v[168:171]
    s_add_u32 s28, s28, 4096
    v_exp_f32 v161, v161
    v_mfma_f32_16x16x32_bf16 v[168:171], a[124:127], a[44:47], v[168:171]
    ds_write_b64 v246, v[70:71] offset:8960
    v_cvt_pk_bf16_f32 v176, v160, v161
    v_mfma_f32_16x16x32_bf16 v[172:175], a[140:143], a[44:47], v[200:203]
    v_exp_f32 v162, v162
    v_cvt_pk_bf16_f32 v80, v80, v84
    v_mfma_f32_16x16x32_bf16 v[172:175], a[136:139], a[40:43], v[172:175]
    v_accvgpr_read_b32 v227, a230
    v_accvgpr_read_b32 v243, a231
    v_cvt_pk_bf16_f32 v84, v81, v85
    v_mfma_f32_16x16x32_bf16 v[172:175], a[132:135], a[36:39], v[172:175]
    s_add_u32 m0, s29, 12288
    s_waitcnt lgkmcnt(15)
    v_exp_f32 v163, v163
    v_mfma_f32_16x16x32_bf16 v[172:175], a[128:131], a[32:35], v[172:175]
    v_cvt_pk_bf16_f32 v177, v162, v163
    v_add_f32 v227, v227, v243
    v_mfma_f32_16x16x32_bf16 v[204:207], a[80:83], a[48:51], 0
    v_rcp_f32 v243, v227
    v_mfma_f32_16x16x32_bf16 v[204:207], a[84:87], a[52:55], v[204:207]
    ds_write_b32 v244, v243
    v_mfma_f32_16x16x32_bf16 v[204:207], a[88:91], a[56:59], v[204:207]
    ds_read_b128 v[236:239], v245 offset:64
    v_cvt_pk_bf16_f32 v81, v88, v92
    v_mfma_f32_16x16x32_bf16 v[204:207], a[92:95], a[60:63], v[204:207]
    ds_write_b64 v246, v[80:81] offset:8320
    v_cvt_pk_bf16_f32 v85, v89, v93
    v_smfmac_f32_16x16x64_bf16 a[232:235], a[212:215], v[184:191], v226
    ds_write_b64 v246, v[84:85] offset:8576
    v_mfma_f32_16x16x32_bf16 v[32:35], v[184:187], a[144:147], 0
    v_exp_f32 v164, v164
    v_cvt_pk_bf16_f32 v82, v82, v86
    v_mfma_f32_16x16x32_bf16 v[32:35], v[188:191], a[176:179], v[32:35]
    buffer_load_dwordx4 v224, s[12:15], s28 offen lds
    v_cvt_pk_bf16_f32 v86, v83, v87
    v_mfma_f32_16x16x32_bf16 v[36:39], v[184:187], a[148:151], 0
    s_add_u32 s28, s28, 4096
    v_exp_f32 v165, v165
    v_cvt_pk_bf16_f32 v83, v90, v94
    v_mfma_f32_16x16x32_bf16 v[36:39], v[188:191], a[180:183], v[36:39]
    ds_write_b64 v246, v[82:83] offset:8832
    v_cvt_pk_bf16_f32 v178, v164, v165
    v_max3_f32 v204, v204, v205, v206
    v_mfma_f32_16x16x32_bf16 v[40:43], v[184:187], a[152:155], 0
    v_exp_f32 v166, v166
    v_cvt_pk_bf16_f32 v87, v91, v95
    v_mfma_f32_16x16x32_bf16 v[40:43], v[188:191], a[184:187], v[40:43]
    ds_write_b64 v246, v[86:87] offset:9088
    v_max_f32 v204, v204, v207
    v_mov_b32 v205, v204
    v_mfma_f32_16x16x32_bf16 v[44:47], v[184:187], a[156:159], 0
L_page3:
    s_cbranch_execz L_page7
    v_exp_f32 v167, v167
    v_mfma_f32_16x16x32_bf16 v[44:47], v[188:191], a[188:191], v[44:47]
    v_cvt_pk_bf16_f32 v179, v166, v167
    v_permlane16_swap_b32 v204, v205
    v_mfma_f32_16x16x32_bf16 v[48:51], v[184:187], a[160:163], 0
    v_exp_f32 v168, v168
    v_mfma_f32_16x16x32_bf16 v[48:51], v[188:191], a[192:195], v[48:51]
    v_max_f32 v204, v204, v205
    v_mov_b32 v205, v204
    v_mfma_f32_16x16x32_bf16 v[52:55], v[184:187], a[164:167], 0
    v_exp_f32 v169, v169
    v_accvgpr_read_b32 v250, a228
    v_mfma_f32_16x16x32_bf16 v[52:55], v[188:191], a[196:199], v[52:55]
    v_cvt_pk_bf16_f32 v180, v168, v169
    v_permlane32_swap_b32 v204, v205
    v_mfma_f32_16x16x32_bf16 v[56:59], v[184:187], a[168:171], 0
    v_exp_f32 v170, v170
    v_max_f32 v204, v204, v205
    v_mfma_f32_16x16x32_bf16 v[56:59], v[188:191], a[200:203], v[56:59]
    v_sub_f32 v207, -4.0, v204
    v_sub_f32 v206, -4.0, v204
    v_sub_f32 v205, -4.0, v204
    v_mfma_f32_16x16x32_bf16 v[60:63], v[184:187], a[172:175], 0
    v_exp_f32 v171, v171
    v_sub_f32 v204, -4.0, v204
    v_mfma_f32_16x16x32_bf16 v[60:63], v[188:191], a[204:207], v[60:63]
    v_cvt_pk_bf16_f32 v181, v170, v171
    v_accvgpr_read_b32 v243, a229
    v_add_f32 v250, v250, v243
    v_mfma_f32_16x16x32_bf16 v[160:163], a[80:83], a[48:51], v[204:207]
    s_waitcnt vmcnt(9)
    s_waitcnt lgkmcnt(4)
    v_exp_f32 v172, v172
    v_rcp_f32 v243, v250
    v_pk_mul_f32 v[96:97], v[96:97], v[236:237]
    v_pk_mul_f32 v[98:99], v[98:99], v[238:239]
    v_pk_mul_f32 v[100:101], v[100:101], v[236:237]
    v_pk_mul_f32 v[102:103], v[102:103], v[238:239]
    v_pk_mul_f32 v[104:105], v[104:105], v[236:237]
    v_pk_mul_f32 v[106:107], v[106:107], v[238:239]
    v_pk_mul_f32 v[108:109], v[108:109], v[236:237]
    v_pk_mul_f32 v[110:111], v[110:111], v[238:239]
    v_pk_mul_f32 v[112:113], v[112:113], v[236:237]
    v_pk_mul_f32 v[114:115], v[114:115], v[238:239]
    v_pk_mul_f32 v[116:117], v[116:117], v[236:237]
    v_pk_mul_f32 v[118:119], v[118:119], v[238:239]
    v_pk_mul_f32 v[120:121], v[120:121], v[236:237]
    v_pk_mul_f32 v[122:123], v[122:123], v[238:239]
    v_pk_mul_f32 v[124:125], v[124:125], v[236:237]
    v_pk_mul_f32 v[126:127], v[126:127], v[238:239]
    v_mfma_f32_16x16x32_bf16 v[160:163], a[84:87], a[52:55], v[160:163]
    ds_inc_u32 v248, v248
    v_cvt_pk_bf16_f32 v96, v96, v100
    v_mfma_f32_16x16x32_bf16 v[160:163], a[88:91], a[56:59], v[160:163]
    s_add_u32 s69, s69, 4
    v_exp_f32 v173, v173
    v_cvt_pk_bf16_f32 v100, v97, v101
    v_mfma_f32_16x16x32_bf16 v[160:163], a[92:95], a[60:63], v[160:163]
    ds_write_b32 v244, v243
    v_cvt_pk_bf16_f32 v182, v172, v173
    v_mfma_f32_16x16x32_bf16 v[164:167], a[108:111], a[60:63], v[204:207]
    v_exp_f32 v174, v174
    v_cvt_pk_bf16_f32 v97, v104, v108
    v_mfma_f32_16x16x32_bf16 v[164:167], a[104:107], a[56:59], v[164:167]
    ds_read_b128 v[232:235], v245 offset:128
    ds_write_b64 v246, v[96:97] offset:12288
    v_mfma_f32_16x16x32_bf16 v[164:167], a[100:103], a[52:55], v[164:167]
    v_exp_f32 v175, v175
    v_cvt_pk_bf16_f32 v101, v105, v109
    v_mfma_f32_16x16x32_bf16 v[164:167], a[96:99], a[48:51], v[164:167]
    ds_read_b32 v249, v248
    v_cvt_pk_bf16_f32 v183, v174, v175
    v_mfma_f32_16x16x32_bf16 v[168:171], a[112:115], a[48:51], v[204:207]
    v_exp_f32 v160, v160
    v_mfma_f32_16x16x32_bf16 v[168:171], a[116:119], a[52:55], v[168:171]
    ds_write_b64 v246, v[100:101] offset:12544
    v_mfma_f32_16x16x32_bf16 v[168:171], a[120:123], a[56:59], v[168:171]
    v_exp_f32 v161, v161
    v_cvt_pk_bf16_f32 v98, v98, v102
    v_mfma_f32_16x16x32_bf16 v[168:171], a[124:127], a[60:63], v[168:171]
    v_cvt_pk_bf16_f32 v184, v160, v161
    v_cvt_pk_bf16_f32 v102, v99, v103
    v_cvt_pk_bf16_f32 v99, v106, v110
    v_mfma_f32_16x16x32_bf16 v[172:175], a[140:143], a[60:63], v[204:207]
    s_waitcnt lgkmcnt(3)
    ds_write_b64 v246, v[98:99] offset:12800
    v_exp_f32_e64 v162, v162
    v_cvt_pk_bf16_f32 v103, v107, v111
    v_pk_mul_f32 v[128:129], v[128:129], v[232:233]
    v_pk_mul_f32 v[130:131], v[130:131], v[234:235]
    v_pk_mul_f32 v[132:133], v[132:133], v[232:233]
    v_pk_mul_f32 v[134:135], v[134:135], v[234:235]
    v_pk_mul_f32 v[136:137], v[136:137], v[232:233]
    v_pk_mul_f32 v[138:139], v[138:139], v[234:235]
    v_pk_mul_f32 v[140:141], v[140:141], v[232:233]
    v_pk_mul_f32 v[142:143], v[142:143], v[234:235]
    v_pk_mul_f32 v[144:145], v[144:145], v[232:233]
    v_pk_mul_f32 v[146:147], v[146:147], v[234:235]
    v_pk_mul_f32 v[148:149], v[148:149], v[232:233]
    v_pk_mul_f32 v[150:151], v[150:151], v[234:235]
    v_pk_mul_f32 v[152:153], v[152:153], v[232:233]
    v_pk_mul_f32 v[154:155], v[154:155], v[234:235]
    v_pk_mul_f32 v[156:157], v[156:157], v[232:233]
    v_pk_mul_f32 v[158:159], v[158:159], v[234:235]
    v_mfma_f32_16x16x32_bf16 v[172:175], a[136:139], a[56:59], v[172:175]
    ds_write_b64 v246, v[102:103] offset:13056
    v_mfma_f32_16x16x32_bf16 v[172:175], a[132:135], a[52:55], v[172:175]
    s_waitcnt lgkmcnt(15)
    v_exp_f32_e64 v163, v163
    v_cvt_pk_bf16_f32 v112, v112, v116
    v_mfma_f32_16x16x32_bf16 v[172:175], a[128:131], a[48:51], v[172:175]
    s_waitcnt lgkmcnt(3)
    v_cvt_pk_bf16_f32 v185, v162, v163
    v_cmp_gt_u32 vcc, s69, v249
    v_mfma_f32_16x16x32_bf16 v[208:211], a[80:83], a[64:67], 0
    v_cvt_pk_bf16_f32 v116, v113, v117
    v_cvt_pk_bf16_f32 v113, v120, v124
    v_mfma_f32_16x16x32_bf16 v[208:211], a[84:87], a[68:71], v[208:211]
    ds_write_b64 v246, v[112:113] offset:12416
    v_cvt_pk_bf16_f32 v117, v121, v125
    v_cvt_pk_bf16_f32 v128, v128, v132
    v_mfma_f32_16x16x32_bf16 v[208:211], a[88:91], a[72:75], v[208:211]
    ds_write_b64 v246, v[116:117] offset:12672
    v_cvt_pk_bf16_f32 v132, v129, v133
    v_mfma_f32_16x16x32_bf16 v[208:211], a[92:95], a[76:79], v[208:211]
    v_cvt_pk_bf16_f32 v114, v114, v118
    v_cvt_pk_bf16_f32 v118, v115, v119
    v_cvt_pk_bf16_f32 v115, v122, v126
    v_smfmac_f32_16x16x64_bf16 a[232:235], a[216:219], v[176:183], v226
    ds_write_b64 v246, v[114:115] offset:12928
    v_mfma_f32_16x16x32_bf16 v[64:67], v[176:179], a[144:147], 0
    v_exp_f32_e64 v164, v164
    v_cvt_pk_bf16_f32 v119, v123, v127
    v_mfma_f32_16x16x32_bf16 v[64:67], v[180:183], a[176:179], v[64:67]
    ds_write_b64 v246, v[118:119] offset:13184
    v_mfma_f32_16x16x32_bf16 v[68:71], v[176:179], a[148:151], 0
    s_cbranch_vccnz L_wait_tr_1_a
L_go_tr_1_a:
    v_exp_f32 v165, v165
    v_mfma_f32_16x16x32_bf16 v[68:71], v[180:183], a[180:183], v[68:71]
    s_add_u32 m0, s29, 32768
    v_cvt_pk_bf16_f32 v186, v164, v165
    v_max3_f32 v208, v208, v209, v210
    v_max_f32 v208, v208, v211
    v_mfma_f32_16x16x32_bf16 v[72:75], v[176:179], a[152:155], 0
    v_exp_f32 v166, v166
    v_mov_b32 v209, v208
    v_mfma_f32_16x16x32_bf16 v[72:75], v[180:183], a[184:187], v[72:75]
    buffer_load_dwordx4 v225, s[16:19], s66 offen lds
    v_mfma_f32_16x16x32_bf16 v[76:79], v[176:179], a[156:159], 0
    s_add_u32 s66, s66, 4096
    v_exp_f32 v167, v167
    v_permlane16_swap_b32 v208, v209
    v_mfma_f32_16x16x32_bf16 v[76:79], v[180:183], a[188:191], v[76:79]
    v_cvt_pk_bf16_f32 v187, v166, v167
    v_max_f32 v208, v208, v209
    v_mov_b32 v209, v208
    v_mfma_f32_16x16x32_bf16 v[80:83], v[176:179], a[160:163], 0
    v_exp_f32 v168, v168
    v_mfma_f32_16x16x32_bf16 v[80:83], v[180:183], a[192:195], v[80:83]
    v_permlane32_swap_b32 v208, v209
    v_max_f32 v208, v208, v209
    v_mfma_f32_16x16x32_bf16 v[84:87], v[176:179], a[164:167], 0
    s_add_u32 m0, s29, 36864
    v_exp_f32 v169, v169
    v_sub_f32 v211, s55, v208
    v_mfma_f32_16x16x32_bf16 v[84:87], v[180:183], a[196:199], v[84:87]
    v_cvt_pk_bf16_f32 v188, v168, v169
    v_sub_f32 v210, s55, v208
    v_sub_f32 v209, s55, v208
    v_mfma_f32_16x16x32_bf16 v[88:91], v[176:179], a[168:171], 0
    v_exp_f32 v170, v170
    v_sub_f32 v208, s55, v208
    v_mfma_f32_16x16x32_bf16 v[88:91], v[180:183], a[200:203], v[88:91]
    buffer_load_dwordx4 v225, s[16:19], s66 offen lds
    v_mfma_f32_16x16x32_bf16 v[92:95], v[176:179], a[172:175], 0
    s_add_u32 s66, s66, 4096
    v_exp_f32 v171, v171
    v_cvt_pk_bf16_f32 v129, v136, v140
    v_mfma_f32_16x16x32_bf16 v[92:95], v[180:183], a[204:207], v[92:95]
    ds_write_b64 v246, v[128:129] offset:16384
    v_cvt_pk_bf16_f32 v189, v170, v171
    v_mfma_f32_16x16x32_bf16 v[160:163], a[80:83], a[64:67], v[208:211]
    v_exp_f32 v172, v172
    v_mfma_f32_16x16x32_bf16 v[160:163], a[84:87], a[68:71], v[160:163]
    ds_read_b128 a[80:83], v212 offset:16384
    ds_read_b128 a[84:87], v213 offset:16384
    v_mfma_f32_16x16x32_bf16 v[160:163], a[88:91], a[72:75], v[160:163]
    v_exp_f32 v173, v173
    v_mfma_f32_16x16x32_bf16 v[160:163], a[92:95], a[76:79], v[160:163]
    ds_read_b128 a[88:91], v214 offset:16384
    v_cvt_pk_bf16_f32 v190, v172, v173
    v_mfma_f32_16x16x32_bf16 v[164:167], a[108:111], a[76:79], v[208:211]
    v_exp_f32 v174, v174
    v_mfma_f32_16x16x32_bf16 v[164:167], a[104:107], a[72:75], v[164:167]
    ds_read_b128 a[92:95], v215 offset:16384
    ds_read_b128 a[108:111], v215 offset:20480
    v_mfma_f32_16x16x32_bf16 v[164:167], a[100:103], a[68:71], v[164:167]
    v_exp_f32 v175, v175
    v_mfma_f32_16x16x32_bf16 v[164:167], a[96:99], a[64:67], v[164:167]
    ds_read_b128 a[104:107], v214 offset:20480
    v_cvt_pk_bf16_f32 v191, v174, v175
    v_mfma_f32_16x16x32_bf16 v[168:171], a[112:115], a[64:67], v[208:211]
    v_exp_f32 v160, v160
    v_mfma_f32_16x16x32_bf16 v[168:171], a[116:119], a[68:71], v[168:171]
    ds_read_b128 a[100:103], v213 offset:20480
    ds_read_b128 a[96:99], v212 offset:20480
    v_mfma_f32_16x16x32_bf16 v[168:171], a[120:123], a[72:75], v[168:171]
    v_exp_f32 v161, v161
    v_cvt_pk_bf16_f32 v133, v137, v141
    v_mfma_f32_16x16x32_bf16 v[168:171], a[124:127], a[76:79], v[168:171]
    ds_read_b128 a[112:115], v212 offset:24576
    ds_write_b64 v246, v[132:133] offset:16640
    v_cvt_pk_bf16_f32 v176, v160, v161
    v_mfma_f32_16x16x32_bf16 v[172:175], a[140:143], a[76:79], v[208:211]
    v_exp_f32 v162, v162
    v_mfma_f32_16x16x32_bf16 v[172:175], a[136:139], a[72:75], v[172:175]
    ds_read_b128 a[116:119], v213 offset:24576
    ds_read_b128 a[120:123], v214 offset:24576
    v_mfma_f32_16x16x32_bf16 v[172:175], a[132:135], a[68:71], v[172:175]
    v_exp_f32 v163, v163
    v_mfma_f32_16x16x32_bf16 v[172:175], a[128:131], a[64:67], v[172:175]
    ds_read_b128 a[124:127], v215 offset:24576
    v_cvt_pk_bf16_f32 v177, v162, v163
    v_cvt_pk_bf16_f32 v130, v130, v134
    v_smfmac_f32_16x16x64_bf16 a[232:235], a[220:223], v[184:191], v226
    ds_read_b128 a[140:143], v215 offset:28672
    ds_read_b128 a[136:139], v214 offset:28672
    v_cvt_pk_bf16_f32 v134, v131, v135
    v_cvt_pk_bf16_f32 v131, v138, v142
    v_mfma_f32_16x16x32_bf16 v[96:99], v[184:187], a[144:147], 0
    v_exp_f32 v164, v164
    v_mfma_f32_16x16x32_bf16 v[96:99], v[188:191], a[176:179], v[96:99]
    ds_read_b128 a[132:135], v213 offset:28672
    ds_read_b128 a[128:131], v212 offset:28672
    v_mfma_f32_16x16x32_bf16 v[100:103], v[184:187], a[148:151], 0
    v_exp_f32 v165, v165
    v_mfma_f32_16x16x32_bf16 v[100:103], v[188:191], a[180:183], v[100:103]
    ds_write_b64 v246, v[130:131] offset:16896
    v_cvt_pk_bf16_f32 v178, v164, v165
    v_mfma_f32_16x16x32_bf16 v[104:107], v[184:187], a[152:155], 0
    v_exp_f32 v166, v166
    v_cvt_pk_bf16_f32 v135, v139, v143
    v_mfma_f32_16x16x32_bf16 v[104:107], v[188:191], a[184:187], v[104:107]
    ds_write_b64 v246, v[134:135] offset:17152
    v_mfma_f32_16x16x32_bf16 v[108:111], v[184:187], a[156:159], 0
    s_add_u32 m0, s29, 40960
    v_exp_f32 v167, v167
    v_mfma_f32_16x16x32_bf16 v[108:111], v[188:191], a[188:191], v[108:111]
    v_cvt_pk_bf16_f32 v179, v166, v167
    v_cvt_pk_bf16_f32 v144, v144, v148
    v_mfma_f32_16x16x32_bf16 v[112:115], v[184:187], a[160:163], 0
    v_exp_f32 v168, v168
    v_mfma_f32_16x16x32_bf16 v[112:115], v[188:191], a[192:195], v[112:115]
    buffer_load_dwordx4 v225, s[16:19], s66 offen lds
    v_cvt_pk_bf16_f32 v148, v145, v149
    v_mfma_f32_16x16x32_bf16 v[116:119], v[184:187], a[164:167], 0
    s_add_u32 s66, s66, 4096
    v_exp_f32 v169, v169
    v_cvt_pk_bf16_f32 v145, v152, v156
    v_mfma_f32_16x16x32_bf16 v[116:119], v[188:191], a[196:199], v[116:119]
    ds_write_b64 v246, v[144:145] offset:16512
    v_cvt_pk_bf16_f32 v180, v168, v169
    v_mfma_f32_16x16x32_bf16 v[120:123], v[184:187], a[168:171], 0
    s_waitcnt vmcnt(7) lgkmcnt(3)
    v_exp_f32 v170, v170
    v_mfma_f32_16x16x32_bf16 v[120:123], v[188:191], a[200:203], v[120:123]
    ds_inc_u32 v248, v248
    v_mfma_f32_16x16x32_bf16 v[124:127], v[184:187], a[172:175], 0
    s_add_u32 s69, s69, 4
    v_exp_f32 v171, v171
    v_mfma_f32_16x16x32_bf16 v[124:127], v[188:191], a[204:207], v[124:127]
    v_cvt_pk_bf16_f32 v181, v170, v171
    v_cvt_pk_bf16_f32 v149, v153, v157
    v_mfma_f32_16x16x32_bf16 v[160:163], a[80:83], a[0:3], v[192:195]
    v_exp_f32 v172, v172
    v_mfma_f32_16x16x32_bf16 v[160:163], a[84:87], a[4:7], v[160:163]
    ds_write_b64 v246, v[148:149] offset:16768
    v_mfma_f32_16x16x32_bf16 v[160:163], a[88:91], a[8:11], v[160:163]
    s_add_u32 m0, s29, 45056
    v_exp_f32 v173, v173
    v_mfma_f32_16x16x32_bf16 v[160:163], a[92:95], a[12:15], v[160:163]
    ds_read_b32 v249, v248
    v_cvt_pk_bf16_f32 v182, v172, v173
    v_mfma_f32_16x16x32_bf16 v[164:167], a[108:111], a[12:15], v[192:195]
    v_exp_f32 v174, v174
    v_mfma_f32_16x16x32_bf16 v[164:167], a[104:107], a[8:11], v[164:167]
    buffer_load_dwordx4 v225, s[16:19], s66 offen lds
    v_mfma_f32_16x16x32_bf16 v[164:167], a[100:103], a[4:7], v[164:167]
    s_add_u32 s66, s66, 4096
    v_exp_f32 v175, v175
    v_mfma_f32_16x16x32_bf16 v[164:167], a[96:99], a[0:3], v[164:167]
    v_cvt_pk_bf16_f32 v183, v174, v175
    v_cvt_pk_bf16_f32 v146, v146, v150
    v_cvt_pk_bf16_f32 v150, v147, v151
    v_mfma_f32_16x16x32_bf16 v[168:171], a[112:115], a[0:3], v[192:195]
    v_exp_f32 v160, v160
    v_cvt_pk_bf16_f32 v147, v154, v158
    v_mfma_f32_16x16x32_bf16 v[168:171], a[116:119], a[4:7], v[168:171]
    ds_write_b64 v246, v[146:147] offset:17024
    v_mfma_f32_16x16x32_bf16 v[168:171], a[120:123], a[8:11], v[168:171]
    v_exp_f32 v161, v161
    v_mfma_f32_16x16x32_bf16 v[168:171], a[124:127], a[12:15], v[168:171]
    s_waitcnt lgkmcnt(1)
    v_cvt_pk_bf16_f32 v184, v160, v161
    v_cmp_gt_u32 vcc, s69, v249
    v_mfma_f32_16x16x32_bf16 v[172:175], a[140:143], a[12:15], v[192:195]
    v_exp_f32 v162, v162
    v_cvt_pk_bf16_f32 v151, v155, v159
    v_mfma_f32_16x16x32_bf16 v[172:175], a[136:139], a[8:11], v[172:175]
    ds_write_b64 v246, v[150:151] offset:17280
    v_mfma_f32_16x16x32_bf16 v[172:175], a[132:135], a[4:7], v[172:175]
    s_cbranch_vccnz L_wait_tr_1_b
L_go_tr_1_b:
    v_exp_f32 v163, v163
    v_mfma_f32_16x16x32_bf16 v[172:175], a[128:131], a[0:3], v[172:175]
    v_cvt_pk_bf16_f32 v185, v162, v163
    v_smfmac_f32_16x16x64_bf16 a[232:235], a[224:227], v[176:183], v226
    v_mfma_f32_16x16x32_bf16 v[128:131], v[176:179], a[144:147], 0
    v_exp_f32 v164, v164
    v_mfma_f32_16x16x32_bf16 v[128:131], v[180:183], a[176:179], v[128:131]
    ds_read_b64_tr_b16 a[144:145], v216 offset:49152
    ds_read_b64_tr_b16 a[146:147], v216 offset:53248
    v_mfma_f32_16x16x32_bf16 v[132:135], v[176:179], a[148:151], 0
    v_exp_f32 v165, v165
    v_mfma_f32_16x16x32_bf16 v[132:135], v[180:183], a[180:183], v[132:135]
    ds_read_b64_tr_b16 a[176:177], v216 offset:57344
    v_cvt_pk_bf16_f32 v186, v164, v165
    v_mfma_f32_16x16x32_bf16 v[136:139], v[176:179], a[152:155], 0
    v_exp_f32 v166, v166
    v_mfma_f32_16x16x32_bf16 v[136:139], v[180:183], a[184:187], v[136:139]
    ds_read_b64_tr_b16 a[178:179], v216 offset:61440
    ds_read_b64_tr_b16 a[148:149], v217 offset:49152
    v_mfma_f32_16x16x32_bf16 v[140:143], v[176:179], a[156:159], 0
    v_exp_f32 v167, v167
    v_mfma_f32_16x16x32_bf16 v[140:143], v[180:183], a[188:191], v[140:143]
    ds_read_b64_tr_b16 a[150:151], v217 offset:53248
    v_cvt_pk_bf16_f32 v187, v166, v167
    v_mfma_f32_16x16x32_bf16 v[144:147], v[176:179], a[160:163], 0
    v_exp_f32 v168, v168
    v_mfma_f32_16x16x32_bf16 v[144:147], v[180:183], a[192:195], v[144:147]
    ds_read_b64_tr_b16 a[180:181], v217 offset:57344
    ds_read_b64_tr_b16 a[182:183], v217 offset:61440
    v_mfma_f32_16x16x32_bf16 v[148:151], v[176:179], a[164:167], 0
    v_exp_f32 v169, v169
    v_mfma_f32_16x16x32_bf16 v[148:151], v[180:183], a[196:199], v[148:151]
    ds_read_b64_tr_b16 a[152:153], v218 offset:49152
    v_cvt_pk_bf16_f32 v188, v168, v169
    v_mfma_f32_16x16x32_bf16 v[152:155], v[176:179], a[168:171], 0
    v_exp_f32 v170, v170
    v_mfma_f32_16x16x32_bf16 v[152:155], v[180:183], a[200:203], v[152:155]
    ds_read_b64_tr_b16 a[154:155], v218 offset:53248
    ds_read_b64_tr_b16 a[184:185], v218 offset:57344
    v_mfma_f32_16x16x32_bf16 v[156:159], v[176:179], a[172:175], 0
    v_exp_f32 v171, v171
    v_mfma_f32_16x16x32_bf16 v[156:159], v[180:183], a[204:207], v[156:159]
    ds_read_b64_tr_b16 a[186:187], v218 offset:61440
    v_cvt_pk_bf16_f32 v189, v170, v171
    v_mfma_f32_16x16x32_bf16 v[160:163], a[80:83], a[16:19], v[196:199]
    v_exp_f32 v172, v172
    v_mfma_f32_16x16x32_bf16 v[160:163], a[84:87], a[20:23], v[160:163]
    ds_read_b64_tr_b16 a[156:157], v219 offset:49152
    ds_read_b64_tr_b16 a[158:159], v219 offset:53248
    v_mfma_f32_16x16x32_bf16 v[160:163], a[88:91], a[24:27], v[160:163]
    v_exp_f32 v173, v173
    v_mfma_f32_16x16x32_bf16 v[160:163], a[92:95], a[28:31], v[160:163]
    ds_read_b64_tr_b16 a[188:189], v219 offset:57344
    v_cvt_pk_bf16_f32 v190, v172, v173
    v_mfma_f32_16x16x32_bf16 v[164:167], a[108:111], a[28:31], v[196:199]
    v_exp_f32 v174, v174
    v_mfma_f32_16x16x32_bf16 v[164:167], a[104:107], a[24:27], v[164:167]
    ds_read_b64_tr_b16 a[190:191], v219 offset:61440
    ds_read_b64_tr_b16 a[160:161], v220 offset:49152
    v_mfma_f32_16x16x32_bf16 v[164:167], a[100:103], a[20:23], v[164:167]
    v_exp_f32 v175, v175
    v_mfma_f32_16x16x32_bf16 v[164:167], a[96:99], a[16:19], v[164:167]
    ds_read_b64_tr_b16 a[162:163], v220 offset:53248
    v_cvt_pk_bf16_f32 v191, v174, v175
    v_mfma_f32_16x16x32_bf16 v[168:171], a[112:115], a[16:19], v[196:199]
    v_exp_f32 v160, v160
    v_mfma_f32_16x16x32_bf16 v[168:171], a[116:119], a[20:23], v[168:171]
    ds_read_b64_tr_b16 a[192:193], v220 offset:57344
    ds_read_b64_tr_b16 a[194:195], v220 offset:61440
    v_mfma_f32_16x16x32_bf16 v[168:171], a[120:123], a[24:27], v[168:171]
    v_exp_f32 v161, v161
    v_mfma_f32_16x16x32_bf16 v[168:171], a[124:127], a[28:31], v[168:171]
    ds_read_b64_tr_b16 a[164:165], v221 offset:49152
    v_cvt_pk_bf16_f32 v176, v160, v161
    v_mfma_f32_16x16x32_bf16 v[172:175], a[140:143], a[28:31], v[196:199]
    v_exp_f32 v162, v162
    v_mfma_f32_16x16x32_bf16 v[172:175], a[136:139], a[24:27], v[172:175]
    ds_read_b64_tr_b16 a[166:167], v221 offset:53248
    ds_read_b64_tr_b16 a[196:197], v221 offset:57344
    v_mfma_f32_16x16x32_bf16 v[172:175], a[132:135], a[20:23], v[172:175]
    v_exp_f32 v163, v163
    v_mfma_f32_16x16x32_bf16 v[172:175], a[128:131], a[16:19], v[172:175]
    s_waitcnt lgkmcnt(7)
    ds_read_b64_tr_b16 a[198:199], v221 offset:61440
    v_cvt_pk_bf16_f32 v177, v162, v163
    v_smfmac_f32_16x16x64_bf16 a[232:235], a[208:211], v[184:191], v226
    ds_read_b64_tr_b16 a[168:169], v222 offset:49152
    ds_read_b64_tr_b16 a[170:171], v222 offset:53248
    v_mfma_f32_16x16x32_bf16 v[0:3], v[184:187], a[144:147], v[0:3]
    s_mov_b32 s31, -1024
    v_exp_f32 v164, v164
    v_mfma_f32_16x16x32_bf16 v[0:3], v[188:191], a[176:179], v[0:3]
    s_mov_b32 s30, 6
    ds_read_b64_tr_b16 a[200:201], v222 offset:57344
    ds_read_b64_tr_b16 a[202:203], v222 offset:61440
    v_mfma_f32_16x16x32_bf16 v[4:7], v[184:187], a[148:151], v[4:7]
    v_exp_f32 v165, v165
    v_mfma_f32_16x16x32_bf16 v[4:7], v[188:191], a[180:183], v[4:7]
    ds_read_b64_tr_b16 a[172:173], v223 offset:49152
    v_cvt_pk_bf16_f32 v178, v164, v165
    v_mfma_f32_16x16x32_bf16 v[8:11], v[184:187], a[152:155], v[8:11]
    v_exp_f32 v166, v166
    v_mfma_f32_16x16x32_bf16 v[8:11], v[188:191], a[184:187], v[8:11]
    ds_read_b64_tr_b16 a[174:175], v223 offset:53248
    ds_read_b64_tr_b16 a[204:205], v223 offset:57344
    v_mfma_f32_16x16x32_bf16 v[12:15], v[184:187], a[156:159], v[12:15]
    s_add_u32 m0, s29, 16384
    v_exp_f32 v167, v167
    v_mfma_f32_16x16x32_bf16 v[12:15], v[188:191], a[188:191], v[12:15]
    s_waitcnt lgkmcnt(7)
    ds_read_b64_tr_b16 a[206:207], v223 offset:61440
    v_cvt_pk_bf16_f32 v179, v166, v167
    v_mfma_f32_16x16x32_bf16 v[16:19], v[184:187], a[160:163], v[16:19]
    v_exp_f32 v168, v168
    v_mfma_f32_16x16x32_bf16 v[16:19], v[188:191], a[192:195], v[16:19]
    buffer_load_dwordx4 v224, s[12:15], s28 offen lds
    v_mfma_f32_16x16x32_bf16 v[20:23], v[184:187], a[164:167], v[20:23]
    s_add_u32 s28, s28, 4096
    v_exp_f32 v169, v169
    v_mfma_f32_16x16x32_bf16 v[20:23], v[188:191], a[196:199], v[20:23]
    s_waitcnt lgkmcnt(4)
    v_cvt_pk_bf16_f32 v180, v168, v169
    v_mfma_f32_16x16x32_bf16 v[24:27], v[184:187], a[168:171], v[24:27]
    v_exp_f32 v170, v170
    v_mfma_f32_16x16x32_bf16 v[24:27], v[188:191], a[200:203], v[24:27]
    s_waitcnt lgkmcnt(0)
    v_mfma_f32_16x16x32_bf16 v[28:31], v[184:187], a[172:175], v[28:31]
    s_add_u32 m0, s29, 20480
    v_exp_f32 v171, v171
    v_mfma_f32_16x16x32_bf16 v[28:31], v[188:191], a[204:207], v[28:31]
    v_cvt_pk_bf16_f32 v181, v170, v171
    v_mfma_f32_16x16x32_bf16 v[160:163], a[80:83], a[32:35], v[200:203]
    v_exp_f32 v172, v172
    v_mfma_f32_16x16x32_bf16 v[160:163], a[84:87], a[36:39], v[160:163]
    buffer_load_dwordx4 v224, s[12:15], s28 offen lds
    v_mfma_f32_16x16x32_bf16 v[160:163], a[88:91], a[40:43], v[160:163]
    s_add_u32 s28, s28, 4096
    v_exp_f32 v173, v173
    v_mfma_f32_16x16x32_bf16 v[160:163], a[92:95], a[44:47], v[160:163]
    v_cvt_pk_bf16_f32 v182, v172, v173
    v_mfma_f32_16x16x32_bf16 v[164:167], a[108:111], a[44:47], v[200:203]
    v_exp_f32 v174, v174
    v_mfma_f32_16x16x32_bf16 v[164:167], a[104:107], a[40:43], v[164:167]
    v_mfma_f32_16x16x32_bf16 v[164:167], a[100:103], a[36:39], v[164:167]
    s_add_u32 m0, s29, 24576
    v_exp_f32 v175, v175
    v_mfma_f32_16x16x32_bf16 v[164:167], a[96:99], a[32:35], v[164:167]
    v_cvt_pk_bf16_f32 v183, v174, v175
    v_mfma_f32_16x16x32_bf16 v[168:171], a[112:115], a[32:35], v[200:203]
    v_exp_f32 v160, v160
    v_mfma_f32_16x16x32_bf16 v[168:171], a[116:119], a[36:39], v[168:171]
    buffer_load_dwordx4 v224, s[12:15], s28 offen lds
    v_mfma_f32_16x16x32_bf16 v[168:171], a[120:123], a[40:43], v[168:171]
    s_add_u32 s28, s28, 4096
    v_exp_f32 v161, v161
    v_mfma_f32_16x16x32_bf16 v[168:171], a[124:127], a[44:47], v[168:171]
    v_cvt_pk_bf16_f32 v184, v160, v161
    v_add_f32 v250, v250, v227
    v_mfma_f32_16x16x32_bf16 v[172:175], a[140:143], a[44:47], v[200:203]
    v_exp_f32 v162, v162
    v_mfma_f32_16x16x32_bf16 v[172:175], a[136:139], a[40:43], v[172:175]
    v_fmac_f32 v250, 0x53800000, v228
    v_cmp_ngt_f32 s[46:47], s76, v250
    v_mfma_f32_16x16x32_bf16 v[172:175], a[132:135], a[36:39], v[172:175]
    s_add_u32 m0, s29, 28672
    v_exp_f32 v163, v163
    v_mfma_f32_16x16x32_bf16 v[172:175], a[128:131], a[32:35], v[172:175]
    s_cmp_lg_u64 s[46:47], 0
    s_cselect_b32 s46, 1, 0
    v_cvt_pk_bf16_f32 v185, v162, v163
    v_smfmac_f32_16x16x64_bf16 a[232:235], a[212:215], v[176:183], v226
    s_or_b32 s34, s34, s46
    v_mfma_f32_16x16x32_bf16 v[32:35], v[176:179], a[144:147], v[32:35]
    v_exp_f32 v164, v164
    v_mfma_f32_16x16x32_bf16 v[32:35], v[180:183], a[176:179], v[32:35]
    buffer_load_dwordx4 v224, s[12:15], s28 offen lds
    v_mfma_f32_16x16x32_bf16 v[36:39], v[176:179], a[148:151], v[36:39]
    s_add_u32 s28, s28, 4096
    v_exp_f32 v165, v165
    v_mfma_f32_16x16x32_bf16 v[36:39], v[180:183], a[180:183], v[36:39]
    v_cvt_pk_bf16_f32 v186, v164, v165
    v_mfma_f32_16x16x32_bf16 v[40:43], v[176:179], a[152:155], v[40:43]
    v_exp_f32 v166, v166
    v_mfma_f32_16x16x32_bf16 v[40:43], v[180:183], a[184:187], v[40:43]
    v_mfma_f32_16x16x32_bf16 v[44:47], v[176:179], a[156:159], v[44:47]
    v_exp_f32 v167, v167
    v_mfma_f32_16x16x32_bf16 v[44:47], v[180:183], a[188:191], v[44:47]
    v_cvt_pk_bf16_f32 v187, v166, v167
    v_mfma_f32_16x16x32_bf16 v[48:51], v[176:179], a[160:163], v[48:51]
    v_exp_f32 v168, v168
    v_mfma_f32_16x16x32_bf16 v[48:51], v[180:183], a[192:195], v[48:51]
    v_mfma_f32_16x16x32_bf16 v[52:55], v[176:179], a[164:167], v[52:55]
    v_exp_f32 v169, v169
    v_mfma_f32_16x16x32_bf16 v[52:55], v[180:183], a[196:199], v[52:55]
    v_cvt_pk_bf16_f32 v188, v168, v169
    v_mfma_f32_16x16x32_bf16 v[56:59], v[176:179], a[168:171], v[56:59]
    v_exp_f32 v170, v170
    v_mfma_f32_16x16x32_bf16 v[56:59], v[180:183], a[200:203], v[56:59]
    v_mfma_f32_16x16x32_bf16 v[60:63], v[176:179], a[172:175], v[60:63]
    v_exp_f32 v171, v171
    v_mfma_f32_16x16x32_bf16 v[60:63], v[180:183], a[204:207], v[60:63]
L_B:
    v_mfma_f32_16x16x32_bf16 v[160:163], a[80:83], a[48:51], v[204:207]
    s_waitcnt vmcnt(8)
    v_exp_f32 v172, v172
    v_mfma_f32_16x16x32_bf16 v[160:163], a[84:87], a[52:55], v[160:163]
    ds_inc_u32 v248, v248
    v_mfma_f32_16x16x32_bf16 v[160:163], a[88:91], a[56:59], v[160:163]
    s_add_u32 s69, s69, 4
    v_exp_f32 v173, v173
    v_mfma_f32_16x16x32_bf16 v[160:163], a[92:95], a[60:63], v[160:163]
    v_cvt_pk_bf16_f32 v189, v170, v171
    v_cvt_pk_bf16_f32 v190, v172, v173
    v_mfma_f32_16x16x32_bf16 v[164:167], a[108:111], a[60:63], v[204:207]
    v_exp_f32 v174, v174
    v_mfma_f32_16x16x32_bf16 v[164:167], a[104:107], a[56:59], v[164:167]
    v_mfma_f32_16x16x32_bf16 v[164:167], a[100:103], a[52:55], v[164:167]
    v_exp_f32 v175, v175
    v_mfma_f32_16x16x32_bf16 v[164:167], a[96:99], a[48:51], v[164:167]
    ds_read_b32 v249, v248
    v_cvt_pk_bf16_f32 v191, v174, v175
    v_mfma_f32_16x16x32_bf16 v[168:171], a[112:115], a[48:51], v[204:207]
    v_exp_f32 v160, v160
    v_mfma_f32_16x16x32_bf16 v[168:171], a[116:119], a[52:55], v[168:171]
    v_mfma_f32_16x16x32_bf16 v[168:171], a[120:123], a[56:59], v[168:171]
    v_exp_f32 v161, v161
    v_mfma_f32_16x16x32_bf16 v[168:171], a[124:127], a[60:63], v[168:171]
    v_cvt_pk_bf16_f32 v176, v160, v161
    v_mfma_f32_16x16x32_bf16 v[172:175], a[140:143], a[60:63], v[204:207]
    v_exp_f32 v162, v162
    v_mfma_f32_16x16x32_bf16 v[172:175], a[136:139], a[56:59], v[172:175]
    global_load_dword a255, v252, s[58:59]
    v_mfma_f32_16x16x32_bf16 v[172:175], a[132:135], a[52:55], v[172:175]
    v_exp_f32_e64 v163, v163
    v_mfma_f32_16x16x32_bf16 v[172:175], a[128:131], a[48:51], v[172:175]
    s_waitcnt lgkmcnt(0)
    v_cvt_pk_bf16_f32 v177, v162, v163
    v_cmp_gt_u32 vcc, s69, v249
    v_smfmac_f32_16x16x64_bf16 a[232:235], a[216:219], v[184:191], v226
    v_mfma_f32_16x16x32_bf16 v[64:67], v[184:187], a[144:147], v[64:67]
    v_exp_f32_e64 v164, v164
    v_mfma_f32_16x16x32_bf16 v[64:67], v[188:191], a[176:179], v[64:67]
    v_mfma_f32_16x16x32_bf16 v[68:71], v[184:187], a[148:151], v[68:71]
    s_cbranch_vccnz L_wait_B_0_a
L_go_B_0_a:
    v_exp_f32 v165, v165
    v_mfma_f32_16x16x32_bf16 v[68:71], v[188:191], a[180:183], v[68:71]
    s_add_u32 m0, s29, 49152
    v_cvt_pk_bf16_f32 v178, v164, v165
    v_mfma_f32_16x16x32_bf16 v[72:75], v[184:187], a[152:155], v[72:75]
    v_exp_f32 v166, v166
    v_mfma_f32_16x16x32_bf16 v[72:75], v[188:191], a[184:187], v[72:75]
    buffer_load_dwordx4 v225, s[16:19], s66 offen lds
    v_mfma_f32_16x16x32_bf16 v[76:79], v[184:187], a[156:159], v[76:79]
    s_add_u32 s66, s66, 4096
    v_exp_f32 v167, v167
    v_mfma_f32_16x16x32_bf16 v[76:79], v[188:191], a[188:191], v[76:79]
    v_cvt_pk_bf16_f32 v179, v166, v167
    v_mfma_f32_16x16x32_bf16 v[80:83], v[184:187], a[160:163], v[80:83]
    v_exp_f32 v168, v168
    v_mfma_f32_16x16x32_bf16 v[80:83], v[188:191], a[192:195], v[80:83]
    v_mfma_f32_16x16x32_bf16 v[84:87], v[184:187], a[164:167], v[84:87]
    s_add_u32 m0, s29, 53248
    v_exp_f32 v169, v169
    v_mfma_f32_16x16x32_bf16 v[84:87], v[188:191], a[196:199], v[84:87]
    v_cvt_pk_bf16_f32 v180, v168, v169
    v_mfma_f32_16x16x32_bf16 v[88:91], v[184:187], a[168:171], v[88:91]
    v_exp_f32 v170, v170
    v_mfma_f32_16x16x32_bf16 v[88:91], v[188:191], a[200:203], v[88:91]
    buffer_load_dwordx4 v225, s[16:19], s66 offen lds
    v_mfma_f32_16x16x32_bf16 v[92:95], v[184:187], a[172:175], v[92:95]
    s_add_u32 s66, s66, 4096
    v_exp_f32 v171, v171
    v_mfma_f32_16x16x32_bf16 v[92:95], v[188:191], a[204:207], v[92:95]
    v_cvt_pk_bf16_f32 v181, v170, v171
    v_mfma_f32_16x16x32_bf16 v[160:163], a[80:83], a[64:67], v[208:211]
L_page4:
    s_cbranch_execz L_warm
    v_exp_f32 v172, v172
    v_mfma_f32_16x16x32_bf16 v[160:163], a[84:87], a[68:71], v[160:163]
    ds_read_b128 a[80:83], v212 offset:0
    ds_read_b128 a[84:87], v213 offset:0
    v_mfma_f32_16x16x32_bf16 v[160:163], a[88:91], a[72:75], v[160:163]
    v_exp_f32 v173, v173
    v_mfma_f32_16x16x32_bf16 v[160:163], a[92:95], a[76:79], v[160:163]
    ds_read_b128 a[88:91], v214 offset:0
    v_cvt_pk_bf16_f32 v182, v172, v173
    v_mfma_f32_16x16x32_bf16 v[164:167], a[108:111], a[76:79], v[208:211]
    v_exp_f32 v174, v174
    v_mfma_f32_16x16x32_bf16 v[164:167], a[104:107], a[72:75], v[164:167]
    ds_read_b128 a[92:95], v215 offset:0
    ds_read_b128 a[108:111], v215 offset:4096
    v_mfma_f32_16x16x32_bf16 v[164:167], a[100:103], a[68:71], v[164:167]
    v_exp_f32 v175, v175
    v_mfma_f32_16x16x32_bf16 v[164:167], a[96:99], a[64:67], v[164:167]
    ds_read_b128 a[104:107], v214 offset:4096
    v_cvt_pk_bf16_f32 v183, v174, v175
    v_mfma_f32_16x16x32_bf16 v[168:171], a[112:115], a[64:67], v[208:211]
    v_exp_f32 v160, v160
    v_mfma_f32_16x16x32_bf16 v[168:171], a[116:119], a[68:71], v[168:171]
    ds_read_b128 a[100:103], v213 offset:4096
    ds_read_b128 a[96:99], v212 offset:4096
    v_mfma_f32_16x16x32_bf16 v[168:171], a[120:123], a[72:75], v[168:171]
    v_exp_f32 v161, v161
    v_mfma_f32_16x16x32_bf16 v[168:171], a[124:127], a[76:79], v[168:171]
    ds_read_b128 a[112:115], v212 offset:8192
    v_cvt_pk_bf16_f32 v184, v160, v161
    v_mfma_f32_16x16x32_bf16 v[172:175], a[140:143], a[76:79], v[208:211]
    v_exp_f32 v162, v162
    v_mfma_f32_16x16x32_bf16 v[172:175], a[136:139], a[72:75], v[172:175]
    ds_read_b128 a[116:119], v213 offset:8192
    ds_read_b128 a[120:123], v214 offset:8192
    v_mfma_f32_16x16x32_bf16 v[172:175], a[132:135], a[68:71], v[172:175]
    v_exp_f32 v163, v163
    v_mfma_f32_16x16x32_bf16 v[172:175], a[128:131], a[64:67], v[172:175]
    ds_read_b128 a[124:127], v215 offset:8192
    v_cvt_pk_bf16_f32 v185, v162, v163
    v_smfmac_f32_16x16x64_bf16 a[232:235], a[220:223], v[176:183], v226
    ds_read_b128 a[140:143], v215 offset:12288
    ds_read_b128 a[136:139], v214 offset:12288
    v_mfma_f32_16x16x32_bf16 v[96:99], v[176:179], a[144:147], v[96:99]
    v_exp_f32 v164, v164
    v_mfma_f32_16x16x32_bf16 v[96:99], v[180:183], a[176:179], v[96:99]
    ds_read_b128 a[132:135], v213 offset:12288
    ds_read_b128 a[128:131], v212 offset:12288
    v_mfma_f32_16x16x32_bf16 v[100:103], v[176:179], a[148:151], v[100:103]
    v_exp_f32 v165, v165
    v_mfma_f32_16x16x32_bf16 v[100:103], v[180:183], a[180:183], v[100:103]
    v_cvt_pk_bf16_f32 v186, v164, v165
    v_mfma_f32_16x16x32_bf16 v[104:107], v[176:179], a[152:155], v[104:107]
    v_exp_f32 v166, v166
    v_mfma_f32_16x16x32_bf16 v[104:107], v[180:183], a[184:187], v[104:107]
    v_mfma_f32_16x16x32_bf16 v[108:111], v[176:179], a[156:159], v[108:111]
    s_add_u32 m0, s29, 57344
    v_exp_f32 v167, v167
    v_mfma_f32_16x16x32_bf16 v[108:111], v[180:183], a[188:191], v[108:111]
    v_cvt_pk_bf16_f32 v187, v166, v167
    v_mfma_f32_16x16x32_bf16 v[112:115], v[176:179], a[160:163], v[112:115]
    v_exp_f32 v168, v168
    v_mfma_f32_16x16x32_bf16 v[112:115], v[180:183], a[192:195], v[112:115]
    buffer_load_dwordx4 v225, s[16:19], s66 offen lds
    v_mfma_f32_16x16x32_bf16 v[116:119], v[176:179], a[164:167], v[116:119]
    s_add_u32 s66, s66, 4096
    v_exp_f32 v169, v169
    v_mfma_f32_16x16x32_bf16 v[116:119], v[180:183], a[196:199], v[116:119]
    v_cvt_pk_bf16_f32 v188, v168, v169
    v_mfma_f32_16x16x32_bf16 v[120:123], v[176:179], a[168:171], v[120:123]
    s_waitcnt vmcnt(8) lgkmcnt(0)
    v_exp_f32 v170, v170
    v_mfma_f32_16x16x32_bf16 v[120:123], v[180:183], a[200:203], v[120:123]
    ds_inc_u32 v248, v248
    v_mfma_f32_16x16x32_bf16 v[124:127], v[176:179], a[172:175], v[124:127]
    s_add_u32 s69, s69, 4
    v_exp_f32 v171, v171
    v_mfma_f32_16x16x32_bf16 v[124:127], v[180:183], a[204:207], v[124:127]
    v_cvt_pk_bf16_f32 v189, v170, v171
    v_mfma_f32_16x16x32_bf16 v[160:163], a[80:83], a[0:3], v[192:195]
    v_exp_f32 v172, v172
    v_mfma_f32_16x16x32_bf16 v[160:163], a[84:87], a[4:7], v[160:163]
    v_mfma_f32_16x16x32_bf16 v[160:163], a[88:91], a[8:11], v[160:163]
    s_add_u32 m0, s29, 61440
    v_exp_f32 v173, v173
    v_mfma_f32_16x16x32_bf16 v[160:163], a[92:95], a[12:15], v[160:163]
    ds_read_b32 v249, v248
    v_cvt_pk_bf16_f32 v190, v172, v173
    v_mfma_f32_16x16x32_bf16 v[164:167], a[108:111], a[12:15], v[192:195]
    v_exp_f32 v174, v174
    v_mfma_f32_16x16x32_bf16 v[164:167], a[104:107], a[8:11], v[164:167]
    buffer_load_dwordx4 v225, s[16:19], s66 offen lds
    v_mfma_f32_16x16x32_bf16 v[164:167], a[100:103], a[4:7], v[164:167]
    s_add_u32 s66, s66, 4096
    v_exp_f32 v175, v175
    v_mfma_f32_16x16x32_bf16 v[164:167], a[96:99], a[0:3], v[164:167]
    v_cvt_pk_bf16_f32 v191, v174, v175
    v_mfma_f32_16x16x32_bf16 v[168:171], a[112:115], a[0:3], v[192:195]
    v_exp_f32 v160, v160
    v_mfma_f32_16x16x32_bf16 v[168:171], a[116:119], a[4:7], v[168:171]
    v_mfma_f32_16x16x32_bf16 v[168:171], a[120:123], a[8:11], v[168:171]
    v_exp_f32 v161, v161
    v_mfma_f32_16x16x32_bf16 v[168:171], a[124:127], a[12:15], v[168:171]
    s_waitcnt lgkmcnt(0)
    v_cvt_pk_bf16_f32 v176, v160, v161
    v_cmp_gt_u32 vcc, s69, v249
    v_mfma_f32_16x16x32_bf16 v[172:175], a[140:143], a[12:15], v[192:195]
    v_exp_f32 v162, v162
    v_mfma_f32_16x16x32_bf16 v[172:175], a[136:139], a[8:11], v[172:175]
    v_mfma_f32_16x16x32_bf16 v[172:175], a[132:135], a[4:7], v[172:175]
    s_cbranch_vccnz L_wait_B_0_b
L_go_B_0_b:
    v_exp_f32 v163, v163
    v_mfma_f32_16x16x32_bf16 v[172:175], a[128:131], a[0:3], v[172:175]
    v_cvt_pk_bf16_f32 v177, v162, v163
    v_smfmac_f32_16x16x64_bf16 a[232:235], a[224:227], v[184:191], v226
    v_mfma_f32_16x16x32_bf16 v[128:131], v[184:187], a[144:147], v[128:131]
    v_exp_f32 v164, v164
    v_mfma_f32_16x16x32_bf16 v[128:131], v[188:191], a[176:179], v[128:131]
    ds_read_b64_tr_b16 a[144:145], v216 offset:32768
    ds_read_b64_tr_b16 a[146:147], v216 offset:36864
    v_mfma_f32_16x16x32_bf16 v[132:135], v[184:187], a[148:151], v[132:135]
    v_exp_f32 v165, v165
    v_mfma_f32_16x16x32_bf16 v[132:135], v[188:191], a[180:183], v[132:135]
    ds_read_b64_tr_b16 a[176:177], v216 offset:40960
    v_cvt_pk_bf16_f32 v178, v164, v165
    v_mfma_f32_16x16x32_bf16 v[136:139], v[184:187], a[152:155], v[136:139]
    v_exp_f32 v166, v166
    v_mfma_f32_16x16x32_bf16 v[136:139], v[188:191], a[184:187], v[136:139]
    ds_read_b64_tr_b16 a[178:179], v216 offset:45056
    ds_read_b64_tr_b16 a[148:149], v217 offset:32768
    v_mfma_f32_16x16x32_bf16 v[140:143], v[184:187], a[156:159], v[140:143]
    v_exp_f32 v167, v167
    v_mfma_f32_16x16x32_bf16 v[140:143], v[188:191], a[188:191], v[140:143]
    ds_read_b64_tr_b16 a[150:151], v217 offset:36864
    v_cvt_pk_bf16_f32 v179, v166, v167
    v_mfma_f32_16x16x32_bf16 v[144:147], v[184:187], a[160:163], v[144:147]
    v_exp_f32 v168, v168
    v_mfma_f32_16x16x32_bf16 v[144:147], v[188:191], a[192:195], v[144:147]
    ds_read_b64_tr_b16 a[180:181], v217 offset:40960
    ds_read_b64_tr_b16 a[182:183], v217 offset:45056
    v_mfma_f32_16x16x32_bf16 v[148:151], v[184:187], a[164:167], v[148:151]
    v_exp_f32 v169, v169
    v_mfma_f32_16x16x32_bf16 v[148:151], v[188:191], a[196:199], v[148:151]
    ds_read_b64_tr_b16 a[152:153], v218 offset:32768
    v_cvt_pk_bf16_f32 v180, v168, v169
    v_mfma_f32_16x16x32_bf16 v[152:155], v[184:187], a[168:171], v[152:155]
    v_exp_f32 v170, v170
    v_mfma_f32_16x16x32_bf16 v[152:155], v[188:191], a[200:203], v[152:155]
    ds_read_b64_tr_b16 a[154:155], v218 offset:36864
    ds_read_b64_tr_b16 a[184:185], v218 offset:40960
    v_mfma_f32_16x16x32_bf16 v[156:159], v[184:187], a[172:175], v[156:159]
    v_exp_f32 v171, v171
    v_mfma_f32_16x16x32_bf16 v[156:159], v[188:191], a[204:207], v[156:159]
    ds_read_b64_tr_b16 a[186:187], v218 offset:45056
    v_cvt_pk_bf16_f32 v181, v170, v171
    v_mfma_f32_16x16x32_bf16 v[160:163], a[80:83], a[16:19], v[196:199]
    v_exp_f32 v172, v172
    v_mfma_f32_16x16x32_bf16 v[160:163], a[84:87], a[20:23], v[160:163]
    ds_read_b64_tr_b16 a[156:157], v219 offset:32768
    ds_read_b64_tr_b16 a[158:159], v219 offset:36864
    v_mfma_f32_16x16x32_bf16 v[160:163], a[88:91], a[24:27], v[160:163]
    v_exp_f32 v173, v173
    v_mfma_f32_16x16x32_bf16 v[160:163], a[92:95], a[28:31], v[160:163]
    ds_read_b64_tr_b16 a[188:189], v219 offset:40960
    v_cvt_pk_bf16_f32 v182, v172, v173
    v_mfma_f32_16x16x32_bf16 v[164:167], a[108:111], a[28:31], v[196:199]
    v_exp_f32 v174, v174
    v_mfma_f32_16x16x32_bf16 v[164:167], a[104:107], a[24:27], v[164:167]
    ds_read_b64_tr_b16 a[190:191], v219 offset:45056
    ds_read_b64_tr_b16 a[160:161], v220 offset:32768
    v_mfma_f32_16x16x32_bf16 v[164:167], a[100:103], a[20:23], v[164:167]
    v_exp_f32 v175, v175
    v_mfma_f32_16x16x32_bf16 v[164:167], a[96:99], a[16:19], v[164:167]
    ds_read_b64_tr_b16 a[162:163], v220 offset:36864
    v_cvt_pk_bf16_f32 v183, v174, v175
    v_mfma_f32_16x16x32_bf16 v[168:171], a[112:115], a[16:19], v[196:199]
    v_exp_f32 v160, v160
    v_mfma_f32_16x16x32_bf16 v[168:171], a[116:119], a[20:23], v[168:171]
    ds_read_b64_tr_b16 a[192:193], v220 offset:40960
    ds_read_b64_tr_b16 a[194:195], v220 offset:45056
    v_mfma_f32_16x16x32_bf16 v[168:171], a[120:123], a[24:27], v[168:171]
    v_exp_f32 v161, v161
    v_mfma_f32_16x16x32_bf16 v[168:171], a[124:127], a[28:31], v[168:171]
    ds_read_b64_tr_b16 a[164:165], v221 offset:32768
    v_cvt_pk_bf16_f32 v184, v160, v161
    v_mfma_f32_16x16x32_bf16 v[172:175], a[140:143], a[28:31], v[196:199]
    v_exp_f32 v162, v162
    v_mfma_f32_16x16x32_bf16 v[172:175], a[136:139], a[24:27], v[172:175]
    ds_read_b64_tr_b16 a[166:167], v221 offset:36864
    ds_read_b64_tr_b16 a[196:197], v221 offset:40960
    v_mfma_f32_16x16x32_bf16 v[172:175], a[132:135], a[20:23], v[172:175]
    v_exp_f32 v163, v163
    v_mfma_f32_16x16x32_bf16 v[172:175], a[128:131], a[16:19], v[172:175]
    s_waitcnt lgkmcnt(7)
    ds_read_b64_tr_b16 a[198:199], v221 offset:45056
    v_cvt_pk_bf16_f32 v185, v162, v163
    v_smfmac_f32_16x16x64_bf16 a[232:235], a[208:211], v[176:183], v226
    ds_read_b64_tr_b16 a[168:169], v222 offset:32768
    ds_read_b64_tr_b16 a[170:171], v222 offset:36864
    v_mfma_f32_16x16x32_bf16 v[0:3], v[176:179], a[144:147], v[0:3]
    v_exp_f32 v164, v164
    v_mfma_f32_16x16x32_bf16 v[0:3], v[180:183], a[176:179], v[0:3]
    ds_read_b64_tr_b16 a[200:201], v222 offset:40960
    ds_read_b64_tr_b16 a[202:203], v222 offset:45056
    v_mfma_f32_16x16x32_bf16 v[4:7], v[176:179], a[148:151], v[4:7]
    v_exp_f32 v165, v165
    v_mfma_f32_16x16x32_bf16 v[4:7], v[180:183], a[180:183], v[4:7]
    ds_read_b64_tr_b16 a[172:173], v223 offset:32768
    v_cvt_pk_bf16_f32 v186, v164, v165
    v_mfma_f32_16x16x32_bf16 v[8:11], v[176:179], a[152:155], v[8:11]
    v_exp_f32 v166, v166
    v_mfma_f32_16x16x32_bf16 v[8:11], v[180:183], a[184:187], v[8:11]
    ds_read_b64_tr_b16 a[174:175], v223 offset:36864
    ds_read_b64_tr_b16 a[204:205], v223 offset:40960
    v_mfma_f32_16x16x32_bf16 v[12:15], v[176:179], a[156:159], v[12:15]
    s_add_u32 m0, s29, 0
    v_exp_f32 v167, v167
    v_mfma_f32_16x16x32_bf16 v[12:15], v[180:183], a[188:191], v[12:15]
    s_waitcnt lgkmcnt(7)
    ds_read_b64_tr_b16 a[206:207], v223 offset:45056
    v_cvt_pk_bf16_f32 v187, v166, v167
    v_mfma_f32_16x16x32_bf16 v[16:19], v[176:179], a[160:163], v[16:19]
    v_exp_f32 v168, v168
    v_mfma_f32_16x16x32_bf16 v[16:19], v[180:183], a[192:195], v[16:19]
    buffer_load_dwordx4 v224, s[12:15], s28 offen lds
    v_mfma_f32_16x16x32_bf16 v[20:23], v[176:179], a[164:167], v[20:23]
    s_add_u32 s28, s28, 4096
    v_exp_f32 v169, v169
    v_mfma_f32_16x16x32_bf16 v[20:23], v[180:183], a[196:199], v[20:23]
    s_waitcnt lgkmcnt(4)
    v_cvt_pk_bf16_f32 v188, v168, v169
    v_mfma_f32_16x16x32_bf16 v[24:27], v[176:179], a[168:171], v[24:27]
    v_exp_f32 v170, v170
    v_mfma_f32_16x16x32_bf16 v[24:27], v[180:183], a[200:203], v[24:27]
    s_waitcnt lgkmcnt(0)
    v_mfma_f32_16x16x32_bf16 v[28:31], v[176:179], a[172:175], v[28:31]
    s_add_u32 m0, s29, 4096
    v_exp_f32 v171, v171
    v_mfma_f32_16x16x32_bf16 v[28:31], v[180:183], a[204:207], v[28:31]
    v_cvt_pk_bf16_f32 v189, v170, v171
    v_mfma_f32_16x16x32_bf16 v[160:163], a[80:83], a[32:35], v[200:203]
    s_add_u32 s31, s31, 1024
    v_exp_f32 v172, v172
    v_mfma_f32_16x16x32_bf16 v[160:163], a[84:87], a[36:39], v[160:163]
    buffer_load_dwordx4 v224, s[12:15], s28 offen lds
    v_mfma_f32_16x16x32_bf16 v[160:163], a[88:91], a[40:43], v[160:163]
    s_add_u32 s28, s28, 4096
    v_exp_f32 v173, v173
    v_mfma_f32_16x16x32_bf16 v[160:163], a[92:95], a[44:47], v[160:163]
    ds_read_b64_tr_b16 v[232:233], v247 offset:0
    v_cvt_pk_bf16_f32 v190, v172, v173
    v_mfma_f32_16x16x32_bf16 v[164:167], a[108:111], a[44:47], v[200:203]
    v_exp_f32 v174, v174
    v_mfma_f32_16x16x32_bf16 v[164:167], a[104:107], a[40:43], v[164:167]
    ds_read_b64_tr_b16 v[234:235], v247 offset:32
    v_mfma_f32_16x16x32_bf16 v[164:167], a[100:103], a[36:39], v[164:167]
    s_add_u32 m0, s29, 8192
    v_exp_f32 v175, v175
    v_mfma_f32_16x16x32_bf16 v[164:167], a[96:99], a[32:35], v[164:167]
    v_cvt_pk_bf16_f32 v191, v174, v175
    v_mfma_f32_16x16x32_bf16 v[168:171], a[112:115], a[32:35], v[200:203]
    v_exp_f32 v160, v160
    v_mfma_f32_16x16x32_bf16 v[168:171], a[116:119], a[36:39], v[168:171]
    buffer_load_dwordx4 v224, s[12:15], s28 offen lds
    v_mfma_f32_16x16x32_bf16 v[168:171], a[120:123], a[40:43], v[168:171]
    s_add_u32 s28, s28, 4096
    v_exp_f32 v161, v161
    v_mfma_f32_16x16x32_bf16 v[168:171], a[124:127], a[44:47], v[168:171]
    v_cvt_pk_bf16_f32 v176, v160, v161
    v_mfma_f32_16x16x32_bf16 v[172:175], a[140:143], a[44:47], v[200:203]
    v_exp_f32 v162, v162
    v_mfma_f32_16x16x32_bf16 v[172:175], a[136:139], a[40:43], v[172:175]
    v_mfma_f32_16x16x32_bf16 v[172:175], a[132:135], a[36:39], v[172:175]
    s_add_u32 m0, s29, 12288
    v_exp_f32 v163, v163
    v_mfma_f32_16x16x32_bf16 v[172:175], a[128:131], a[32:35], v[172:175]
    v_cvt_pk_bf16_f32 v177, v162, v163
    v_smfmac_f32_16x16x64_bf16 a[232:235], a[212:215], v[184:191], v226
    v_mfma_f32_16x16x32_bf16 v[32:35], v[184:187], a[144:147], v[32:35]
    v_exp_f32 v164, v164
    v_mfma_f32_16x16x32_bf16 v[32:35], v[188:191], a[176:179], v[32:35]
    buffer_load_dwordx4 v224, s[12:15], s28 offen lds
    v_mfma_f32_16x16x32_bf16 v[36:39], v[184:187], a[148:151], v[36:39]
    s_add_u32 s28, s28, 4096
    v_exp_f32 v165, v165
    v_mfma_f32_16x16x32_bf16 v[36:39], v[188:191], a[180:183], v[36:39]
    v_cvt_pk_bf16_f32 v178, v164, v165
    v_mfma_f32_16x16x32_bf16 v[40:43], v[184:187], a[152:155], v[40:43]
    v_exp_f32 v166, v166
    v_mfma_f32_16x16x32_bf16 v[40:43], v[188:191], a[184:187], v[40:43]
    v_mfma_f32_16x16x32_bf16 v[44:47], v[184:187], a[156:159], v[44:47]
    v_exp_f32 v167, v167
    v_mfma_f32_16x16x32_bf16 v[44:47], v[188:191], a[188:191], v[44:47]
    v_cvt_pk_bf16_f32 v179, v166, v167
    v_mfma_f32_16x16x32_bf16 v[48:51], v[184:187], a[160:163], v[48:51]
    s_waitcnt lgkmcnt(0)
    v_exp_f32 v168, v168
    v_mfma_f32_16x16x32_bf16 v[48:51], v[188:191], a[192:195], v[48:51]
    buffer_store_dwordx4 v[232:235], v229, s[24:27], s31 offen sc0 sc1
    v_mfma_f32_16x16x32_bf16 v[52:55], v[184:187], a[164:167], v[52:55]
    v_exp_f32 v169, v169
    v_mfma_f32_16x16x32_bf16 v[52:55], v[188:191], a[196:199], v[52:55]
    v_cvt_pk_bf16_f32 v180, v168, v169
    v_mfma_f32_16x16x32_bf16 v[56:59], v[184:187], a[168:171], v[56:59]
    v_exp_f32 v170, v170
    v_mfma_f32_16x16x32_bf16 v[56:59], v[188:191], a[200:203], v[56:59]
    v_mfma_f32_16x16x32_bf16 v[60:63], v[184:187], a[172:175], v[60:63]
    v_exp_f32 v171, v171
    v_mfma_f32_16x16x32_bf16 v[60:63], v[188:191], a[204:207], v[60:63]
    v_cvt_pk_bf16_f32 v181, v170, v171
    v_mfma_f32_16x16x32_bf16 v[160:163], a[80:83], a[48:51], v[204:207]
    s_waitcnt vmcnt(10)
    v_exp_f32 v172, v172
    v_mfma_f32_16x16x32_bf16 v[160:163], a[84:87], a[52:55], v[160:163]
    s_add_u32 s31, s31, 1024
    ds_inc_u32 v248, v248
    v_mfma_f32_16x16x32_bf16 v[160:163], a[88:91], a[56:59], v[160:163]
    s_add_u32 s69, s69, 4
    v_exp_f32 v173, v173
    v_mfma_f32_16x16x32_bf16 v[160:163], a[92:95], a[60:63], v[160:163]
    ds_read_b64_tr_b16 v[232:233], v247 offset:1024
    v_cvt_pk_bf16_f32 v182, v172, v173
    v_mfma_f32_16x16x32_bf16 v[164:167], a[108:111], a[60:63], v[204:207]
    v_exp_f32 v174, v174
    v_mfma_f32_16x16x32_bf16 v[164:167], a[104:107], a[56:59], v[164:167]
    ds_read_b64_tr_b16 v[234:235], v247 offset:1056
    v_mfma_f32_16x16x32_bf16 v[164:167], a[100:103], a[52:55], v[164:167]
    v_exp_f32 v175, v175
    v_mfma_f32_16x16x32_bf16 v[164:167], a[96:99], a[48:51], v[164:167]
    ds_read_b32 v249, v248
    v_cvt_pk_bf16_f32 v183, v174, v175
    v_mfma_f32_16x16x32_bf16 v[168:171], a[112:115], a[48:51], v[204:207]
    v_exp_f32 v160, v160
    v_mfma_f32_16x16x32_bf16 v[168:171], a[116:119], a[52:55], v[168:171]
    v_mfma_f32_16x16x32_bf16 v[168:171], a[120:123], a[56:59], v[168:171]
    v_exp_f32 v161, v161
    v_mfma_f32_16x16x32_bf16 v[168:171], a[124:127], a[60:63], v[168:171]
    v_cvt_pk_bf16_f32 v184, v160, v161
    v_mfma_f32_16x16x32_bf16 v[172:175], a[140:143], a[60:63], v[204:207]
    s_waitcnt lgkmcnt(1)
    v_exp_f32 v162, v162
    v_mfma_f32_16x16x32_bf16 v[172:175], a[136:139], a[56:59], v[172:175]
    buffer_store_dwordx4 v[232:235], v229, s[24:27], s31 offen sc0 sc1
    v_mfma_f32_16x16x32_bf16 v[172:175], a[132:135], a[52:55], v[172:175]
    v_exp_f32 v163, v163
    v_mfma_f32_16x16x32_bf16 v[172:175], a[128:131], a[48:51], v[172:175]
    s_waitcnt lgkmcnt(0)
    v_cvt_pk_bf16_f32 v185, v162, v163
    v_cmp_gt_u32 vcc, s69, v249
    v_smfmac_f32_16x16x64_bf16 a[232:235], a[216:219], v[176:183], v226
    v_mfma_f32_16x16x32_bf16 v[64:67], v[176:179], a[144:147], v[64:67]
    v_exp_f32 v164, v164
    v_mfma_f32_16x16x32_bf16 v[64:67], v[180:183], a[176:179], v[64:67]
    v_mfma_f32_16x16x32_bf16 v[68:71], v[176:179], a[148:151], v[68:71]
    s_cbranch_vccnz L_wait_B_1_a
L_go_B_1_a:
    v_exp_f32 v165, v165
    v_mfma_f32_16x16x32_bf16 v[68:71], v[180:183], a[180:183], v[68:71]
    s_add_u32 m0, s29, 32768
    v_cvt_pk_bf16_f32 v186, v164, v165
    v_mfma_f32_16x16x32_bf16 v[72:75], v[176:179], a[152:155], v[72:75]
    v_exp_f32 v166, v166
    v_mfma_f32_16x16x32_bf16 v[72:75], v[180:183], a[184:187], v[72:75]
    buffer_load_dwordx4 v225, s[16:19], s66 offen lds
    v_mfma_f32_16x16x32_bf16 v[76:79], v[176:179], a[156:159], v[76:79]
    s_add_u32 s66, s66, 4096
    v_exp_f32 v167, v167
    v_mfma_f32_16x16x32_bf16 v[76:79], v[180:183], a[188:191], v[76:79]
    v_cvt_pk_bf16_f32 v187, v166, v167
    v_mfma_f32_16x16x32_bf16 v[80:83], v[176:179], a[160:163], v[80:83]
    v_exp_f32 v168, v168
    v_mfma_f32_16x16x32_bf16 v[80:83], v[180:183], a[192:195], v[80:83]
    v_mfma_f32_16x16x32_bf16 v[84:87], v[176:179], a[164:167], v[84:87]
    s_add_u32 m0, s29, 36864
    v_exp_f32 v169, v169
    v_mfma_f32_16x16x32_bf16 v[84:87], v[180:183], a[196:199], v[84:87]
    v_cvt_pk_bf16_f32 v188, v168, v169
    v_mfma_f32_16x16x32_bf16 v[88:91], v[176:179], a[168:171], v[88:91]
    v_exp_f32 v170, v170
    v_mfma_f32_16x16x32_bf16 v[88:91], v[180:183], a[200:203], v[88:91]
    buffer_load_dwordx4 v225, s[16:19], s66 offen lds
    v_mfma_f32_16x16x32_bf16 v[92:95], v[176:179], a[172:175], v[92:95]
    s_add_u32 s66, s66, 4096
    v_exp_f32 v171, v171
    v_mfma_f32_16x16x32_bf16 v[92:95], v[180:183], a[204:207], v[92:95]
    v_cvt_pk_bf16_f32 v189, v170, v171
    v_mfma_f32_16x16x32_bf16 v[160:163], a[80:83], a[64:67], v[208:211]
    v_exp_f32 v172, v172
    v_mfma_f32_16x16x32_bf16 v[160:163], a[84:87], a[68:71], v[160:163]
    ds_read_b128 a[80:83], v212 offset:16384
    ds_read_b128 a[84:87], v213 offset:16384
    v_mfma_f32_16x16x32_bf16 v[160:163], a[88:91], a[72:75], v[160:163]
    v_exp_f32 v173, v173
    v_mfma_f32_16x16x32_bf16 v[160:163], a[92:95], a[76:79], v[160:163]
    ds_read_b128 a[88:91], v214 offset:16384
    v_cvt_pk_bf16_f32 v190, v172, v173
    v_mfma_f32_16x16x32_bf16 v[164:167], a[108:111], a[76:79], v[208:211]
    v_exp_f32 v174, v174
    v_mfma_f32_16x16x32_bf16 v[164:167], a[104:107], a[72:75], v[164:167]
    ds_read_b128 a[92:95], v215 offset:16384
    ds_read_b128 a[108:111], v215 offset:20480
    v_mfma_f32_16x16x32_bf16 v[164:167], a[100:103], a[68:71], v[164:167]
    v_exp_f32 v175, v175
    v_mfma_f32_16x16x32_bf16 v[164:167], a[96:99], a[64:67], v[164:167]
    ds_read_b128 a[104:107], v214 offset:20480
    v_cvt_pk_bf16_f32 v191, v174, v175
    v_mfma_f32_16x16x32_bf16 v[168:171], a[112:115], a[64:67], v[208:211]
    v_exp_f32 v160, v160
    v_mfma_f32_16x16x32_bf16 v[168:171], a[116:119], a[68:71], v[168:171]
    ds_read_b128 a[100:103], v213 offset:20480
    ds_read_b128 a[96:99], v212 offset:20480
    v_mfma_f32_16x16x32_bf16 v[168:171], a[120:123], a[72:75], v[168:171]
    v_exp_f32 v161, v161
    v_mfma_f32_16x16x32_bf16 v[168:171], a[124:127], a[76:79], v[168:171]
    ds_read_b128 a[112:115], v212 offset:24576
    v_cvt_pk_bf16_f32 v176, v160, v161
    v_mfma_f32_16x16x32_bf16 v[172:175], a[140:143], a[76:79], v[208:211]
    v_exp_f32 v162, v162
    v_mfma_f32_16x16x32_bf16 v[172:175], a[136:139], a[72:75], v[172:175]
    ds_read_b128 a[116:119], v213 offset:24576
    ds_read_b128 a[120:123], v214 offset:24576
    v_mfma_f32_16x16x32_bf16 v[172:175], a[132:135], a[68:71], v[172:175]
    v_exp_f32 v163, v163
    v_mfma_f32_16x16x32_bf16 v[172:175], a[128:131], a[64:67], v[172:175]
    ds_read_b128 a[124:127], v215 offset:24576
    v_cvt_pk_bf16_f32 v177, v162, v163
    v_smfmac_f32_16x16x64_bf16 a[232:235], a[220:223], v[184:191], v226
    ds_read_b128 a[140:143], v215 offset:28672
    ds_read_b128 a[136:139], v214 offset:28672
    v_mfma_f32_16x16x32_bf16 v[96:99], v[184:187], a[144:147], v[96:99]
    v_exp_f32 v164, v164
    v_mfma_f32_16x16x32_bf16 v[96:99], v[188:191], a[176:179], v[96:99]
    ds_read_b128 a[132:135], v213 offset:28672
    ds_read_b128 a[128:131], v212 offset:28672
    v_mfma_f32_16x16x32_bf16 v[100:103], v[184:187], a[148:151], v[100:103]
    v_exp_f32 v165, v165
    v_mfma_f32_16x16x32_bf16 v[100:103], v[188:191], a[180:183], v[100:103]
    v_cvt_pk_bf16_f32 v178, v164, v165
    v_mfma_f32_16x16x32_bf16 v[104:107], v[184:187], a[152:155], v[104:107]
    v_exp_f32 v166, v166
    v_mfma_f32_16x16x32_bf16 v[104:107], v[188:191], a[184:187], v[104:107]
    v_mfma_f32_16x16x32_bf16 v[108:111], v[184:187], a[156:159], v[108:111]
    s_add_u32 m0, s29, 40960
    v_exp_f32 v167, v167
    v_mfma_f32_16x16x32_bf16 v[108:111], v[188:191], a[188:191], v[108:111]
    v_cvt_pk_bf16_f32 v179, v166, v167
    v_mfma_f32_16x16x32_bf16 v[112:115], v[184:187], a[160:163], v[112:115]
    v_exp_f32 v168, v168
    v_mfma_f32_16x16x32_bf16 v[112:115], v[188:191], a[192:195], v[112:115]
    buffer_load_dwordx4 v225, s[16:19], s66 offen lds
    v_mfma_f32_16x16x32_bf16 v[116:119], v[184:187], a[164:167], v[116:119]
    s_add_u32 s66, s66, 4096
    v_exp_f32 v169, v169
    v_mfma_f32_16x16x32_bf16 v[116:119], v[188:191], a[196:199], v[116:119]
    v_cvt_pk_bf16_f32 v180, v168, v169
    v_mfma_f32_16x16x32_bf16 v[120:123], v[184:187], a[168:171], v[120:123]
    s_waitcnt vmcnt(9) lgkmcnt(0)
    v_exp_f32 v170, v170
    v_mfma_f32_16x16x32_bf16 v[120:123], v[188:191], a[200:203], v[120:123]
    ds_inc_u32 v248, v248
    v_mfma_f32_16x16x32_bf16 v[124:127], v[184:187], a[172:175], v[124:127]
    s_add_u32 s69, s69, 4
    v_exp_f32 v171, v171
    v_mfma_f32_16x16x32_bf16 v[124:127], v[188:191], a[204:207], v[124:127]
    v_cvt_pk_bf16_f32 v181, v170, v171
    v_mfma_f32_16x16x32_bf16 v[160:163], a[80:83], a[0:3], v[192:195]
    v_exp_f32 v172, v172
    v_mfma_f32_16x16x32_bf16 v[160:163], a[84:87], a[4:7], v[160:163]
    v_mfma_f32_16x16x32_bf16 v[160:163], a[88:91], a[8:11], v[160:163]
    s_add_u32 m0, s29, 45056
    v_exp_f32 v173, v173
    v_mfma_f32_16x16x32_bf16 v[160:163], a[92:95], a[12:15], v[160:163]
    ds_read_b32 v249, v248
    v_cvt_pk_bf16_f32 v182, v172, v173
    v_mfma_f32_16x16x32_bf16 v[164:167], a[108:111], a[12:15], v[192:195]
    v_exp_f32 v174, v174
    v_mfma_f32_16x16x32_bf16 v[164:167], a[104:107], a[8:11], v[164:167]
    buffer_load_dwordx4 v225, s[16:19], s66 offen lds
    v_mfma_f32_16x16x32_bf16 v[164:167], a[100:103], a[4:7], v[164:167]
    s_add_u32 s66, s66, 4096
    v_exp_f32 v175, v175
    v_mfma_f32_16x16x32_bf16 v[164:167], a[96:99], a[0:3], v[164:167]
    v_cvt_pk_bf16_f32 v183, v174, v175
    v_mfma_f32_16x16x32_bf16 v[168:171], a[112:115], a[0:3], v[192:195]
    v_exp_f32 v160, v160
    v_mfma_f32_16x16x32_bf16 v[168:171], a[116:119], a[4:7], v[168:171]
    v_mfma_f32_16x16x32_bf16 v[168:171], a[120:123], a[8:11], v[168:171]
    v_exp_f32 v161, v161
    v_mfma_f32_16x16x32_bf16 v[168:171], a[124:127], a[12:15], v[168:171]
    s_waitcnt lgkmcnt(0)
    v_cvt_pk_bf16_f32 v184, v160, v161
    v_cmp_gt_u32 vcc, s69, v249
    v_mfma_f32_16x16x32_bf16 v[172:175], a[140:143], a[12:15], v[192:195]
    v_exp_f32 v162, v162
    v_mfma_f32_16x16x32_bf16 v[172:175], a[136:139], a[8:11], v[172:175]
    v_mfma_f32_16x16x32_bf16 v[172:175], a[132:135], a[4:7], v[172:175]
    s_cbranch_vccnz L_wait_B_1_b
L_go_B_1_b:
    v_exp_f32 v163, v163
    v_mfma_f32_16x16x32_bf16 v[172:175], a[128:131], a[0:3], v[172:175]
    v_cvt_pk_bf16_f32 v185, v162, v163
    v_smfmac_f32_16x16x64_bf16 a[232:235], a[224:227], v[176:183], v226
    v_mfma_f32_16x16x32_bf16 v[128:131], v[176:179], a[144:147], v[128:131]
    v_exp_f32 v164, v164
    v_mfma_f32_16x16x32_bf16 v[128:131], v[180:183], a[176:179], v[128:131]
    ds_read_b64_tr_b16 a[144:145], v216 offset:49152
    ds_read_b64_tr_b16 a[146:147], v216 offset:53248
    v_mfma_f32_16x16x32_bf16 v[132:135], v[176:179], a[148:151], v[132:135]
    v_exp_f32 v165, v165
    v_mfma_f32_16x16x32_bf16 v[132:135], v[180:183], a[180:183], v[132:135]
    ds_read_b64_tr_b16 a[176:177], v216 offset:57344
    v_cvt_pk_bf16_f32 v186, v164, v165
    v_mfma_f32_16x16x32_bf16 v[136:139], v[176:179], a[152:155], v[136:139]
    v_exp_f32 v166, v166
    v_mfma_f32_16x16x32_bf16 v[136:139], v[180:183], a[184:187], v[136:139]
    ds_read_b64_tr_b16 a[178:179], v216 offset:61440
    ds_read_b64_tr_b16 a[148:149], v217 offset:49152
    v_mfma_f32_16x16x32_bf16 v[140:143], v[176:179], a[156:159], v[140:143]
    v_exp_f32 v167, v167
    v_mfma_f32_16x16x32_bf16 v[140:143], v[180:183], a[188:191], v[140:143]
    ds_read_b64_tr_b16 a[150:151], v217 offset:53248
    v_cvt_pk_bf16_f32 v187, v166, v167
    v_mfma_f32_16x16x32_bf16 v[144:147], v[176:179], a[160:163], v[144:147]
    v_exp_f32 v168, v168
    v_mfma_f32_16x16x32_bf16 v[144:147], v[180:183], a[192:195], v[144:147]
    ds_read_b64_tr_b16 a[180:181], v217 offset:57344
    ds_read_b64_tr_b16 a[182:183], v217 offset:61440
    v_mfma_f32_16x16x32_bf16 v[148:151], v[176:179], a[164:167], v[148:151]
    v_exp_f32 v169, v169
    v_mfma_f32_16x16x32_bf16 v[148:151], v[180:183], a[196:199], v[148:151]
    ds_read_b64_tr_b16 a[152:153], v218 offset:49152
    v_cvt_pk_bf16_f32 v188, v168, v169
    v_mfma_f32_16x16x32_bf16 v[152:155], v[176:179], a[168:171], v[152:155]
    v_exp_f32 v170, v170
    v_mfma_f32_16x16x32_bf16 v[152:155], v[180:183], a[200:203], v[152:155]
    ds_read_b64_tr_b16 a[154:155], v218 offset:53248
    ds_read_b64_tr_b16 a[184:185], v218 offset:57344
    v_mfma_f32_16x16x32_bf16 v[156:159], v[176:179], a[172:175], v[156:159]
    v_exp_f32 v171, v171
    v_mfma_f32_16x16x32_bf16 v[156:159], v[180:183], a[204:207], v[156:159]
    ds_read_b64_tr_b16 a[186:187], v218 offset:61440
    v_cvt_pk_bf16_f32 v189, v170, v171
    v_mfma_f32_16x16x32_bf16 v[160:163], a[80:83], a[16:19], v[196:199]
    v_exp_f32 v172, v172
    v_mfma_f32_16x16x32_bf16 v[160:163], a[84:87], a[20:23], v[160:163]
    ds_read_b64_tr_b16 a[156:157], v219 offset:49152
    ds_read_b64_tr_b16 a[158:159], v219 offset:53248
    v_mfma_f32_16x16x32_bf16 v[160:163], a[88:91], a[24:27], v[160:163]
    v_exp_f32 v173, v173
    v_mfma_f32_16x16x32_bf16 v[160:163], a[92:95], a[28:31], v[160:163]
    ds_read_b64_tr_b16 a[188:189], v219 offset:57344
    v_cvt_pk_bf16_f32 v190, v172, v173
    v_mfma_f32_16x16x32_bf16 v[164:167], a[108:111], a[28:31], v[196:199]
    v_exp_f32 v174, v174
    v_mfma_f32_16x16x32_bf16 v[164:167], a[104:107], a[24:27], v[164:167]
    ds_read_b64_tr_b16 a[190:191], v219 offset:61440
    ds_read_b64_tr_b16 a[160:161], v220 offset:49152
    v_mfma_f32_16x16x32_bf16 v[164:167], a[100:103], a[20:23], v[164:167]
    v_exp_f32 v175, v175
    v_mfma_f32_16x16x32_bf16 v[164:167], a[96:99], a[16:19], v[164:167]
    ds_read_b64_tr_b16 a[162:163], v220 offset:53248
    v_cvt_pk_bf16_f32 v191, v174, v175
    v_mfma_f32_16x16x32_bf16 v[168:171], a[112:115], a[16:19], v[196:199]
    v_exp_f32 v160, v160
    v_mfma_f32_16x16x32_bf16 v[168:171], a[116:119], a[20:23], v[168:171]
    ds_read_b64_tr_b16 a[192:193], v220 offset:57344
    ds_read_b64_tr_b16 a[194:195], v220 offset:61440
    v_mfma_f32_16x16x32_bf16 v[168:171], a[120:123], a[24:27], v[168:171]
    v_exp_f32 v161, v161
    v_mfma_f32_16x16x32_bf16 v[168:171], a[124:127], a[28:31], v[168:171]
    ds_read_b64_tr_b16 a[164:165], v221 offset:49152
    v_cvt_pk_bf16_f32 v176, v160, v161
    v_mfma_f32_16x16x32_bf16 v[172:175], a[140:143], a[28:31], v[196:199]
    v_exp_f32 v162, v162
    v_mfma_f32_16x16x32_bf16 v[172:175], a[136:139], a[24:27], v[172:175]
    ds_read_b64_tr_b16 a[166:167], v221 offset:53248
    ds_read_b64_tr_b16 a[196:197], v221 offset:57344
    v_mfma_f32_16x16x32_bf16 v[172:175], a[132:135], a[20:23], v[172:175]
    v_exp_f32 v163, v163
    v_mfma_f32_16x16x32_bf16 v[172:175], a[128:131], a[16:19], v[172:175]
    s_waitcnt lgkmcnt(7)
    ds_read_b64_tr_b16 a[198:199], v221 offset:61440
    v_cvt_pk_bf16_f32 v177, v162, v163
    v_smfmac_f32_16x16x64_bf16 a[232:235], a[208:211], v[184:191], v226
L_page5:
    s_cbranch_execz L_warm
    ds_read_b64_tr_b16 a[168:169], v222 offset:49152
    ds_read_b64_tr_b16 a[170:171], v222 offset:53248
    v_mfma_f32_16x16x32_bf16 v[0:3], v[184:187], a[144:147], v[0:3]
    v_exp_f32 v164, v164
    v_mfma_f32_16x16x32_bf16 v[0:3], v[188:191], a[176:179], v[0:3]
    ds_read_b64_tr_b16 a[200:201], v222 offset:57344
    ds_read_b64_tr_b16 a[202:203], v222 offset:61440
    v_mfma_f32_16x16x32_bf16 v[4:7], v[184:187], a[148:151], v[4:7]
    v_exp_f32 v165, v165
    v_mfma_f32_16x16x32_bf16 v[4:7], v[188:191], a[180:183], v[4:7]
    ds_read_b64_tr_b16 a[172:173], v223 offset:49152
    v_cvt_pk_bf16_f32 v178, v164, v165
    v_mfma_f32_16x16x32_bf16 v[8:11], v[184:187], a[152:155], v[8:11]
    v_exp_f32 v166, v166
    v_mfma_f32_16x16x32_bf16 v[8:11], v[188:191], a[184:187], v[8:11]
    ds_read_b64_tr_b16 a[174:175], v223 offset:53248
    ds_read_b64_tr_b16 a[204:205], v223 offset:57344
    v_mfma_f32_16x16x32_bf16 v[12:15], v[184:187], a[156:159], v[12:15]
    s_add_u32 m0, s29, 16384
    v_exp_f32 v167, v167
    v_mfma_f32_16x16x32_bf16 v[12:15], v[188:191], a[188:191], v[12:15]
    s_waitcnt lgkmcnt(7)
    ds_read_b64_tr_b16 a[206:207], v223 offset:61440
    v_cvt_pk_bf16_f32 v179, v166, v167
    v_mfma_f32_16x16x32_bf16 v[16:19], v[184:187], a[160:163], v[16:19]
    v_exp_f32 v168, v168
    v_mfma_f32_16x16x32_bf16 v[16:19], v[188:191], a[192:195], v[16:19]
    buffer_load_dwordx4 v224, s[12:15], s28 offen lds
    v_mfma_f32_16x16x32_bf16 v[20:23], v[184:187], a[164:167], v[20:23]
    s_add_u32 s28, s28, 4096
    v_exp_f32 v169, v169
    v_mfma_f32_16x16x32_bf16 v[20:23], v[188:191], a[196:199], v[20:23]
    s_waitcnt lgkmcnt(4)
    v_cvt_pk_bf16_f32 v180, v168, v169
    v_mfma_f32_16x16x32_bf16 v[24:27], v[184:187], a[168:171], v[24:27]
    v_exp_f32 v170, v170
    v_mfma_f32_16x16x32_bf16 v[24:27], v[188:191], a[200:203], v[24:27]
    s_waitcnt lgkmcnt(0)
    v_mfma_f32_16x16x32_bf16 v[28:31], v[184:187], a[172:175], v[28:31]
    s_add_u32 m0, s29, 20480
    v_exp_f32 v171, v171
    v_mfma_f32_16x16x32_bf16 v[28:31], v[188:191], a[204:207], v[28:31]
    v_cvt_pk_bf16_f32 v181, v170, v171
    v_mfma_f32_16x16x32_bf16 v[160:163], a[80:83], a[32:35], v[200:203]
    s_add_u32 s31, s31, 1024
    v_exp_f32 v172, v172
    v_mfma_f32_16x16x32_bf16 v[160:163], a[84:87], a[36:39], v[160:163]
    buffer_load_dwordx4 v224, s[12:15], s28 offen lds
    v_mfma_f32_16x16x32_bf16 v[160:163], a[88:91], a[40:43], v[160:163]
    s_add_u32 s28, s28, 4096
    v_exp_f32 v173, v173
    v_mfma_f32_16x16x32_bf16 v[160:163], a[92:95], a[44:47], v[160:163]
    ds_read_b64_tr_b16 v[232:233], v247 offset:2048
    v_cvt_pk_bf16_f32 v182, v172, v173
    v_mfma_f32_16x16x32_bf16 v[164:167], a[108:111], a[44:47], v[200:203]
    v_exp_f32 v174, v174
    v_mfma_f32_16x16x32_bf16 v[164:167], a[104:107], a[40:43], v[164:167]
    ds_read_b64_tr_b16 v[234:235], v247 offset:2080
    v_add_u32 v247, 3072, v247
    v_mfma_f32_16x16x32_bf16 v[164:167], a[100:103], a[36:39], v[164:167]
    s_add_u32 m0, s29, 24576
    v_exp_f32 v175, v175
    v_mfma_f32_16x16x32_bf16 v[164:167], a[96:99], a[32:35], v[164:167]
    v_cvt_pk_bf16_f32 v183, v174, v175
    v_mfma_f32_16x16x32_bf16 v[168:171], a[112:115], a[32:35], v[200:203]
    v_exp_f32 v160, v160
    v_mfma_f32_16x16x32_bf16 v[168:171], a[116:119], a[36:39], v[168:171]
    buffer_load_dwordx4 v224, s[12:15], s28 offen lds
    v_mfma_f32_16x16x32_bf16 v[168:171], a[120:123], a[40:43], v[168:171]
    s_add_u32 s28, s28, 4096
    v_exp_f32 v161, v161
    v_mfma_f32_16x16x32_bf16 v[168:171], a[124:127], a[44:47], v[168:171]
    v_cvt_pk_bf16_f32 v184, v160, v161
    v_mfma_f32_16x16x32_bf16 v[172:175], a[140:143], a[44:47], v[200:203]
    v_exp_f32 v162, v162
    v_mfma_f32_16x16x32_bf16 v[172:175], a[136:139], a[40:43], v[172:175]
    v_mfma_f32_16x16x32_bf16 v[172:175], a[132:135], a[36:39], v[172:175]
    s_add_u32 m0, s29, 28672
    v_exp_f32 v163, v163
    v_mfma_f32_16x16x32_bf16 v[172:175], a[128:131], a[32:35], v[172:175]
    v_cvt_pk_bf16_f32 v185, v162, v163
    v_smfmac_f32_16x16x64_bf16 a[232:235], a[212:215], v[176:183], v226
    v_mfma_f32_16x16x32_bf16 v[32:35], v[176:179], a[144:147], v[32:35]
    v_exp_f32 v164, v164
    v_mfma_f32_16x16x32_bf16 v[32:35], v[180:183], a[176:179], v[32:35]
    buffer_load_dwordx4 v224, s[12:15], s28 offen lds
    v_mfma_f32_16x16x32_bf16 v[36:39], v[176:179], a[148:151], v[36:39]
    s_add_u32 s28, s28, 4096
    v_exp_f32 v165, v165
    v_mfma_f32_16x16x32_bf16 v[36:39], v[180:183], a[180:183], v[36:39]
    v_cvt_pk_bf16_f32 v186, v164, v165
    v_mfma_f32_16x16x32_bf16 v[40:43], v[176:179], a[152:155], v[40:43]
    v_exp_f32 v166, v166
    v_mfma_f32_16x16x32_bf16 v[40:43], v[180:183], a[184:187], v[40:43]
    v_mfma_f32_16x16x32_bf16 v[44:47], v[176:179], a[156:159], v[44:47]
    v_exp_f32 v167, v167
    v_mfma_f32_16x16x32_bf16 v[44:47], v[180:183], a[188:191], v[44:47]
    v_cvt_pk_bf16_f32 v187, v166, v167
    v_mfma_f32_16x16x32_bf16 v[48:51], v[176:179], a[160:163], v[48:51]
    s_waitcnt lgkmcnt(0)
    v_exp_f32 v168, v168
    v_mfma_f32_16x16x32_bf16 v[48:51], v[180:183], a[192:195], v[48:51]
    buffer_store_dwordx4 v[232:235], v229, s[24:27], s31 offen sc0 sc1
    v_mfma_f32_16x16x32_bf16 v[52:55], v[176:179], a[164:167], v[52:55]
    v_exp_f32 v169, v169
    v_mfma_f32_16x16x32_bf16 v[52:55], v[180:183], a[196:199], v[52:55]
    s_sub_u32 s30, s30, 1
    v_cvt_pk_bf16_f32 v188, v168, v169
    v_mfma_f32_16x16x32_bf16 v[56:59], v[176:179], a[168:171], v[56:59]
    v_exp_f32 v170, v170
    v_mfma_f32_16x16x32_bf16 v[56:59], v[180:183], a[200:203], v[56:59]
    s_cmp_lg_u32 s30, 0
    v_mfma_f32_16x16x32_bf16 v[60:63], v[176:179], a[172:175], v[60:63]
    v_exp_f32 v171, v171
    v_mfma_f32_16x16x32_bf16 v[60:63], v[180:183], a[204:207], v[60:63]
    s_cbranch_scc1 L_B
L_final:
    v_mfma_f32_16x16x32_bf16 v[160:163], a[80:83], a[48:51], v[204:207]
    s_waitcnt vmcnt(11)
    v_exp_f32 v172, v172
    v_mfma_f32_16x16x32_bf16 v[160:163], a[84:87], a[52:55], v[160:163]
    s_add_u32 s31, s31, 1024
    ds_inc_u32 v248, v248
    v_mfma_f32_16x16x32_bf16 v[160:163], a[88:91], a[56:59], v[160:163]
    s_add_u32 s69, s69, 4
    v_exp_f32 v173, v173
    v_mfma_f32_16x16x32_bf16 v[160:163], a[92:95], a[60:63], v[160:163]
    v_cvt_pk_bf16_f32 v189, v170, v171
    v_cvt_pk_bf16_f32 v190, v172, v173
    v_mfma_f32_16x16x32_bf16 v[164:167], a[108:111], a[60:63], v[204:207]
    v_exp_f32 v174, v174
    v_mfma_f32_16x16x32_bf16 v[164:167], a[104:107], a[56:59], v[164:167]
    ds_read_b64_tr_b16 v[232:233], v247 offset:0
    ds_read_b64_tr_b16 v[234:235], v247 offset:32
    v_mfma_f32_16x16x32_bf16 v[164:167], a[100:103], a[52:55], v[164:167]
    v_exp_f32 v175, v175
    v_mfma_f32_16x16x32_bf16 v[164:167], a[96:99], a[48:51], v[164:167]
    ds_read_b32 v249, v248
    v_cvt_pk_bf16_f32 v191, v174, v175
    v_mfma_f32_16x16x32_bf16 v[168:171], a[112:115], a[48:51], v[204:207]
    v_exp_f32 v160, v160
    v_mfma_f32_16x16x32_bf16 v[168:171], a[116:119], a[52:55], v[168:171]
    v_mfma_f32_16x16x32_bf16 v[168:171], a[120:123], a[56:59], v[168:171]
    v_exp_f32 v161, v161
    v_mfma_f32_16x16x32_bf16 v[168:171], a[124:127], a[60:63], v[168:171]
    v_cvt_pk_bf16_f32 v176, v160, v161
    v_mfma_f32_16x16x32_bf16 v[172:175], a[140:143], a[60:63], v[204:207]
    s_waitcnt lgkmcnt(1)
    v_exp_f32 v162, v162
    v_mfma_f32_16x16x32_bf16 v[172:175], a[136:139], a[56:59], v[172:175]
    buffer_store_dwordx4 v[232:235], v229, s[24:27], s31 offen sc0 sc1
    v_mfma_f32_16x16x32_bf16 v[172:175], a[132:135], a[52:55], v[172:175]
    v_exp_f32 v163, v163
    v_mfma_f32_16x16x32_bf16 v[172:175], a[128:131], a[48:51], v[172:175]
    s_waitcnt lgkmcnt(0)
    v_cvt_pk_bf16_f32 v177, v162, v163
    v_cmp_gt_u32 vcc, s69, v249
    v_smfmac_f32_16x16x64_bf16 a[232:235], a[216:219], v[184:191], v226
    v_mfma_f32_16x16x32_bf16 v[64:67], v[184:187], a[144:147], v[64:67]
    v_exp_f32 v164, v164
    v_mfma_f32_16x16x32_bf16 v[64:67], v[188:191], a[176:179], v[64:67]
    v_mfma_f32_16x16x32_bf16 v[68:71], v[184:187], a[148:151], v[68:71]
    s_cbranch_vccnz L_wait_fin_0_a
L_go_fin_0_a:
    v_exp_f32 v165, v165
    v_mfma_f32_16x16x32_bf16 v[68:71], v[188:191], a[180:183], v[68:71]
    s_add_u32 m0, s29, 49152
    v_cvt_pk_bf16_f32 v178, v164, v165
    v_mfma_f32_16x16x32_bf16 v[72:75], v[184:187], a[152:155], v[72:75]
    v_exp_f32 v166, v166
    v_mfma_f32_16x16x32_bf16 v[72:75], v[188:191], a[184:187], v[72:75]
    buffer_load_dwordx4 v225, s[16:19], s66 offen lds
    v_mfma_f32_16x16x32_bf16 v[76:79], v[184:187], a[156:159], v[76:79]
    s_add_u32 s66, s66, 4096
    v_exp_f32 v167, v167
    v_mfma_f32_16x16x32_bf16 v[76:79], v[188:191], a[188:191], v[76:79]
    s_add_u32 m0, s29, 53248
    v_cvt_pk_bf16_f32 v179, v166, v167
    v_mfma_f32_16x16x32_bf16 v[80:83], v[184:187], a[160:163], v[80:83]
    v_exp_f32 v168, v168
    v_mfma_f32_16x16x32_bf16 v[80:83], v[188:191], a[192:195], v[80:83]
    buffer_load_dwordx4 v225, s[16:19], s66 offen lds
    v_mfma_f32_16x16x32_bf16 v[84:87], v[184:187], a[164:167], v[84:87]
    s_add_u32 s66, s66, 4096
    v_exp_f32 v169, v169
    v_mfma_f32_16x16x32_bf16 v[84:87], v[188:191], a[196:199], v[84:87]
    s_add_u32 m0, s29, 57344
    v_cvt_pk_bf16_f32 v180, v168, v169
    v_mfma_f32_16x16x32_bf16 v[88:91], v[184:187], a[168:171], v[88:91]
    v_exp_f32 v170, v170
    v_mfma_f32_16x16x32_bf16 v[88:91], v[188:191], a[200:203], v[88:91]
    buffer_load_dwordx4 v225, s[16:19], s66 offen lds
    v_mfma_f32_16x16x32_bf16 v[92:95], v[184:187], a[172:175], v[92:95]
    s_add_u32 s66, s66, 4096
    v_exp_f32 v171, v171
    v_mfma_f32_16x16x32_bf16 v[92:95], v[188:191], a[204:207], v[92:95]
    v_cvt_pk_bf16_f32 v181, v170, v171
    v_mfma_f32_16x16x32_bf16 v[160:163], a[80:83], a[64:67], v[208:211]
    v_exp_f32 v172, v172
    v_mfma_f32_16x16x32_bf16 v[160:163], a[84:87], a[68:71], v[160:163]
    ds_read_b128 a[80:83], v212 offset:0
    ds_read_b128 a[84:87], v213 offset:0
    v_mfma_f32_16x16x32_bf16 v[160:163], a[88:91], a[72:75], v[160:163]
    s_add_u32 m0, s29, 61440
    v_exp_f32 v173, v173
    v_mfma_f32_16x16x32_bf16 v[160:163], a[92:95], a[76:79], v[160:163]
    ds_read_b128 a[88:91], v214 offset:0
    v_cvt_pk_bf16_f32 v182, v172, v173
    v_mfma_f32_16x16x32_bf16 v[164:167], a[108:111], a[76:79], v[208:211]
    v_exp_f32 v174, v174
    v_mfma_f32_16x16x32_bf16 v[164:167], a[104:107], a[72:75], v[164:167]
    buffer_load_dwordx4 v225, s[16:19], s66 offen lds
    v_mfma_f32_16x16x32_bf16 v[164:167], a[100:103], a[68:71], v[164:167]
    s_add_u32 s66, s66, 4096
    v_exp_f32 v175, v175
    v_mfma_f32_16x16x32_bf16 v[164:167], a[96:99], a[64:67], v[164:167]
    ds_read_b128 a[92:95], v215 offset:0
    v_cvt_pk_bf16_f32 v183, v174, v175
    v_mfma_f32_16x16x32_bf16 v[168:171], a[112:115], a[64:67], v[208:211]
    v_exp_f32 v160, v160
    v_mfma_f32_16x16x32_bf16 v[168:171], a[116:119], a[68:71], v[168:171]
    ds_read_b128 a[108:111], v215 offset:4096
    ds_read_b128 a[104:107], v214 offset:4096
    v_mfma_f32_16x16x32_bf16 v[168:171], a[120:123], a[72:75], v[168:171]
    v_exp_f32 v161, v161
    v_mfma_f32_16x16x32_bf16 v[168:171], a[124:127], a[76:79], v[168:171]
    ds_read_b128 a[100:103], v213 offset:4096
    v_cvt_pk_bf16_f32 v184, v160, v161
    v_mfma_f32_16x16x32_bf16 v[172:175], a[140:143], a[76:79], v[208:211]
    v_exp_f32 v162, v162
    v_mfma_f32_16x16x32_bf16 v[172:175], a[136:139], a[72:75], v[172:175]
    ds_read_b128 a[96:99], v212 offset:4096
    ds_read_b128 a[112:115], v212 offset:8192
    v_mfma_f32_16x16x32_bf16 v[172:175], a[132:135], a[68:71], v[172:175]
    v_exp_f32 v163, v163
    v_mfma_f32_16x16x32_bf16 v[172:175], a[128:131], a[64:67], v[172:175]
    ds_read_b128 a[116:119], v213 offset:8192
    v_cvt_pk_bf16_f32 v185, v162, v163
    v_smfmac_f32_16x16x64_bf16 a[232:235], a[220:223], v[176:183], v226
    ds_read_b128 a[120:123], v214 offset:8192
    ds_read_b128 a[124:127], v215 offset:8192
    v_mfma_f32_16x16x32_bf16 v[96:99], v[176:179], a[144:147], v[96:99]
    v_exp_f32 v164, v164
    v_mfma_f32_16x16x32_bf16 v[96:99], v[180:183], a[176:179], v[96:99]
    ds_read_b128 a[140:143], v215 offset:12288
    ds_read_b128 a[136:139], v214 offset:12288
    v_mfma_f32_16x16x32_bf16 v[100:103], v[176:179], a[148:151], v[100:103]
    v_exp_f32 v165, v165
    v_mfma_f32_16x16x32_bf16 v[100:103], v[180:183], a[180:183], v[100:103]
    ds_read_b128 a[132:135], v213 offset:12288
    v_cvt_pk_bf16_f32 v186, v164, v165
    v_mfma_f32_16x16x32_bf16 v[104:107], v[176:179], a[152:155], v[104:107]
    v_exp_f32 v166, v166
    v_mfma_f32_16x16x32_bf16 v[104:107], v[180:183], a[184:187], v[104:107]
    ds_read_b128 a[128:131], v212 offset:12288
    v_mfma_f32_16x16x32_bf16 v[108:111], v[176:179], a[156:159], v[108:111]
    v_exp_f32 v167, v167
    v_mfma_f32_16x16x32_bf16 v[108:111], v[180:183], a[188:191], v[108:111]
    v_cvt_pk_bf16_f32 v187, v166, v167
    v_mfma_f32_16x16x32_bf16 v[112:115], v[176:179], a[160:163], v[112:115]
    v_exp_f32 v168, v168
    v_mfma_f32_16x16x32_bf16 v[112:115], v[180:183], a[192:195], v[112:115]
    v_mfma_f32_16x16x32_bf16 v[116:119], v[176:179], a[164:167], v[116:119]
    v_exp_f32 v169, v169
    v_mfma_f32_16x16x32_bf16 v[116:119], v[180:183], a[196:199], v[116:119]
    v_cvt_pk_bf16_f32 v188, v168, v169
    v_mfma_f32_16x16x32_bf16 v[120:123], v[176:179], a[168:171], v[120:123]
    s_waitcnt vmcnt(10) lgkmcnt(0)
    v_exp_f32 v170, v170
    v_mfma_f32_16x16x32_bf16 v[120:123], v[180:183], a[200:203], v[120:123]
    ds_inc_u32 v248, v248
    v_mfma_f32_16x16x32_bf16 v[124:127], v[176:179], a[172:175], v[124:127]
    s_add_u32 s69, s69, 4
    v_exp_f32 v171, v171
    v_mfma_f32_16x16x32_bf16 v[124:127], v[180:183], a[204:207], v[124:127]
    v_cvt_pk_bf16_f32 v189, v170, v171
    v_mfma_f32_16x16x32_bf16 v[160:163], a[80:83], a[0:3], v[192:195]
    v_exp_f32 v172, v172
    v_mfma_f32_16x16x32_bf16 v[160:163], a[84:87], a[4:7], v[160:163]
    v_mfma_f32_16x16x32_bf16 v[160:163], a[88:91], a[8:11], v[160:163]
    v_exp_f32 v173, v173
    v_mfma_f32_16x16x32_bf16 v[160:163], a[92:95], a[12:15], v[160:163]
    ds_read_b32 v249, v248
    v_cvt_pk_bf16_f32 v190, v172, v173
    v_mfma_f32_16x16x32_bf16 v[164:167], a[108:111], a[12:15], v[192:195]
    v_exp_f32 v174, v174
    v_mfma_f32_16x16x32_bf16 v[164:167], a[104:107], a[8:11], v[164:167]
    v_mfma_f32_16x16x32_bf16 v[164:167], a[100:103], a[4:7], v[164:167]
    v_exp_f32 v175, v175
    v_mfma_f32_16x16x32_bf16 v[164:167], a[96:99], a[0:3], v[164:167]
    v_cvt_pk_bf16_f32 v191, v174, v175
    v_mfma_f32_16x16x32_bf16 v[168:171], a[112:115], a[0:3], v[192:195]
    v_exp_f32 v160, v160
    v_mfma_f32_16x16x32_bf16 v[168:171], a[116:119], a[4:7], v[168:171]
    v_mfma_f32_16x16x32_bf16 v[168:171], a[120:123], a[8:11], v[168:171]
    v_exp_f32 v161, v161
    v_mfma_f32_16x16x32_bf16 v[168:171], a[124:127], a[12:15], v[168:171]
    s_waitcnt lgkmcnt(0)
    v_cvt_pk_bf16_f32 v176, v160, v161
    v_cmp_gt_u32 vcc, s69, v249
    v_mfma_f32_16x16x32_bf16 v[172:175], a[140:143], a[12:15], v[192:195]
    v_exp_f32 v162, v162
    v_mfma_f32_16x16x32_bf16 v[172:175], a[136:139], a[8:11], v[172:175]
    v_mfma_f32_16x16x32_bf16 v[172:175], a[132:135], a[4:7], v[172:175]
    s_cbranch_vccnz L_wait_fin_0_b
L_go_fin_0_b:
    v_exp_f32 v163, v163
    v_mfma_f32_16x16x32_bf16 v[172:175], a[128:131], a[0:3], v[172:175]
    v_cvt_pk_bf16_f32 v177, v162, v163
    v_smfmac_f32_16x16x64_bf16 a[232:235], a[224:227], v[184:191], v226
    v_mfma_f32_16x16x32_bf16 v[128:131], v[184:187], a[144:147], v[128:131]
    v_exp_f32 v164, v164
    v_mfma_f32_16x16x32_bf16 v[128:131], v[188:191], a[176:179], v[128:131]
    ds_read_b64_tr_b16 a[144:145], v216 offset:32768
    ds_read_b64_tr_b16 a[146:147], v216 offset:36864
    v_mfma_f32_16x16x32_bf16 v[132:135], v[184:187], a[148:151], v[132:135]
    v_exp_f32 v165, v165
    v_mfma_f32_16x16x32_bf16 v[132:135], v[188:191], a[180:183], v[132:135]
    ds_read_b64_tr_b16 a[176:177], v216 offset:40960
    v_cvt_pk_bf16_f32 v178, v164, v165
    v_mfma_f32_16x16x32_bf16 v[136:139], v[184:187], a[152:155], v[136:139]
    v_exp_f32 v166, v166
    v_mfma_f32_16x16x32_bf16 v[136:139], v[188:191], a[184:187], v[136:139]
    ds_read_b64_tr_b16 a[178:179], v216 offset:45056
    ds_read_b64_tr_b16 a[148:149], v217 offset:32768
    v_mfma_f32_16x16x32_bf16 v[140:143], v[184:187], a[156:159], v[140:143]
    v_exp_f32 v167, v167
    v_mfma_f32_16x16x32_bf16 v[140:143], v[188:191], a[188:191], v[140:143]
    ds_read_b64_tr_b16 a[150:151], v217 offset:36864
    v_cvt_pk_bf16_f32 v179, v166, v167
    v_mfma_f32_16x16x32_bf16 v[144:147], v[184:187], a[160:163], v[144:147]
    v_exp_f32 v168, v168
    v_mfma_f32_16x16x32_bf16 v[144:147], v[188:191], a[192:195], v[144:147]
    ds_read_b64_tr_b16 a[180:181], v217 offset:40960
    ds_read_b64_tr_b16 a[182:183], v217 offset:45056
    v_mfma_f32_16x16x32_bf16 v[148:151], v[184:187], a[164:167], v[148:151]
    v_exp_f32 v169, v169
    v_mfma_f32_16x16x32_bf16 v[148:151], v[188:191], a[196:199], v[148:151]
    ds_read_b64_tr_b16 a[152:153], v218 offset:32768
    v_cvt_pk_bf16_f32 v180, v168, v169
    v_mfma_f32_16x16x32_bf16 v[152:155], v[184:187], a[168:171], v[152:155]
    v_exp_f32 v170, v170
    v_mfma_f32_16x16x32_bf16 v[152:155], v[188:191], a[200:203], v[152:155]
    ds_read_b64_tr_b16 a[154:155], v218 offset:36864
    ds_read_b64_tr_b16 a[184:185], v218 offset:40960
    v_mfma_f32_16x16x32_bf16 v[156:159], v[184:187], a[172:175], v[156:159]
    v_exp_f32 v171, v171
    v_mfma_f32_16x16x32_bf16 v[156:159], v[188:191], a[204:207], v[156:159]
    ds_read_b64_tr_b16 a[186:187], v218 offset:45056
    v_cvt_pk_bf16_f32 v181, v170, v171
    v_mfma_f32_16x16x32_bf16 v[160:163], a[80:83], a[16:19], v[196:199]
    v_exp_f32 v172, v172
    v_mfma_f32_16x16x32_bf16 v[160:163], a[84:87], a[20:23], v[160:163]
    ds_read_b64_tr_b16 a[156:157], v219 offset:32768
    ds_read_b64_tr_b16 a[158:159], v219 offset:36864
    v_mfma_f32_16x16x32_bf16 v[160:163], a[88:91], a[24:27], v[160:163]
    v_exp_f32 v173, v173
    v_mfma_f32_16x16x32_bf16 v[160:163], a[92:95], a[28:31], v[160:163]
    ds_read_b64_tr_b16 a[188:189], v219 offset:40960
    v_cvt_pk_bf16_f32 v182, v172, v173
    v_mfma_f32_16x16x32_bf16 v[164:167], a[108:111], a[28:31], v[196:199]
    v_exp_f32 v174, v174
    v_mfma_f32_16x16x32_bf16 v[164:167], a[104:107], a[24:27], v[164:167]
    ds_read_b64_tr_b16 a[190:191], v219 offset:45056
    ds_read_b64_tr_b16 a[160:161], v220 offset:32768
    v_mfma_f32_16x16x32_bf16 v[164:167], a[100:103], a[20:23], v[164:167]
    v_exp_f32 v175, v175
    v_mfma_f32_16x16x32_bf16 v[164:167], a[96:99], a[16:19], v[164:167]
    ds_read_b64_tr_b16 a[162:163], v220 offset:36864
    v_cvt_pk_bf16_f32 v183, v174, v175
    v_mfma_f32_16x16x32_bf16 v[168:171], a[112:115], a[16:19], v[196:199]
    v_exp_f32 v160, v160
    v_mfma_f32_16x16x32_bf16 v[168:171], a[116:119], a[20:23], v[168:171]
    ds_read_b64_tr_b16 a[192:193], v220 offset:40960
    ds_read_b64_tr_b16 a[194:195], v220 offset:45056
    v_mfma_f32_16x16x32_bf16 v[168:171], a[120:123], a[24:27], v[168:171]
    v_exp_f32 v161, v161
    v_mfma_f32_16x16x32_bf16 v[168:171], a[124:127], a[28:31], v[168:171]
    ds_read_b64_tr_b16 a[164:165], v221 offset:32768
    v_cvt_pk_bf16_f32 v184, v160, v161
    v_mfma_f32_16x16x32_bf16 v[172:175], a[140:143], a[28:31], v[196:199]
    v_exp_f32 v162, v162
    v_mfma_f32_16x16x32_bf16 v[172:175], a[136:139], a[24:27], v[172:175]
    ds_read_b64_tr_b16 a[166:167], v221 offset:36864
    ds_read_b64_tr_b16 a[196:197], v221 offset:40960
    v_mfma_f32_16x16x32_bf16 v[172:175], a[132:135], a[20:23], v[172:175]
    v_exp_f32 v163, v163
    v_mfma_f32_16x16x32_bf16 v[172:175], a[128:131], a[16:19], v[172:175]
    s_waitcnt lgkmcnt(7)
    ds_read_b64_tr_b16 a[198:199], v221 offset:45056
    v_cvt_pk_bf16_f32 v185, v162, v163
    v_smfmac_f32_16x16x64_bf16 a[232:235], a[208:211], v[176:183], v226
    ds_read_b64_tr_b16 a[168:169], v222 offset:32768
    ds_read_b64_tr_b16 a[170:171], v222 offset:36864
    v_mfma_f32_16x16x32_bf16 v[0:3], v[176:179], a[144:147], v[0:3]
    v_exp_f32 v164, v164
    v_mfma_f32_16x16x32_bf16 v[0:3], v[180:183], a[176:179], v[0:3]
    ds_read_b64_tr_b16 a[200:201], v222 offset:40960
    ds_read_b64_tr_b16 a[202:203], v222 offset:45056
    v_mfma_f32_16x16x32_bf16 v[4:7], v[176:179], a[148:151], v[4:7]
    v_exp_f32 v165, v165
    v_mfma_f32_16x16x32_bf16 v[4:7], v[180:183], a[180:183], v[4:7]
    ds_read_b64_tr_b16 a[172:173], v223 offset:32768
    v_cvt_pk_bf16_f32 v186, v164, v165
    v_mfma_f32_16x16x32_bf16 v[8:11], v[176:179], a[152:155], v[8:11]
    v_exp_f32 v166, v166
    v_mfma_f32_16x16x32_bf16 v[8:11], v[180:183], a[184:187], v[8:11]
    ds_read_b64_tr_b16 a[174:175], v223 offset:36864
    ds_read_b64_tr_b16 a[204:205], v223 offset:40960
    v_mfma_f32_16x16x32_bf16 v[12:15], v[176:179], a[156:159], v[12:15]
    v_exp_f32 v167, v167
    v_mfma_f32_16x16x32_bf16 v[12:15], v[180:183], a[188:191], v[12:15]
    s_waitcnt lgkmcnt(7)
    ds_read_b64_tr_b16 a[206:207], v223 offset:45056
    v_cvt_pk_bf16_f32 v187, v166, v167
    v_mfma_f32_16x16x32_bf16 v[16:19], v[176:179], a[160:163], v[16:19]
    v_exp_f32 v168, v168
    v_mfma_f32_16x16x32_bf16 v[16:19], v[180:183], a[192:195], v[16:19]
    v_mfma_f32_16x16x32_bf16 v[20:23], v[176:179], a[164:167], v[20:23]
    v_exp_f32 v169, v169
    v_mfma_f32_16x16x32_bf16 v[20:23], v[180:183], a[196:199], v[20:23]
    s_waitcnt lgkmcnt(4)
    v_cvt_pk_bf16_f32 v188, v168, v169
    v_mfma_f32_16x16x32_bf16 v[24:27], v[176:179], a[168:171], v[24:27]
    v_exp_f32 v170, v170
    v_mfma_f32_16x16x32_bf16 v[24:27], v[180:183], a[200:203], v[24:27]
    s_waitcnt lgkmcnt(0)
    v_mfma_f32_16x16x32_bf16 v[28:31], v[176:179], a[172:175], v[28:31]
    v_exp_f32 v171, v171
    v_mfma_f32_16x16x32_bf16 v[28:31], v[180:183], a[204:207], v[28:31]
    v_cvt_pk_bf16_f32 v189, v170, v171
    v_mfma_f32_16x16x32_bf16 v[160:163], a[80:83], a[32:35], v[200:203]
    s_add_u32 s31, s31, 1024
    v_exp_f32 v172, v172
    v_mfma_f32_16x16x32_bf16 v[160:163], a[84:87], a[36:39], v[160:163]
    ds_read_b64_tr_b16 v[232:233], v247 offset:1024
    ds_read_b64_tr_b16 v[234:235], v247 offset:1056
    v_mfma_f32_16x16x32_bf16 v[160:163], a[88:91], a[40:43], v[160:163]
    v_exp_f32 v173, v173
    v_mfma_f32_16x16x32_bf16 v[160:163], a[92:95], a[44:47], v[160:163]
    v_cvt_pk_bf16_f32 v190, v172, v173
    v_add_u32 v247, -18432, v247
    v_mfma_f32_16x16x32_bf16 v[164:167], a[108:111], a[44:47], v[200:203]
    v_exp_f32 v174, v174
    v_mfma_f32_16x16x32_bf16 v[164:167], a[104:107], a[40:43], v[164:167]
    v_mfma_f32_16x16x32_bf16 v[164:167], a[100:103], a[36:39], v[164:167]
    v_exp_f32 v175, v175
    v_mfma_f32_16x16x32_bf16 v[164:167], a[96:99], a[32:35], v[164:167]
    v_cvt_pk_bf16_f32 v191, v174, v175
    v_mfma_f32_16x16x32_bf16 v[168:171], a[112:115], a[32:35], v[200:203]
    v_exp_f32 v160, v160
    v_mfma_f32_16x16x32_bf16 v[168:171], a[116:119], a[36:39], v[168:171]
    v_mfma_f32_16x16x32_bf16 v[168:171], a[120:123], a[40:43], v[168:171]
    v_exp_f32 v161, v161
    v_mfma_f32_16x16x32_bf16 v[168:171], a[124:127], a[44:47], v[168:171]
    v_cvt_pk_bf16_f32 v176, v160, v161
    v_mfma_f32_16x16x32_bf16 v[172:175], a[140:143], a[44:47], v[200:203]
    s_waitcnt lgkmcnt(0)
    v_exp_f32 v162, v162
    v_mfma_f32_16x16x32_bf16 v[172:175], a[136:139], a[40:43], v[172:175]
    buffer_store_dwordx4 v[232:235], v229, s[24:27], s31 offen sc0 sc1
    v_mfma_f32_16x16x32_bf16 v[172:175], a[132:135], a[36:39], v[172:175]
    v_exp_f32 v163, v163
    v_mfma_f32_16x16x32_bf16 v[172:175], a[128:131], a[32:35], v[172:175]
    v_cvt_pk_bf16_f32 v177, v162, v163
    v_smfmac_f32_16x16x64_bf16 a[232:235], a[212:215], v[184:191], v226
    v_mfma_f32_16x16x32_bf16 v[32:35], v[184:187], a[144:147], v[32:35]
    s_xor_b32 s47, s36, 1
    v_exp_f32 v164, v164
    v_mfma_f32_16x16x32_bf16 v[32:35], v[188:191], a[176:179], v[32:35]
    s_mul_i32 s47, s47, 81920
    v_max3_f32 v228, abs(v192), abs(v196), abs(v200)
    v_max3_f32 v228, v228, abs(v204), abs(v208)
    v_mfma_f32_16x16x32_bf16 v[36:39], v[184:187], a[148:151], v[36:39]
    s_mul_i32 s48, s35, 20480
    v_exp_f32 v165, v165
    v_mfma_f32_16x16x32_bf16 v[36:39], v[188:191], a[180:183], v[36:39]
    s_add_u32 s47, s47, s48
    s_add_u32 s46, s37, 1
    v_cvt_pk_bf16_f32 v178, v164, v165
    v_mfma_f32_16x16x32_bf16 v[40:43], v[184:187], a[152:155], v[40:43]
    s_mul_i32 s46, s46, 159744
    v_exp_f32 v166, v166
    v_mfma_f32_16x16x32_bf16 v[40:43], v[188:191], a[184:187], v[40:43]
    s_add_u32 s46, s46, s47
    s_add_u32 s24, s10, s46
    s_addc_u32 s25, s11, 0
    v_mfma_f32_16x16x32_bf16 v[44:47], v[184:187], a[156:159], v[44:47]
    s_sub_u32 s47, 159744, s47
    v_exp_f32 v167, v167
    v_mfma_f32_16x16x32_bf16 v[44:47], v[188:191], a[188:191], v[44:47]
    s_min_u32 s26, s47, 20480
    s_mov_b32 s27, 0x20000
    v_cvt_pk_bf16_f32 v179, v166, v167
    v_mfma_f32_16x16x32_bf16 v[48:51], v[184:187], a[160:163], v[48:51]
    v_exp_f32 v168, v168
    v_mfma_f32_16x16x32_bf16 v[48:51], v[188:191], a[192:195], v[48:51]
    v_mfma_f32_16x16x32_bf16 v[52:55], v[184:187], a[164:167], v[52:55]
    v_exp_f32 v169, v169
    v_mfma_f32_16x16x32_bf16 v[52:55], v[188:191], a[196:199], v[52:55]
    v_cvt_pk_bf16_f32 v180, v168, v169
    v_mfma_f32_16x16x32_bf16 v[56:59], v[184:187], a[168:171], v[56:59]
    v_exp_f32 v170, v170
    v_mfma_f32_16x16x32_bf16 v[56:59], v[188:191], a[200:203], v[56:59]
    v_mfma_f32_16x16x32_bf16 v[60:63], v[184:187], a[172:175], v[60:63]
    v_exp_f32 v171, v171
    v_mfma_f32_16x16x32_bf16 v[60:63], v[188:191], a[204:207], v[60:63]
    v_cvt_pk_bf16_f32 v181, v170, v171
    v_mfma_f32_16x16x32_bf16 v[160:163], a[80:83], a[48:51], v[204:207]
    s_waitcnt vmcnt(7)
    v_exp_f32 v172, v172
    v_mfma_f32_16x16x32_bf16 v[160:163], a[84:87], a[52:55], v[160:163]
    ds_inc_u32 v248, v248
    v_mfma_f32_16x16x32_bf16 v[160:163], a[88:91], a[56:59], v[160:163]
    s_add_u32 s69, s69, 4
    v_exp_f32 v173, v173
    v_mfma_f32_16x16x32_bf16 v[160:163], a[92:95], a[60:63], v[160:163]
    v_cvt_pk_bf16_f32 v182, v172, v173
    v_mfma_f32_16x16x32_bf16 v[164:167], a[108:111], a[60:63], v[204:207]
    v_exp_f32 v174, v174
    v_mfma_f32_16x16x32_bf16 v[164:167], a[104:107], a[56:59], v[164:167]
    v_mfma_f32_16x16x32_bf16 v[164:167], a[100:103], a[52:55], v[164:167]
    v_exp_f32 v175, v175
    v_mfma_f32_16x16x32_bf16 v[164:167], a[96:99], a[48:51], v[164:167]
    ds_read_b32 v249, v248
    v_cvt_pk_bf16_f32 v183, v174, v175
    v_mfma_f32_16x16x32_bf16 v[168:171], a[112:115], a[48:51], v[204:207]
    v_exp_f32 v160, v160
    v_mfma_f32_16x16x32_bf16 v[168:171], a[116:119], a[52:55], v[168:171]
    v_mfma_f32_16x16x32_bf16 v[168:171], a[120:123], a[56:59], v[168:171]
    v_exp_f32 v161, v161
    v_mfma_f32_16x16x32_bf16 v[168:171], a[124:127], a[60:63], v[168:171]
    v_cvt_pk_bf16_f32 v184, v160, v161
    v_mfma_f32_16x16x32_bf16 v[172:175], a[140:143], a[60:63], v[204:207]
    v_exp_f32 v162, v162
    v_mfma_f32_16x16x32_bf16 v[172:175], a[136:139], a[56:59], v[172:175]
    v_mfma_f32_16x16x32_bf16 v[172:175], a[132:135], a[52:55], v[172:175]
    v_exp_f32 v163, v163
    v_mfma_f32_16x16x32_bf16 v[172:175], a[128:131], a[48:51], v[172:175]
    s_waitcnt lgkmcnt(0)
    v_cvt_pk_bf16_f32 v185, v162, v163
    v_cmp_gt_u32 vcc, s69, v249
    v_smfmac_f32_16x16x64_bf16 a[232:235], a[216:219], v[176:183], v226
    v_mfma_f32_16x16x32_bf16 v[64:67], v[176:179], a[144:147], v[64:67]
    v_exp_f32 v164, v164
    v_mfma_f32_16x16x32_bf16 v[64:67], v[180:183], a[176:179], v[64:67]
    v_mfma_f32_16x16x32_bf16 v[68:71], v[176:179], a[148:151], v[68:71]
    s_cbranch_vccnz L_wait_fin_1_a
L_go_fin_1_a:
    v_exp_f32 v165, v165
    v_mfma_f32_16x16x32_bf16 v[68:71], v[180:183], a[180:183], v[68:71]
    v_cvt_pk_bf16_f32 v186, v164, v165
    v_mfma_f32_16x16x32_bf16 v[72:75], v[176:179], a[152:155], v[72:75]
    v_exp_f32 v166, v166
    v_mfma_f32_16x16x32_bf16 v[72:75], v[180:183], a[184:187], v[72:75]
    v_mfma_f32_16x16x32_bf16 v[76:79], v[176:179], a[156:159], v[76:79]
    v_exp_f32 v167, v167
    v_mfma_f32_16x16x32_bf16 v[76:79], v[180:183], a[188:191], v[76:79]
    v_cvt_pk_bf16_f32 v187, v166, v167
    v_mfma_f32_16x16x32_bf16 v[80:83], v[176:179], a[160:163], v[80:83]
    v_exp_f32 v168, v168
    v_mfma_f32_16x16x32_bf16 v[80:83], v[180:183], a[192:195], v[80:83]
    v_mfma_f32_16x16x32_bf16 v[84:87], v[176:179], a[164:167], v[84:87]
    v_exp_f32 v169, v169
    v_mfma_f32_16x16x32_bf16 v[84:87], v[180:183], a[196:199], v[84:87]
    v_cvt_pk_bf16_f32 v188, v168, v169
    v_mfma_f32_16x16x32_bf16 v[88:91], v[176:179], a[168:171], v[88:91]
    v_exp_f32 v170, v170
    v_mfma_f32_16x16x32_bf16 v[88:91], v[180:183], a[200:203], v[88:91]
    v_mfma_f32_16x16x32_bf16 v[92:95], v[176:179], a[172:175], v[92:95]
    v_exp_f32 v171, v171
    v_mfma_f32_16x16x32_bf16 v[92:95], v[180:183], a[204:207], v[92:95]
    v_cvt_pk_bf16_f32 v189, v170, v171
    v_mfma_f32_16x16x32_bf16 v[160:163], a[80:83], a[64:67], v[208:211]
    v_exp_f32 v172, v172
    v_mfma_f32_16x16x32_bf16 v[160:163], a[84:87], a[68:71], v[160:163]
    ds_read_b128 a[80:83], v212 offset:16384
    ds_read_b128 a[84:87], v213 offset:16384
    v_mfma_f32_16x16x32_bf16 v[160:163], a[88:91], a[72:75], v[160:163]
    v_exp_f32 v173, v173
    v_mfma_f32_16x16x32_bf16 v[160:163], a[92:95], a[76:79], v[160:163]
    ds_read_b128 a[88:91], v214 offset:16384
    v_cvt_pk_bf16_f32 v190, v172, v173
    v_mfma_f32_16x16x32_bf16 v[164:167], a[108:111], a[76:79], v[208:211]
    v_exp_f32 v174, v174
    v_mfma_f32_16x16x32_bf16 v[164:167], a[104:107], a[72:75], v[164:167]
    ds_read_b128 a[92:95], v215 offset:16384
    ds_read_b128 a[108:111], v215 offset:20480
    v_mfma_f32_16x16x32_bf16 v[164:167], a[100:103], a[68:71], v[164:167]
    v_exp_f32 v175, v175
    v_mfma_f32_16x16x32_bf16 v[164:167], a[96:99], a[64:67], v[164:167]
    ds_read_b128 a[104:107], v214 offset:20480
    v_cvt_pk_bf16_f32 v191, v174, v175
    v_mfma_f32_16x16x32_bf16 v[168:171], a[112:115], a[64:67], v[208:211]
L_page6:
    s_cbranch_execz L_warm
    v_exp_f32 v160, v160
    v_mfma_f32_16x16x32_bf16 v[168:171], a[116:119], a[68:71], v[168:171]
    ds_read_b128 a[100:103], v213 offset:20480
    ds_read_b128 a[96:99], v212 offset:20480
    v_mfma_f32_16x16x32_bf16 v[168:171], a[120:123], a[72:75], v[168:171]
    v_exp_f32 v161, v161
    v_mfma_f32_16x16x32_bf16 v[168:171], a[124:127], a[76:79], v[168:171]
    ds_read_b128 a[112:115], v212 offset:24576
    v_cvt_pk_bf16_f32 v176, v160, v161
    v_mfma_f32_16x16x32_bf16 v[172:175], a[140:143], a[76:79], v[208:211]
    v_exp_f32 v162, v162
    v_mfma_f32_16x16x32_bf16 v[172:175], a[136:139], a[72:75], v[172:175]
    ds_read_b128 a[116:119], v213 offset:24576
    ds_read_b128 a[120:123], v214 offset:24576
    v_mfma_f32_16x16x32_bf16 v[172:175], a[132:135], a[68:71], v[172:175]
    v_exp_f32 v163, v163
    v_mfma_f32_16x16x32_bf16 v[172:175], a[128:131], a[64:67], v[172:175]
    ds_read_b128 a[124:127], v215 offset:24576
    v_cvt_pk_bf16_f32 v177, v162, v163
    v_smfmac_f32_16x16x64_bf16 a[232:235], a[220:223], v[184:191], v226
    ds_read_b128 a[140:143], v215 offset:28672
    ds_read_b128 a[136:139], v214 offset:28672
    v_mfma_f32_16x16x32_bf16 v[96:99], v[184:187], a[144:147], v[96:99]
    v_exp_f32 v164, v164
    v_mfma_f32_16x16x32_bf16 v[96:99], v[188:191], a[176:179], v[96:99]
    ds_read_b128 a[132:135], v213 offset:28672
    ds_read_b128 a[128:131], v212 offset:28672
    v_mfma_f32_16x16x32_bf16 v[100:103], v[184:187], a[148:151], v[100:103]
    v_exp_f32 v165, v165
    v_mfma_f32_16x16x32_bf16 v[100:103], v[188:191], a[180:183], v[100:103]
    v_cvt_pk_bf16_f32 v178, v164, v165
    v_mfma_f32_16x16x32_bf16 v[104:107], v[184:187], a[152:155], v[104:107]
    v_exp_f32 v166, v166
    v_mfma_f32_16x16x32_bf16 v[104:107], v[188:191], a[184:187], v[104:107]
    v_mfma_f32_16x16x32_bf16 v[108:111], v[184:187], a[156:159], v[108:111]
    v_exp_f32 v167, v167
    v_mfma_f32_16x16x32_bf16 v[108:111], v[188:191], a[188:191], v[108:111]
    v_cvt_pk_bf16_f32 v179, v166, v167
    v_mfma_f32_16x16x32_bf16 v[112:115], v[184:187], a[160:163], v[112:115]
    v_exp_f32 v168, v168
    v_mfma_f32_16x16x32_bf16 v[112:115], v[188:191], a[192:195], v[112:115]
    v_mfma_f32_16x16x32_bf16 v[116:119], v[184:187], a[164:167], v[116:119]
    v_exp_f32 v169, v169
    v_mfma_f32_16x16x32_bf16 v[116:119], v[188:191], a[196:199], v[116:119]
    v_cvt_pk_bf16_f32 v180, v168, v169
    v_mfma_f32_16x16x32_bf16 v[120:123], v[184:187], a[168:171], v[120:123]
    s_waitcnt vmcnt(1) lgkmcnt(0)
    v_exp_f32 v170, v170
    v_mfma_f32_16x16x32_bf16 v[120:123], v[188:191], a[200:203], v[120:123]
    ds_inc_u32 v248, v248
    v_mfma_f32_16x16x32_bf16 v[124:127], v[184:187], a[172:175], v[124:127]
    s_add_u32 s69, s69, 4
    v_exp_f32 v171, v171
    v_mfma_f32_16x16x32_bf16 v[124:127], v[188:191], a[204:207], v[124:127]
    v_cvt_pk_bf16_f32 v181, v170, v171
    v_mfma_f32_16x16x32_bf16 v[160:163], a[80:83], a[0:3], v[192:195]
    v_exp_f32 v172, v172
    v_mfma_f32_16x16x32_bf16 v[160:163], a[84:87], a[4:7], v[160:163]
    v_mfma_f32_16x16x32_bf16 v[160:163], a[88:91], a[8:11], v[160:163]
    v_exp_f32 v173, v173
    v_mfma_f32_16x16x32_bf16 v[160:163], a[92:95], a[12:15], v[160:163]
    ds_read_b32 v249, v248
    v_cvt_pk_bf16_f32 v182, v172, v173
    v_mfma_f32_16x16x32_bf16 v[164:167], a[108:111], a[12:15], v[192:195]
    v_exp_f32 v174, v174
    v_mfma_f32_16x16x32_bf16 v[164:167], a[104:107], a[8:11], v[164:167]
    v_mfma_f32_16x16x32_bf16 v[164:167], a[100:103], a[4:7], v[164:167]
    v_exp_f32 v175, v175
    v_mfma_f32_16x16x32_bf16 v[164:167], a[96:99], a[0:3], v[164:167]
    v_cvt_pk_bf16_f32 v183, v174, v175
    v_mfma_f32_16x16x32_bf16 v[168:171], a[112:115], a[0:3], v[192:195]
    v_exp_f32 v160, v160
    v_mfma_f32_16x16x32_bf16 v[168:171], a[116:119], a[4:7], v[168:171]
    v_mfma_f32_16x16x32_bf16 v[168:171], a[120:123], a[8:11], v[168:171]
    v_exp_f32 v161, v161
    v_mfma_f32_16x16x32_bf16 v[168:171], a[124:127], a[12:15], v[168:171]
    s_waitcnt lgkmcnt(0)
    v_cvt_pk_bf16_f32 v184, v160, v161
    v_cmp_gt_u32 vcc, s69, v249
    v_mfma_f32_16x16x32_bf16 v[172:175], a[140:143], a[12:15], v[192:195]
    v_exp_f32 v162, v162
    v_mfma_f32_16x16x32_bf16 v[172:175], a[136:139], a[8:11], v[172:175]
    v_mfma_f32_16x16x32_bf16 v[172:175], a[132:135], a[4:7], v[172:175]
    s_cbranch_vccnz L_wait_fin_1_b
L_go_fin_1_b:
    v_exp_f32 v163, v163
    v_mfma_f32_16x16x32_bf16 v[172:175], a[128:131], a[0:3], v[172:175]
    v_cvt_pk_bf16_f32 v185, v162, v163
    v_smfmac_f32_16x16x64_bf16 a[232:235], a[224:227], v[176:183], v226
    v_mfma_f32_16x16x32_bf16 v[128:131], v[176:179], a[144:147], v[128:131]
    v_exp_f32 v164, v164
    v_mfma_f32_16x16x32_bf16 v[128:131], v[180:183], a[176:179], v[128:131]
    ds_read_b64_tr_b16 a[144:145], v216 offset:49152
    ds_read_b64_tr_b16 a[146:147], v216 offset:53248
    v_mfma_f32_16x16x32_bf16 v[132:135], v[176:179], a[148:151], v[132:135]
    v_exp_f32 v165, v165
    v_mfma_f32_16x16x32_bf16 v[132:135], v[180:183], a[180:183], v[132:135]
    ds_read_b64_tr_b16 a[176:177], v216 offset:57344
    v_cvt_pk_bf16_f32 v186, v164, v165
    v_mfma_f32_16x16x32_bf16 v[136:139], v[176:179], a[152:155], v[136:139]
    v_exp_f32 v166, v166
    v_mfma_f32_16x16x32_bf16 v[136:139], v[180:183], a[184:187], v[136:139]
    ds_read_b64_tr_b16 a[178:179], v216 offset:61440
    ds_read_b64_tr_b16 a[148:149], v217 offset:49152
    v_mfma_f32_16x16x32_bf16 v[140:143], v[176:179], a[156:159], v[140:143]
    v_exp_f32 v167, v167
    v_mfma_f32_16x16x32_bf16 v[140:143], v[180:183], a[188:191], v[140:143]
    ds_read_b64_tr_b16 a[150:151], v217 offset:53248
    v_cvt_pk_bf16_f32 v187, v166, v167
    v_mfma_f32_16x16x32_bf16 v[144:147], v[176:179], a[160:163], v[144:147]
    v_exp_f32 v168, v168
    v_mfma_f32_16x16x32_bf16 v[144:147], v[180:183], a[192:195], v[144:147]
    ds_read_b64_tr_b16 a[180:181], v217 offset:57344
    ds_read_b64_tr_b16 a[182:183], v217 offset:61440
    v_mfma_f32_16x16x32_bf16 v[148:151], v[176:179], a[164:167], v[148:151]
    v_exp_f32 v169, v169
    v_mfma_f32_16x16x32_bf16 v[148:151], v[180:183], a[196:199], v[148:151]
    ds_read_b64_tr_b16 a[152:153], v218 offset:49152
    v_cvt_pk_bf16_f32 v188, v168, v169
    v_mfma_f32_16x16x32_bf16 v[152:155], v[176:179], a[168:171], v[152:155]
    v_exp_f32 v170, v170
    v_mfma_f32_16x16x32_bf16 v[152:155], v[180:183], a[200:203], v[152:155]
    ds_read_b64_tr_b16 a[154:155], v218 offset:53248
    ds_read_b64_tr_b16 a[184:185], v218 offset:57344
    v_mfma_f32_16x16x32_bf16 v[156:159], v[176:179], a[172:175], v[156:159]
    v_exp_f32 v171, v171
    v_mfma_f32_16x16x32_bf16 v[156:159], v[180:183], a[204:207], v[156:159]
    ds_read_b64_tr_b16 a[186:187], v218 offset:61440
    v_cvt_pk_bf16_f32 v189, v170, v171
    v_mfma_f32_16x16x32_bf16 v[160:163], a[80:83], a[16:19], v[196:199]
    v_exp_f32 v172, v172
    v_mfma_f32_16x16x32_bf16 v[160:163], a[84:87], a[20:23], v[160:163]
    ds_read_b64_tr_b16 a[156:157], v219 offset:49152
    ds_read_b64_tr_b16 a[158:159], v219 offset:53248
    v_mfma_f32_16x16x32_bf16 v[160:163], a[88:91], a[24:27], v[160:163]
    v_exp_f32 v173, v173
    v_mfma_f32_16x16x32_bf16 v[160:163], a[92:95], a[28:31], v[160:163]
    ds_read_b64_tr_b16 a[188:189], v219 offset:57344
    v_cvt_pk_bf16_f32 v190, v172, v173
    v_mfma_f32_16x16x32_bf16 v[164:167], a[108:111], a[28:31], v[196:199]
    v_exp_f32 v174, v174
    v_mfma_f32_16x16x32_bf16 v[164:167], a[104:107], a[24:27], v[164:167]
    ds_read_b64_tr_b16 a[190:191], v219 offset:61440
    ds_read_b64_tr_b16 a[160:161], v220 offset:49152
    v_mfma_f32_16x16x32_bf16 v[164:167], a[100:103], a[20:23], v[164:167]
    v_exp_f32 v175, v175
    v_mfma_f32_16x16x32_bf16 v[164:167], a[96:99], a[16:19], v[164:167]
    ds_read_b64_tr_b16 a[162:163], v220 offset:53248
    v_cvt_pk_bf16_f32 v191, v174, v175
    v_mfma_f32_16x16x32_bf16 v[168:171], a[112:115], a[16:19], v[196:199]
    v_exp_f32 v160, v160
    v_mfma_f32_16x16x32_bf16 v[168:171], a[116:119], a[20:23], v[168:171]
    ds_read_b64_tr_b16 a[192:193], v220 offset:57344
    ds_read_b64_tr_b16 a[194:195], v220 offset:61440
    v_mfma_f32_16x16x32_bf16 v[168:171], a[120:123], a[24:27], v[168:171]
    v_exp_f32 v161, v161
    v_mfma_f32_16x16x32_bf16 v[168:171], a[124:127], a[28:31], v[168:171]
    ds_read_b64_tr_b16 a[164:165], v221 offset:49152
    v_cvt_pk_bf16_f32 v176, v160, v161
    v_mfma_f32_16x16x32_bf16 v[172:175], a[140:143], a[28:31], v[196:199]
    v_exp_f32 v162, v162
    v_mfma_f32_16x16x32_bf16 v[172:175], a[136:139], a[24:27], v[172:175]
    ds_read_b64_tr_b16 a[166:167], v221 offset:53248
    ds_read_b64_tr_b16 a[196:197], v221 offset:57344
    v_mfma_f32_16x16x32_bf16 v[172:175], a[132:135], a[20:23], v[172:175]
    v_exp_f32 v163, v163
    v_mfma_f32_16x16x32_bf16 v[172:175], a[128:131], a[16:19], v[172:175]
    s_waitcnt lgkmcnt(7)
    ds_read_b64_tr_b16 a[198:199], v221 offset:61440
    v_cvt_pk_bf16_f32 v177, v162, v163
    v_smfmac_f32_16x16x64_bf16 a[232:235], a[208:211], v[184:191], v226
    ds_read_b64_tr_b16 a[168:169], v222 offset:49152
    ds_read_b64_tr_b16 a[170:171], v222 offset:53248
    v_mfma_f32_16x16x32_bf16 v[0:3], v[184:187], a[144:147], v[0:3]
    v_exp_f32 v164, v164
    v_mfma_f32_16x16x32_bf16 v[0:3], v[188:191], a[176:179], v[0:3]
    ds_read_b64_tr_b16 a[200:201], v222 offset:57344
    ds_read_b64_tr_b16 a[202:203], v222 offset:61440
    v_mfma_f32_16x16x32_bf16 v[4:7], v[184:187], a[148:151], v[4:7]
    v_exp_f32 v165, v165
    v_mfma_f32_16x16x32_bf16 v[4:7], v[188:191], a[180:183], v[4:7]
    ds_read_b64_tr_b16 a[172:173], v223 offset:49152
    v_cvt_pk_bf16_f32 v178, v164, v165
    v_mfma_f32_16x16x32_bf16 v[8:11], v[184:187], a[152:155], v[8:11]
    v_exp_f32 v166, v166
    v_mfma_f32_16x16x32_bf16 v[8:11], v[188:191], a[184:187], v[8:11]
    ds_read_b64_tr_b16 a[174:175], v223 offset:53248
    ds_read_b64_tr_b16 a[204:205], v223 offset:57344
    v_mfma_f32_16x16x32_bf16 v[12:15], v[184:187], a[156:159], v[12:15]
    v_exp_f32 v167, v167
    v_accvgpr_read_b32 v250, a232
    v_mfma_f32_16x16x32_bf16 v[12:15], v[188:191], a[188:191], v[12:15]
    s_waitcnt lgkmcnt(7)
    ds_read_b64_tr_b16 a[206:207], v223 offset:61440
    v_cvt_pk_bf16_f32 v179, v166, v167
    v_accvgpr_read_b32 v243, a233
    v_mfma_f32_16x16x32_bf16 v[16:19], v[184:187], a[160:163], v[16:19]
    v_exp_f32 v168, v168
    v_add_f32 v250, v250, v243
    v_mfma_f32_16x16x32_bf16 v[16:19], v[188:191], a[192:195], v[16:19]
    v_rcp_f32 v243, v250
    v_mfma_f32_16x16x32_bf16 v[20:23], v[184:187], a[164:167], v[20:23]
    v_exp_f32 v169, v169
    v_mfma_f32_16x16x32_bf16 v[20:23], v[188:191], a[196:199], v[20:23]
    s_waitcnt lgkmcnt(4)
    ds_write_b32 v244, v243
    v_cvt_pk_bf16_f32 v180, v168, v169
    v_mfma_f32_16x16x32_bf16 v[24:27], v[184:187], a[168:171], v[24:27]
    v_exp_f32 v170, v170
    v_mfma_f32_16x16x32_bf16 v[24:27], v[188:191], a[200:203], v[24:27]
    s_waitcnt lgkmcnt(1)
    ds_read_b128 v[232:235], v245 offset:0
    v_mfma_f32_16x16x32_bf16 v[28:31], v[184:187], a[172:175], v[28:31]
    v_exp_f32 v171, v171
    v_mfma_f32_16x16x32_bf16 v[28:31], v[188:191], a[204:207], v[28:31]
    v_cvt_pk_bf16_f32 v181, v170, v171
    v_mfma_f32_16x16x32_bf16 v[160:163], a[80:83], a[32:35], v[200:203]
    v_exp_f32 v172, v172
    v_mfma_f32_16x16x32_bf16 v[160:163], a[84:87], a[36:39], v[160:163]
    v_mfma_f32_16x16x32_bf16 v[160:163], a[88:91], a[40:43], v[160:163]
    v_exp_f32 v173, v173
    v_mfma_f32_16x16x32_bf16 v[160:163], a[92:95], a[44:47], v[160:163]
    v_cvt_pk_bf16_f32 v182, v172, v173
    v_mfma_f32_16x16x32_bf16 v[164:167], a[108:111], a[44:47], v[200:203]
    s_waitcnt lgkmcnt(0)
    v_exp_f32 v174, v174
    v_pk_mul_f32 v[0:1], v[0:1], v[232:233]
    v_pk_mul_f32 v[2:3], v[2:3], v[234:235]
    v_pk_mul_f32 v[4:5], v[4:5], v[232:233]
    v_pk_mul_f32 v[6:7], v[6:7], v[234:235]
    v_pk_mul_f32 v[8:9], v[8:9], v[232:233]
    v_pk_mul_f32 v[10:11], v[10:11], v[234:235]
    v_pk_mul_f32 v[12:13], v[12:13], v[232:233]
    v_pk_mul_f32 v[14:15], v[14:15], v[234:235]
    v_pk_mul_f32 v[16:17], v[16:17], v[232:233]
    v_pk_mul_f32 v[18:19], v[18:19], v[234:235]
    v_pk_mul_f32 v[20:21], v[20:21], v[232:233]
    v_pk_mul_f32 v[22:23], v[22:23], v[234:235]
    v_pk_mul_f32 v[24:25], v[24:25], v[232:233]
    v_pk_mul_f32 v[26:27], v[26:27], v[234:235]
    v_pk_mul_f32 v[28:29], v[28:29], v[232:233]
    v_pk_mul_f32 v[30:31], v[30:31], v[234:235]
    v_mfma_f32_16x16x32_bf16 v[164:167], a[104:107], a[40:43], v[164:167]
    v_cvt_pk_bf16_f32 v0, v0, v4
    v_cvt_pk_bf16_f32 v4, v1, v5
    v_cvt_pk_bf16_f32 v1, v8, v12
    v_mfma_f32_16x16x32_bf16 v[164:167], a[100:103], a[36:39], v[164:167]
    v_exp_f32 v175, v175
    v_mfma_f32_16x16x32_bf16 v[164:167], a[96:99], a[32:35], v[164:167]
    ds_write_b64 v246, v[0:1] offset:0
    v_cvt_pk_bf16_f32 v183, v174, v175
    v_mfma_f32_16x16x32_bf16 v[168:171], a[112:115], a[32:35], v[200:203]
    v_exp_f32 v160, v160
    v_cvt_pk_bf16_f32 v5, v9, v13
    v_mfma_f32_16x16x32_bf16 v[168:171], a[116:119], a[36:39], v[168:171]
    ds_write_b64 v246, v[4:5] offset:256
    v_cvt_pk_bf16_f32 v2, v2, v6
    v_mfma_f32_16x16x32_bf16 v[168:171], a[120:123], a[40:43], v[168:171]
    v_exp_f32 v161, v161
    v_cvt_pk_bf16_f32 v6, v3, v7
    v_cvt_pk_bf16_f32 v3, v10, v14
    v_mfma_f32_16x16x32_bf16 v[168:171], a[124:127], a[44:47], v[168:171]
    ds_write_b64 v246, v[2:3] offset:512
    v_cvt_pk_bf16_f32 v184, v160, v161
    v_mfma_f32_16x16x32_bf16 v[172:175], a[140:143], a[44:47], v[200:203]
    v_exp_f32 v162, v162
    v_cvt_pk_bf16_f32 v7, v11, v15
    v_mfma_f32_16x16x32_bf16 v[172:175], a[136:139], a[40:43], v[172:175]
    ds_write_b64 v246, v[6:7] offset:768
    v_cvt_pk_bf16_f32 v16, v16, v20
    v_mfma_f32_16x16x32_bf16 v[172:175], a[132:135], a[36:39], v[172:175]
    v_exp_f32 v163, v163
    v_cvt_pk_bf16_f32 v20, v17, v21
    v_cvt_pk_bf16_f32 v17, v24, v28
    v_mfma_f32_16x16x32_bf16 v[172:175], a[128:131], a[32:35], v[172:175]
    ds_write_b64 v246, v[16:17] offset:128
    v_cvt_pk_bf16_f32 v185, v162, v163
    v_cvt_pk_bf16_f32 v21, v25, v29
    v_smfmac_f32_16x16x64_bf16 a[232:235], a[212:215], v[176:183], v226
    ds_write_b64 v246, v[20:21] offset:384
    v_cvt_pk_bf16_f32 v18, v18, v22
    v_mfma_f32_16x16x32_bf16 v[32:35], v[176:179], a[144:147], v[32:35]
    v_exp_f32 v164, v164
    v_cvt_pk_bf16_f32 v22, v19, v23
    v_cvt_pk_bf16_f32 v19, v26, v30
    v_mfma_f32_16x16x32_bf16 v[32:35], v[180:183], a[176:179], v[32:35]
    ds_write_b64 v246, v[18:19] offset:640
    v_cvt_pk_bf16_f32 v23, v27, v31
    v_mfma_f32_16x16x32_bf16 v[36:39], v[176:179], a[148:151], v[36:39]
    ds_write_b64 v246, v[22:23] offset:896
    v_exp_f32 v165, v165
    v_mfma_f32_16x16x32_bf16 v[36:39], v[180:183], a[180:183], v[36:39]
    ds_read_b64_tr_b16 v[0:1], v247 offset:0
    ds_read_b64_tr_b16 v[2:3], v247 offset:32
    ds_read_b64_tr_b16 v[4:5], v247 offset:1024
    v_cvt_pk_bf16_f32 v186, v164, v165
    v_mfma_f32_16x16x32_bf16 v[40:43], v[176:179], a[152:155], v[40:43]
    ds_read_b64_tr_b16 v[6:7], v247 offset:1056
    ds_read_b64_tr_b16 v[8:9], v247 offset:2048
    v_exp_f32 v166, v166
    v_mfma_f32_16x16x32_bf16 v[40:43], v[180:183], a[184:187], v[40:43]
    ds_read_b64_tr_b16 v[10:11], v247 offset:2080
    ds_read_b64_tr_b16 v[12:13], v247 offset:3072
    ds_read_b64_tr_b16 v[14:15], v247 offset:3104
    v_mfma_f32_16x16x32_bf16 v[44:47], v[176:179], a[156:159], v[44:47]
    v_exp_f32 v167, v167
    v_accvgpr_read_b32 v250, a234
    v_mfma_f32_16x16x32_bf16 v[44:47], v[180:183], a[188:191], v[44:47]
    v_cvt_pk_bf16_f32 v187, v166, v167
    v_accvgpr_read_b32 v243, a235
    v_add_f32 v250, v250, v243
    v_mfma_f32_16x16x32_bf16 v[48:51], v[176:179], a[160:163], v[48:51]
    v_exp_f32 v168, v168
    v_rcp_f32 v243, v250
    v_mfma_f32_16x16x32_bf16 v[48:51], v[180:183], a[192:195], v[48:51]
    ds_write_b32 v244, v243
    v_mfma_f32_16x16x32_bf16 v[52:55], v[176:179], a[164:167], v[52:55]
    ds_read_b128 v[236:239], v245 offset:0
    v_exp_f32 v169, v169
    v_mfma_f32_16x16x32_bf16 v[52:55], v[180:183], a[196:199], v[52:55]
    s_waitcnt lgkmcnt(8)
    buffer_store_dwordx4 v[0:3], v229, s[24:27], s40 offen offset:0 sc0 sc1
    v_cvt_pk_bf16_f32 v188, v168, v169
    v_mfma_f32_16x16x32_bf16 v[56:59], v[176:179], a[168:171], v[56:59]
    v_exp_f32 v170, v170
    v_mfma_f32_16x16x32_bf16 v[56:59], v[180:183], a[200:203], v[56:59]
    s_waitcnt lgkmcnt(6)
    buffer_store_dwordx4 v[4:7], v229, s[24:27], s40 offen offset:1024 sc0 sc1
    v_mfma_f32_16x16x32_bf16 v[60:63], v[176:179], a[172:175], v[60:63]
    v_exp_f32 v171, v171
    v_mfma_f32_16x16x32_bf16 v[60:63], v[180:183], a[204:207], v[60:63]
    s_waitcnt lgkmcnt(4)
    buffer_store_dwordx4 v[8:11], v229, s[24:27], s40 offen offset:2048 sc0 sc1
    v_cvt_pk_bf16_f32 v189, v170, v171
    v_mfma_f32_16x16x32_bf16 v[160:163], a[80:83], a[48:51], v[204:207]
    v_exp_f32 v172, v172
    v_mfma_f32_16x16x32_bf16 v[160:163], a[84:87], a[52:55], v[160:163]
    s_waitcnt lgkmcnt(2)
    buffer_store_dwordx4 v[12:15], v229, s[24:27], s40 offen offset:3072 sc0 sc1
    v_mfma_f32_16x16x32_bf16 v[160:163], a[88:91], a[56:59], v[160:163]
    v_exp_f32 v173, v173
    v_mfma_f32_16x16x32_bf16 v[160:163], a[92:95], a[60:63], v[160:163]
    v_cvt_pk_bf16_f32 v190, v172, v173
    v_mfma_f32_16x16x32_bf16 v[164:167], a[108:111], a[60:63], v[204:207]
    s_waitcnt lgkmcnt(0)
    v_exp_f32 v174, v174
    v_pk_mul_f32 v[32:33], v[32:33], v[236:237]
    v_pk_mul_f32 v[34:35], v[34:35], v[238:239]
    v_pk_mul_f32 v[36:37], v[36:37], v[236:237]
    v_pk_mul_f32 v[38:39], v[38:39], v[238:239]
    v_pk_mul_f32 v[40:41], v[40:41], v[236:237]
    v_pk_mul_f32 v[42:43], v[42:43], v[238:239]
    v_pk_mul_f32 v[44:45], v[44:45], v[236:237]
    v_pk_mul_f32 v[46:47], v[46:47], v[238:239]
    v_pk_mul_f32 v[48:49], v[48:49], v[236:237]
    v_pk_mul_f32 v[50:51], v[50:51], v[238:239]
    v_pk_mul_f32 v[52:53], v[52:53], v[236:237]
    v_pk_mul_f32 v[54:55], v[54:55], v[238:239]
    v_pk_mul_f32 v[56:57], v[56:57], v[236:237]
    v_pk_mul_f32 v[58:59], v[58:59], v[238:239]
    v_pk_mul_f32 v[60:61], v[60:61], v[236:237]
    v_pk_mul_f32 v[62:63], v[62:63], v[238:239]
    v_mfma_f32_16x16x32_bf16 v[164:167], a[104:107], a[56:59], v[164:167]
    v_cvt_pk_bf16_f32 v32, v32, v36
    v_cvt_pk_bf16_f32 v36, v33, v37
    v_cvt_pk_bf16_f32 v33, v40, v44
    v_mfma_f32_16x16x32_bf16 v[164:167], a[100:103], a[52:55], v[164:167]
    v_exp_f32 v175, v175
    v_mfma_f32_16x16x32_bf16 v[164:167], a[96:99], a[48:51], v[164:167]
    ds_write_b64 v246, v[32:33] offset:4096
    v_cvt_pk_bf16_f32 v191, v174, v175
    v_mfma_f32_16x16x32_bf16 v[168:171], a[112:115], a[48:51], v[204:207]
    v_exp_f32 v160, v160
    v_cvt_pk_bf16_f32 v37, v41, v45
    v_mfma_f32_16x16x32_bf16 v[168:171], a[116:119], a[52:55], v[168:171]
    ds_write_b64 v246, v[36:37] offset:4352
    v_cvt_pk_bf16_f32 v34, v34, v38
    v_mfma_f32_16x16x32_bf16 v[168:171], a[120:123], a[56:59], v[168:171]
    v_exp_f32 v161, v161
    v_cvt_pk_bf16_f32 v38, v35, v39
    v_cvt_pk_bf16_f32 v35, v42, v46
    v_mfma_f32_16x16x32_bf16 v[168:171], a[124:127], a[60:63], v[168:171]
    ds_write_b64 v246, v[34:35] offset:4608
    v_cvt_pk_bf16_f32 v176, v160, v161
    v_mfma_f32_16x16x32_bf16 v[172:175], a[140:143], a[60:63], v[204:207]
    v_exp_f32 v162, v162
    v_cvt_pk_bf16_f32 v39, v43, v47
    v_mfma_f32_16x16x32_bf16 v[172:175], a[136:139], a[56:59], v[172:175]
    ds_write_b64 v246, v[38:39] offset:4864
    v_cvt_pk_bf16_f32 v48, v48, v52
    v_mfma_f32_16x16x32_bf16 v[172:175], a[132:135], a[52:55], v[172:175]
    v_exp_f32 v163, v163
    v_cvt_pk_bf16_f32 v52, v49, v53
    v_cvt_pk_bf16_f32 v49, v56, v60
    v_mfma_f32_16x16x32_bf16 v[172:175], a[128:131], a[48:51], v[172:175]
    ds_write_b64 v246, v[48:49] offset:4224
    v_cvt_pk_bf16_f32 v177, v162, v163
    v_cvt_pk_bf16_f32 v53, v57, v61
    v_smfmac_f32_16x16x64_bf16 a[232:235], a[216:219], v[184:191], v226
    ds_write_b64 v246, v[52:53] offset:4480
    v_cvt_pk_bf16_f32 v50, v50, v54
    v_mfma_f32_16x16x32_bf16 v[64:67], v[184:187], a[144:147], v[64:67]
    v_exp_f32 v164, v164
    v_cvt_pk_bf16_f32 v54, v51, v55
    v_cvt_pk_bf16_f32 v51, v58, v62
    v_mfma_f32_16x16x32_bf16 v[64:67], v[188:191], a[176:179], v[64:67]
    ds_write_b64 v246, v[50:51] offset:4736
    v_cvt_pk_bf16_f32 v55, v59, v63
    v_mfma_f32_16x16x32_bf16 v[68:71], v[184:187], a[148:151], v[68:71]
    ds_write_b64 v246, v[54:55] offset:4992
    v_exp_f32 v165, v165
    v_mfma_f32_16x16x32_bf16 v[68:71], v[188:191], a[180:183], v[68:71]
    ds_read_b64_tr_b16 v[32:33], v247 offset:4096
    ds_read_b64_tr_b16 v[34:35], v247 offset:4128
    ds_read_b64_tr_b16 v[36:37], v247 offset:5120
    v_cvt_pk_bf16_f32 v178, v164, v165
    v_mfma_f32_16x16x32_bf16 v[72:75], v[184:187], a[152:155], v[72:75]
    ds_read_b64_tr_b16 v[38:39], v247 offset:5152
    ds_read_b64_tr_b16 v[40:41], v247 offset:6144
    v_exp_f32 v166, v166
    v_mfma_f32_16x16x32_bf16 v[72:75], v[188:191], a[184:187], v[72:75]
    ds_read_b64_tr_b16 v[42:43], v247 offset:6176
    ds_read_b64_tr_b16 v[44:45], v247 offset:7168
    ds_read_b64_tr_b16 v[46:47], v247 offset:7200
    v_mfma_f32_16x16x32_bf16 v[76:79], v[184:187], a[156:159], v[76:79]
    v_exp_f32 v167, v167
    v_accvgpr_read_b32 v250, a232
    v_mfma_f32_16x16x32_bf16 v[76:79], v[188:191], a[188:191], v[76:79]
    v_cvt_pk_bf16_f32 v179, v166, v167
    v_accvgpr_read_b32 v243, a233
    v_add_f32 v250, v250, v243
    v_mfma_f32_16x16x32_bf16 v[80:83], v[184:187], a[160:163], v[80:83]
    v_exp_f32 v168, v168
    v_rcp_f32 v243, v250
    v_mfma_f32_16x16x32_bf16 v[80:83], v[188:191], a[192:195], v[80:83]
    ds_write_b32 v244, v243
    v_mfma_f32_16x16x32_bf16 v[84:87], v[184:187], a[164:167], v[84:87]
    ds_read_b128 v[232:235], v245 offset:64
    v_exp_f32 v169, v169
    v_mfma_f32_16x16x32_bf16 v[84:87], v[188:191], a[196:199], v[84:87]
    s_waitcnt lgkmcnt(8)
    buffer_store_dwordx4 v[32:35], v229, s[24:27], s41 offen offset:0 sc0 sc1
    v_cvt_pk_bf16_f32 v180, v168, v169
    v_mfma_f32_16x16x32_bf16 v[88:91], v[184:187], a[168:171], v[88:91]
    v_exp_f32 v170, v170
    v_mfma_f32_16x16x32_bf16 v[88:91], v[188:191], a[200:203], v[88:91]
    s_waitcnt lgkmcnt(6)
    buffer_store_dwordx4 v[36:39], v229, s[24:27], s41 offen offset:1024 sc0 sc1
    v_mfma_f32_16x16x32_bf16 v[92:95], v[184:187], a[172:175], v[92:95]
    v_exp_f32 v171, v171
    v_mfma_f32_16x16x32_bf16 v[92:95], v[188:191], a[204:207], v[92:95]
    s_waitcnt lgkmcnt(4)
    buffer_store_dwordx4 v[40:43], v229, s[24:27], s41 offen offset:2048 sc0 sc1
    v_cvt_pk_bf16_f32 v181, v170, v171
    v_mfma_f32_16x16x32_bf16 v[160:163], a[80:83], a[64:67], v[208:211]
    v_exp_f32 v172, v172
    v_mfma_f32_16x16x32_bf16 v[160:163], a[84:87], a[68:71], v[160:163]
    s_waitcnt lgkmcnt(2)
    buffer_store_dwordx4 v[44:47], v229, s[24:27], s41 offen offset:3072 sc0 sc1
    v_mfma_f32_16x16x32_bf16 v[160:163], a[88:91], a[72:75], v[160:163]
    v_exp_f32 v173, v173
    v_mfma_f32_16x16x32_bf16 v[160:163], a[92:95], a[76:79], v[160:163]
    v_cvt_pk_bf16_f32 v182, v172, v173
    v_mfma_f32_16x16x32_bf16 v[164:167], a[108:111], a[76:79], v[208:211]
    s_waitcnt lgkmcnt(0)
    v_exp_f32 v174, v174
    v_pk_mul_f32 v[64:65], v[64:65], v[232:233]
    v_pk_mul_f32 v[66:67], v[66:67], v[234:235]
    v_pk_mul_f32 v[68:69], v[68:69], v[232:233]
    v_pk_mul_f32 v[70:71], v[70:71], v[234:235]
    v_pk_mul_f32 v[72:73], v[72:73], v[232:233]
    v_pk_mul_f32 v[74:75], v[74:75], v[234:235]
    v_pk_mul_f32 v[76:77], v[76:77], v[232:233]
    v_pk_mul_f32 v[78:79], v[78:79], v[234:235]
    v_pk_mul_f32 v[80:81], v[80:81], v[232:233]
    v_pk_mul_f32 v[82:83], v[82:83], v[234:235]
    v_pk_mul_f32 v[84:85], v[84:85], v[232:233]
    v_pk_mul_f32 v[86:87], v[86:87], v[234:235]
    v_pk_mul_f32 v[88:89], v[88:89], v[232:233]
    v_pk_mul_f32 v[90:91], v[90:91], v[234:235]
    v_pk_mul_f32 v[92:93], v[92:93], v[232:233]
    v_pk_mul_f32 v[94:95], v[94:95], v[234:235]
    v_mfma_f32_16x16x32_bf16 v[164:167], a[104:107], a[72:75], v[164:167]
    v_cvt_pk_bf16_f32 v64, v64, v68
    v_cvt_pk_bf16_f32 v68, v65, v69
    v_cvt_pk_bf16_f32 v65, v72, v76
    v_mfma_f32_16x16x32_bf16 v[164:167], a[100:103], a[68:71], v[164:167]
    v_exp_f32 v175, v175
    v_mfma_f32_16x16x32_bf16 v[164:167], a[96:99], a[64:67], v[164:167]
    ds_write_b64 v246, v[64:65] offset:8192
    v_cvt_pk_bf16_f32 v183, v174, v175
    v_mfma_f32_16x16x32_bf16 v[168:171], a[112:115], a[64:67], v[208:211]
    v_exp_f32 v160, v160
    v_cvt_pk_bf16_f32 v69, v73, v77
    v_mfma_f32_16x16x32_bf16 v[168:171], a[116:119], a[68:71], v[168:171]
    ds_write_b64 v246, v[68:69] offset:8448
    v_cvt_pk_bf16_f32 v66, v66, v70
    v_mfma_f32_16x16x32_bf16 v[168:171], a[120:123], a[72:75], v[168:171]
    v_exp_f32 v161, v161
    v_cvt_pk_bf16_f32 v70, v67, v71
    v_cvt_pk_bf16_f32 v67, v74, v78
    v_mfma_f32_16x16x32_bf16 v[168:171], a[124:127], a[76:79], v[168:171]
    ds_write_b64 v246, v[66:67] offset:8704
    v_cvt_pk_bf16_f32 v184, v160, v161
    v_mfma_f32_16x16x32_bf16 v[172:175], a[140:143], a[76:79], v[208:211]
    v_exp_f32 v162, v162
    v_cvt_pk_bf16_f32 v71, v75, v79
    v_mfma_f32_16x16x32_bf16 v[172:175], a[136:139], a[72:75], v[172:175]
    ds_write_b64 v246, v[70:71] offset:8960
    v_cvt_pk_bf16_f32 v80, v80, v84
    v_mfma_f32_16x16x32_bf16 v[172:175], a[132:135], a[68:71], v[172:175]
    v_exp_f32 v163, v163
    v_cvt_pk_bf16_f32 v84, v81, v85
    v_cvt_pk_bf16_f32 v81, v88, v92
    v_mfma_f32_16x16x32_bf16 v[172:175], a[128:131], a[64:67], v[172:175]
    ds_write_b64 v246, v[80:81] offset:8320
    v_cvt_pk_bf16_f32 v185, v162, v163
    v_cvt_pk_bf16_f32 v85, v89, v93
    v_smfmac_f32_16x16x64_bf16 a[232:235], a[220:223], v[176:183], v226
    ds_write_b64 v246, v[84:85] offset:8576
    v_cvt_pk_bf16_f32 v82, v82, v86
    v_mfma_f32_16x16x32_bf16 v[96:99], v[176:179], a[144:147], v[96:99]
    v_exp_f32 v164, v164
    v_cvt_pk_bf16_f32 v86, v83, v87
    v_cvt_pk_bf16_f32 v83, v90, v94
    v_mfma_f32_16x16x32_bf16 v[96:99], v[180:183], a[176:179], v[96:99]
    ds_write_b64 v246, v[82:83] offset:8832
    v_cvt_pk_bf16_f32 v87, v91, v95
    v_mfma_f32_16x16x32_bf16 v[100:103], v[176:179], a[148:151], v[100:103]
    ds_write_b64 v246, v[86:87] offset:9088
    v_exp_f32 v165, v165
    v_mfma_f32_16x16x32_bf16 v[100:103], v[180:183], a[180:183], v[100:103]
    ds_read_b64_tr_b16 v[64:65], v247 offset:8192
    ds_read_b64_tr_b16 v[66:67], v247 offset:8224
    ds_read_b64_tr_b16 v[68:69], v247 offset:9216
    ds_read_b64_tr_b16 v[70:71], v247 offset:9248
    v_cvt_pk_bf16_f32 v186, v164, v165
    v_mfma_f32_16x16x32_bf16 v[104:107], v[176:179], a[152:155], v[104:107]
    ds_read_b64_tr_b16 v[72:73], v247 offset:10240
    ds_read_b64_tr_b16 v[74:75], v247 offset:10272
    v_exp_f32 v166, v166
    v_mfma_f32_16x16x32_bf16 v[104:107], v[180:183], a[184:187], v[104:107]
    ds_read_b64_tr_b16 v[76:77], v247 offset:11264
    ds_read_b64_tr_b16 v[78:79], v247 offset:11296
    v_exp_f32 v172, v172
    v_mfma_f32_16x16x32_bf16 v[108:111], v[176:179], a[156:159], v[108:111]
    v_exp_f32 v167, v167
    v_accvgpr_read_b32 v227, a234
    v_accvgpr_read_b32 v243, a235
    v_mfma_f32_16x16x32_bf16 v[108:111], v[180:183], a[188:191], v[108:111]
    v_cvt_pk_bf16_f32 v187, v166, v167
    v_exp_f32 v173, v173
    v_add_f32 v227, v227, v243
    v_mfma_f32_16x16x32_bf16 v[112:115], v[176:179], a[160:163], v[112:115]
    v_exp_f32 v168, v168
    v_cvt_pk_bf16_f32 v190, v172, v173
    v_mfma_f32_16x16x32_bf16 v[112:115], v[180:183], a[192:195], v[112:115]
    v_exp_f32 v174, v174
    v_rcp_f32 v243, v227
    v_mfma_f32_16x16x32_bf16 v[116:119], v[176:179], a[164:167], v[116:119]
    ds_write_b32 v244, v243
    v_exp_f32 v169, v169
    v_mfma_f32_16x16x32_bf16 v[116:119], v[180:183], a[196:199], v[116:119]
    ds_read_b128 v[236:239], v245 offset:64
    v_cvt_pk_bf16_f32 v188, v168, v169
    v_exp_f32 v175, v175
    v_mfma_f32_16x16x32_bf16 v[120:123], v[176:179], a[168:171], v[120:123]
    v_exp_f32 v170, v170
    v_mfma_f32_16x16x32_bf16 v[120:123], v[180:183], a[200:203], v[120:123]
    s_waitcnt lgkmcnt(8)
    buffer_store_dwordx4 v[64:67], v229, s[24:27], s42 offen offset:0 sc0 sc1
    v_cvt_pk_bf16_f32 v191, v174, v175
    v_mfma_f32_16x16x32_bf16 v[124:127], v[176:179], a[172:175], v[124:127]
L_page7:
    s_cbranch_execz L_warm
    v_exp_f32 v171, v171
    v_mfma_f32_16x16x32_bf16 v[124:127], v[180:183], a[204:207], v[124:127]
    v_cvt_pk_bf16_f32 v189, v170, v171
    s_nop 1
    v_smfmac_f32_16x16x64_bf16 a[232:235], a[224:227], v[184:191], v226
    s_waitcnt lgkmcnt(6)
    buffer_store_dwordx4 v[68:71], v229, s[24:27], s42 offen offset:1024 sc0 sc1
    v_mfma_f32_16x16x32_bf16 v[128:131], v[184:187], a[144:147], v[128:131]
    v_mfma_f32_16x16x32_bf16 v[128:131], v[188:191], a[176:179], v[128:131]
    s_waitcnt lgkmcnt(4)
    buffer_store_dwordx4 v[72:75], v229, s[24:27], s42 offen offset:2048 sc0 sc1
    v_mfma_f32_16x16x32_bf16 v[132:135], v[184:187], a[148:151], v[132:135]
    s_waitcnt lgkmcnt(0)
    v_pk_mul_f32 v[96:97], v[96:97], v[236:237]
    v_pk_mul_f32 v[98:99], v[98:99], v[238:239]
    v_pk_mul_f32 v[100:101], v[100:101], v[236:237]
    v_pk_mul_f32 v[102:103], v[102:103], v[238:239]
    v_pk_mul_f32 v[104:105], v[104:105], v[236:237]
    v_pk_mul_f32 v[106:107], v[106:107], v[238:239]
    v_pk_mul_f32 v[108:109], v[108:109], v[236:237]
    v_pk_mul_f32 v[110:111], v[110:111], v[238:239]
    v_pk_mul_f32 v[112:113], v[112:113], v[236:237]
    v_pk_mul_f32 v[114:115], v[114:115], v[238:239]
    v_pk_mul_f32 v[116:117], v[116:117], v[236:237]
    v_pk_mul_f32 v[118:119], v[118:119], v[238:239]
    v_pk_mul_f32 v[120:121], v[120:121], v[236:237]
    v_pk_mul_f32 v[122:123], v[122:123], v[238:239]
    v_pk_mul_f32 v[124:125], v[124:125], v[236:237]
    v_pk_mul_f32 v[126:127], v[126:127], v[238:239]
    v_mfma_f32_16x16x32_bf16 v[132:135], v[188:191], a[180:183], v[132:135]
    s_waitcnt lgkmcnt(2)
    buffer_store_dwordx4 v[76:79], v229, s[24:27], s42 offen offset:3072 sc0 sc1
    v_cvt_pk_bf16_f32 v96, v96, v100
    v_cvt_pk_bf16_f32 v100, v97, v101
    v_cvt_pk_bf16_f32 v97, v104, v108
    v_mfma_f32_16x16x32_bf16 v[136:139], v[184:187], a[152:155], v[136:139]
    ds_write_b64 v246, v[96:97] offset:12288
    v_accvgpr_read_b32 v250, a232
    v_accvgpr_read_b32 v243, a233
    v_add_f32 v250, v250, v243
    v_rcp_f32 v243, v250
    v_cvt_pk_bf16_f32 v101, v105, v109
    v_mfma_f32_16x16x32_bf16 v[136:139], v[188:191], a[184:187], v[136:139]
    ds_write_b32 v244, v243
    ds_write_b64 v246, v[100:101] offset:12544
    v_cvt_pk_bf16_f32 v98, v98, v102
    v_cvt_pk_bf16_f32 v102, v99, v103
    v_cvt_pk_bf16_f32 v99, v106, v110
    v_mfma_f32_16x16x32_bf16 v[140:143], v[184:187], a[156:159], v[140:143]
    ds_read_b128 v[232:235], v245 offset:128
    ds_write_b64 v246, v[98:99] offset:12800
    v_cvt_pk_bf16_f32 v103, v107, v111
    v_mfma_f32_16x16x32_bf16 v[140:143], v[188:191], a[188:191], v[140:143]
    ds_write_b64 v246, v[102:103] offset:13056
    v_cvt_pk_bf16_f32 v112, v112, v116
    v_cvt_pk_bf16_f32 v116, v113, v117
    v_cvt_pk_bf16_f32 v113, v120, v124
    v_mfma_f32_16x16x32_bf16 v[144:147], v[184:187], a[160:163], v[144:147]
    ds_write_b64 v246, v[112:113] offset:12416
    v_cvt_pk_bf16_f32 v117, v121, v125
    v_mfma_f32_16x16x32_bf16 v[144:147], v[188:191], a[192:195], v[144:147]
    ds_write_b64 v246, v[116:117] offset:12672
    v_cvt_pk_bf16_f32 v114, v114, v118
    v_cvt_pk_bf16_f32 v118, v115, v119
    v_cvt_pk_bf16_f32 v115, v122, v126
    v_mfma_f32_16x16x32_bf16 v[148:151], v[184:187], a[164:167], v[148:151]
    ds_write_b64 v246, v[114:115] offset:12928
    v_cvt_pk_bf16_f32 v119, v123, v127
    v_mfma_f32_16x16x32_bf16 v[148:151], v[188:191], a[196:199], v[148:151]
    ds_write_b64 v246, v[118:119] offset:13184
    v_mfma_f32_16x16x32_bf16 v[152:155], v[184:187], a[168:171], v[152:155]
    ds_read_b64_tr_b16 v[96:97], v247 offset:12288
    ds_read_b64_tr_b16 v[98:99], v247 offset:12320
    ds_read_b64_tr_b16 v[100:101], v247 offset:13312
    ds_read_b64_tr_b16 v[102:103], v247 offset:13344
    ds_read_b64_tr_b16 v[104:105], v247 offset:14336
    ds_read_b64_tr_b16 v[106:107], v247 offset:14368
    ds_read_b64_tr_b16 v[108:109], v247 offset:15360
    ds_read_b64_tr_b16 v[110:111], v247 offset:15392
    v_mfma_f32_16x16x32_bf16 v[152:155], v[188:191], a[200:203], v[152:155]
    s_waitcnt lgkmcnt(14)
    v_pk_mul_f32 v[128:129], v[128:129], v[232:233]
    v_pk_mul_f32 v[130:131], v[130:131], v[234:235]
    v_pk_mul_f32 v[132:133], v[132:133], v[232:233]
    v_pk_mul_f32 v[134:135], v[134:135], v[234:235]
    v_pk_mul_f32 v[136:137], v[136:137], v[232:233]
    v_pk_mul_f32 v[138:139], v[138:139], v[234:235]
    v_pk_mul_f32 v[140:141], v[140:141], v[232:233]
    v_pk_mul_f32 v[142:143], v[142:143], v[234:235]
    v_mfma_f32_16x16x32_bf16 v[156:159], v[184:187], a[172:175], v[156:159]
    s_waitcnt lgkmcnt(6)
    buffer_store_dwordx4 v[96:99], v229, s[24:27], s43 offen offset:0 sc0 sc1
    v_mfma_f32_16x16x32_bf16 v[156:159], v[188:191], a[204:207], v[156:159]
    s_waitcnt lgkmcnt(4)
    buffer_store_dwordx4 v[100:103], v229, s[24:27], s43 offen offset:1024 sc0 sc1
    s_waitcnt lgkmcnt(2)
    buffer_store_dwordx4 v[104:107], v229, s[24:27], s43 offen offset:2048 sc0 sc1
    s_waitcnt lgkmcnt(0)
    buffer_store_dwordx4 v[108:111], v229, s[24:27], s43 offen offset:3072 sc0 sc1
    v_cvt_pk_bf16_f32 v128, v128, v132
    v_cvt_pk_bf16_f32 v132, v129, v133
    v_cvt_pk_bf16_f32 v129, v136, v140
    v_cvt_pk_bf16_f32 v133, v137, v141
    v_cvt_pk_bf16_f32 v130, v130, v134
    v_cvt_pk_bf16_f32 v134, v131, v135
    v_cvt_pk_bf16_f32 v131, v138, v142
    v_cvt_pk_bf16_f32 v135, v139, v143
    ds_write_b64 v246, v[128:129] offset:16384
    ds_write_b64 v246, v[132:133] offset:16640
    ds_write_b64 v246, v[130:131] offset:16896
    ds_write_b64 v246, v[134:135] offset:17152
    v_pk_mul_f32 v[144:145], v[144:145], v[232:233]
    v_pk_mul_f32 v[146:147], v[146:147], v[234:235]
    v_pk_mul_f32 v[148:149], v[148:149], v[232:233]
    v_pk_mul_f32 v[150:151], v[150:151], v[234:235]
    v_pk_mul_f32 v[152:153], v[152:153], v[232:233]
    v_pk_mul_f32 v[154:155], v[154:155], v[234:235]
    v_pk_mul_f32 v[156:157], v[156:157], v[232:233]
    v_pk_mul_f32 v[158:159], v[158:159], v[234:235]
    v_cvt_pk_bf16_f32 v144, v144, v148
    v_cvt_pk_bf16_f32 v148, v145, v149
    v_cvt_pk_bf16_f32 v145, v152, v156
    v_cvt_pk_bf16_f32 v149, v153, v157
    v_cvt_pk_bf16_f32 v146, v146, v150
    v_cvt_pk_bf16_f32 v150, v147, v151
    v_cvt_pk_bf16_f32 v147, v154, v158
    v_cvt_pk_bf16_f32 v151, v155, v159
    ds_write_b64 v246, v[144:145] offset:16512
    ds_write_b64 v246, v[148:149] offset:16768
    ds_write_b64 v246, v[146:147] offset:17024
    ds_write_b64 v246, v[150:151] offset:17280
    ds_read_b64_tr_b16 v[128:129], v247 offset:16384
    ds_read_b64_tr_b16 v[130:131], v247 offset:16416
    ds_read_b64_tr_b16 v[132:133], v247 offset:17408
    ds_read_b64_tr_b16 v[134:135], v247 offset:17440
    ds_read_b64_tr_b16 v[136:137], v247 offset:18432
    ds_read_b64_tr_b16 v[138:139], v247 offset:18464
    ds_read_b64_tr_b16 v[140:141], v247 offset:19456
    ds_read_b64_tr_b16 v[142:143], v247 offset:19488
    v_add_f32 v250, v250, v227
    v_fmac_f32 v250, 0x53800000, v228
    v_cmp_ngt_f32 s[46:47], s76, v250
    s_nop 1
    s_cmp_lg_u64 s[46:47], 0
    s_cselect_b32 s46, 2, 0
    s_or_b32 s34, s34, s46
    s_waitcnt lgkmcnt(6)
    buffer_store_dwordx4 v[128:131], v229, s[24:27], s44 offen offset:0 sc0 sc1
    s_waitcnt lgkmcnt(4)
    buffer_store_dwordx4 v[132:135], v229, s[24:27], s44 offen offset:1024 sc0 sc1
    s_waitcnt lgkmcnt(2)
    buffer_store_dwordx4 v[136:139], v229, s[24:27], s44 offen offset:2048 sc0 sc1
    s_waitcnt lgkmcnt(0)
    buffer_store_dwordx4 v[140:143], v229, s[24:27], s44 offen offset:3072 sc0 sc1
    s_cmp_lg_u32 s34, 0
    s_cbranch_scc1 L_slow
L_end:
    s_endpgm
L_slow:
    s_waitcnt vmcnt(0) lgkmcnt(0)
    v_and_b32 v136, 15, v231
    v_lshrrev_b32 v137, 4, v231
    v_lshlrev_b32 v128, 4, v137
    v_lshl_add_u32 v128, v136, 8, v128
    v_lshlrev_b32 v131, 3, v137
    v_lshl_add_u32 v131, v136, 8, v131
    v_lshlrev_b32 v129, 4, v231
    v_lshrrev_b32 v136, 2, v231
    v_and_b32 v137, 3, v231
    v_lshl_add_u32 v130, v136, 8, s39
    v_lshl_add_u32 v130, v137, 3, v130
    s_mov_b32 s70, 0
L_slow_pass:
    s_lshr_b32 s46, s34, s70
    s_bitcmp1_b32 s46, 0
    s_cbranch_scc0 L_slow_next
    s_xor_b32 s47, s36, s70
    s_mul_i32 s47, s47, 81920
    s_mul_i32 s48, s35, 20480
    s_add_u32 s47, s47, s48
    s_add_u32 s46, s37, s70
    s_mul_i32 s46, s46, 159744
    s_add_u32 s46, s46, s47
    s_add_u32 s20, s4, s46
    s_addc_u32 s21, s5, 0
    s_sub_u32 s47, 159744, s47
    s_min_u32 s22, s47, 20480
    s_mov_b32 s23, 0x20000
    s_xor_b32 s47, s36, s70
    s_mul_i32 s47, s47, 81920
    s_mul_i32 s48, s35, 20480
    s_add_u32 s47, s47, s48
    s_add_u32 s46, s37, s70
    s_mul_i32 s46, s46, 159744
    s_add_u32 s46, s46, s47
    s_add_u32 s24, s10, s46
    s_addc_u32 s25, s11, 0
    s_sub_u32 s47, 159744, s47
    s_min_u32 s26, s47, 20480
    s_mov_b32 s27, 0x20000
    s_mov_b32 s71, 0
L_slow_tile:
    buffer_load_dwordx4 v[0:3], v128, s[20:23], s71 offen offset:0
    buffer_load_dwordx4 v[4:7], v128, s[20:23], s71 offen offset:64
    buffer_load_dwordx4 v[8:11], v128, s[20:23], s71 offen offset:128
    buffer_load_dwordx4 v[12:15], v128, s[20:23], s71 offen offset:192
    s_mul_i32 s72, s70, 262144
    s_add_u32 s73, s72, 262144
    v_mov_b32 v132, 0xff800000
    s_waitcnt vmcnt(0)
L_slow_max:
    buffer_load_dwordx4 v[16:19], v128, s[12:15], s72 offen offset:0
    buffer_load_dwordx4 v[20:23], v128, s[12:15], s72 offen offset:64
    buffer_load_dwordx4 v[24:27], v128, s[12:15], s72 offen offset:128
    buffer_load_dwordx4 v[28:31], v128, s[12:15], s72 offen offset:192
    s_add_u32 s72, s72, 4096
    s_waitcnt vmcnt(0)
    v_mfma_f32_16x16x32_bf16 v[80:83], v[16:19], v[0:3], 0
    v_mfma_f32_16x16x32_bf16 v[80:83], v[20:23], v[4:7], v[80:83]
    v_mfma_f32_16x16x32_bf16 v[80:83], v[24:27], v[8:11], v[80:83]
    v_mfma_f32_16x16x32_bf16 v[80:83], v[28:31], v[12:15], v[80:83]
    s_nop 7
    v_max3_f32 v132, v132, v80, v81
    v_max3_f32 v132, v132, v82, v83
    s_cmp_lt_u32 s72, s73
    s_cbranch_scc1 L_slow_max
    v_mov_b32 v136, v132
    s_nop 1
    v_permlane16_swap_b32 v132, v136
    v_max_f32 v132, v132, v136
    v_mov_b32 v136, v132
    s_nop 1
    v_permlane32_swap_b32 v132, v136
    v_max_f32 v132, v132, v136
    v_mov_b32 v96, 0
    v_mov_b32 v97, 0
    v_mov_b32 v98, 0
    v_mov_b32 v99, 0
    v_mov_b32 v100, 0
    v_mov_b32 v101, 0
    v_mov_b32 v102, 0
    v_mov_b32 v103, 0
    v_mov_b32 v104, 0
    v_mov_b32 v105, 0
    v_mov_b32 v106, 0
    v_mov_b32 v107, 0
    v_mov_b32 v108, 0
    v_mov_b32 v109, 0
    v_mov_b32 v110, 0
    v_mov_b32 v111, 0
    v_mov_b32 v112, 0
    v_mov_b32 v113, 0
    v_mov_b32 v114, 0
    v_mov_b32 v115, 0
    v_mov_b32 v116, 0
    v_mov_b32 v117, 0
    v_mov_b32 v118, 0
    v_mov_b32 v119, 0
    v_mov_b32 v120, 0
    v_mov_b32 v121, 0
    v_mov_b32 v122, 0
    v_mov_b32 v123, 0
    v_mov_b32 v124, 0
    v_mov_b32 v125, 0
    v_mov_b32 v126, 0
    v_mov_b32 v127, 0
    v_mov_b32 v133, 0
    s_mul_i32 s72, s70, 262144
L_slow_blk:
    s_add_u32 m0, s39, 0
    buffer_load_dwordx4 v[16:19], v128, s[12:15], s72 offen offset:0
    buffer_load_dwordx4 v[20:23], v128, s[12:15], s72 offen offset:64
    buffer_load_dwordx4 v[24:27], v128, s[12:15], s72 offen offset:128
    buffer_load_dwordx4 v[28:31], v128, s[12:15], s72 offen offset:192
    buffer_load_dwordx4 v129, s[16:19], s72 offen offset:0 lds
    buffer_load_dwordx4 v129, s[16:19], s72 offen offset:1024 lds
    buffer_load_dwordx4 v129, s[16:19], s72 offen offset:2048 lds
    buffer_load_dwordx4 v129, s[16:19], s72 offen offset:3072 lds
    s_add_u32 s72, s72, 4096
    s_add_u32 m0, s39, 4096
    buffer_load_dwordx4 v[32:35], v128, s[12:15], s72 offen offset:0
    buffer_load_dwordx4 v[36:39], v128, s[12:15], s72 offen offset:64
    buffer_load_dwordx4 v[40:43], v128, s[12:15], s72 offen offset:128
    buffer_load_dwordx4 v[44:47], v128, s[12:15], s72 offen offset:192
    buffer_load_dwordx4 v129, s[16:19], s72 offen offset:0 lds
    buffer_load_dwordx4 v129, s[16:19], s72 offen offset:1024 lds
    buffer_load_dwordx4 v129, s[16:19], s72 offen offset:2048 lds
    buffer_load_dwordx4 v129, s[16:19], s72 offen offset:3072 lds
    s_add_u32 s72, s72, 4096
    s_waitcnt vmcnt(0)
    ds_read_b64_tr_b16 v[48:49], v130 offset:0
    ds_read_b64_tr_b16 v[50:51], v130 offset:4096
    ds_read_b64_tr_b16 v[52:53], v130 offset:32
    ds_read_b64_tr_b16 v[54:55], v130 offset:4128
    ds_read_b64_tr_b16 v[56:57], v130 offset:64
    ds_read_b64_tr_b16 v[58:59], v130 offset:4160
    ds_read_b64_tr_b16 v[60:61], v130 offset:96
    ds_read_b64_tr_b16 v[62:63], v130 offset:4192
    ds_read_b64_tr_b16 v[64:65], v130 offset:128
    ds_read_b64_tr_b16 v[66:67], v130 offset:4224
    ds_read_b64_tr_b16 v[68:69], v130 offset:160
    ds_read_b64_tr_b16 v[70:71], v130 offset:4256
    ds_read_b64_tr_b16 v[72:73], v130 offset:192
    ds_read_b64_tr_b16 v[74:75], v130 offset:4288
    ds_read_b64_tr_b16 v[76:77], v130 offset:224
    ds_read_b64_tr_b16 v[78:79], v130 offset:4320
    v_mfma_f32_16x16x32_bf16 v[80:83], v[16:19], v[0:3], 0
    v_mfma_f32_16x16x32_bf16 v[80:83], v[20:23], v[4:7], v[80:83]
    v_mfma_f32_16x16x32_bf16 v[80:83], v[24:27], v[8:11], v[80:83]
    v_mfma_f32_16x16x32_bf16 v[80:83], v[28:31], v[12:15], v[80:83]
    v_mfma_f32_16x16x32_bf16 v[84:87], v[32:35], v[0:3], 0
    v_mfma_f32_16x16x32_bf16 v[84:87], v[36:39], v[4:7], v[84:87]
    v_mfma_f32_16x16x32_bf16 v[84:87], v[40:43], v[8:11], v[84:87]
    v_mfma_f32_16x16x32_bf16 v[84:87], v[44:47], v[12:15], v[84:87]
    s_nop 7
    v_sub_f32 v80, v80, v132
    v_sub_f32 v81, v81, v132
    v_sub_f32 v82, v82, v132
    v_sub_f32 v83, v83, v132
    v_sub_f32 v84, v84, v132
    v_sub_f32 v85, v85, v132
    v_sub_f32 v86, v86, v132
    v_sub_f32 v87, v87, v132
    v_mul_f32 v80, s32, v80
    v_mul_f32 v81, s32, v81
    v_mul_f32 v82, s32, v82
    v_mul_f32 v83, s32, v83
    v_mul_f32 v84, s32, v84
    v_mul_f32 v85, s32, v85
    v_mul_f32 v86, s32, v86
    v_mul_f32 v87, s32, v87
    v_exp_f32 v80, v80
    v_exp_f32 v81, v81
    v_exp_f32 v82, v82
    v_exp_f32 v83, v83
    v_exp_f32 v84, v84
    v_exp_f32 v85, v85
    v_exp_f32 v86, v86
    v_exp_f32 v87, v87
    s_nop 0
    v_add_f32 v133, v133, v80
    v_add_f32 v133, v133, v81
    v_add_f32 v133, v133, v82
    v_add_f32 v133, v133, v83
    v_add_f32 v133, v133, v84
    v_add_f32 v133, v133, v85
    v_add_f32 v133, v133, v86
    v_add_f32 v133, v133, v87
    v_cvt_pk_bf16_f32 v88, v80, v81
    v_cvt_pk_bf16_f32 v89, v82, v83
    v_cvt_pk_bf16_f32 v90, v84, v85
    v_cvt_pk_bf16_f32 v91, v86, v87
    s_waitcnt lgkmcnt(0)
    s_nop 0
    v_mfma_f32_16x16x32_bf16 v[96:99], v[48:51], v[88:91], v[96:99]
    v_mfma_f32_16x16x32_bf16 v[100:103], v[52:55], v[88:91], v[100:103]
    v_mfma_f32_16x16x32_bf16 v[104:107], v[56:59], v[88:91], v[104:107]
    v_mfma_f32_16x16x32_bf16 v[108:111], v[60:63], v[88:91], v[108:111]
    v_mfma_f32_16x16x32_bf16 v[112:115], v[64:67], v[88:91], v[112:115]
    v_mfma_f32_16x16x32_bf16 v[116:119], v[68:71], v[88:91], v[116:119]
    v_mfma_f32_16x16x32_bf16 v[120:123], v[72:75], v[88:91], v[120:123]
    v_mfma_f32_16x16x32_bf16 v[124:127], v[76:79], v[88:91], v[124:127]
    s_cmp_lt_u32 s72, s73
    s_cbranch_scc1 L_slow_blk
    v_mov_b32 v136, v133
    s_nop 1
    v_permlane16_swap_b32 v133, v136
    v_add_f32 v133, v133, v136
    v_mov_b32 v136, v133
    s_nop 1
    v_permlane32_swap_b32 v133, v136
    v_add_f32 v133, v133, v136
    v_rcp_f32 v133, v133
    s_nop 0
    v_mul_f32 v96, v96, v133
    v_mul_f32 v97, v97, v133
    v_mul_f32 v98, v98, v133
    v_mul_f32 v99, v99, v133
    v_mul_f32 v100, v100, v133
    v_mul_f32 v101, v101, v133
    v_mul_f32 v102, v102, v133
    v_mul_f32 v103, v103, v133
    v_mul_f32 v104, v104, v133
    v_mul_f32 v105, v105, v133
    v_mul_f32 v106, v106, v133
    v_mul_f32 v107, v107, v133
    v_mul_f32 v108, v108, v133
    v_mul_f32 v109, v109, v133
    v_mul_f32 v110, v110, v133
    v_mul_f32 v111, v111, v133
    v_mul_f32 v112, v112, v133
    v_mul_f32 v113, v113, v133
    v_mul_f32 v114, v114, v133
    v_mul_f32 v115, v115, v133
    v_mul_f32 v116, v116, v133
    v_mul_f32 v117, v117, v133
    v_mul_f32 v118, v118, v133
    v_mul_f32 v119, v119, v133
    v_mul_f32 v120, v120, v133
    v_mul_f32 v121, v121, v133
    v_mul_f32 v122, v122, v133
    v_mul_f32 v123, v123, v133
    v_mul_f32 v124, v124, v133
    v_mul_f32 v125, v125, v133
    v_mul_f32 v126, v126, v133
    v_mul_f32 v127, v127, v133
    v_cvt_pk_bf16_f32 v96, v96, v97
    v_cvt_pk_bf16_f32 v97, v98, v99
    buffer_store_dwordx2 v[96:97], v131, s[24:27], s71 offen offset:0
    v_cvt_pk_bf16_f32 v100, v100, v101
    v_cvt_pk_bf16_f32 v101, v102, v103
    buffer_store_dwordx2 v[100:101], v131, s[24:27], s71 offen offset:32
    v_cvt_pk_bf16_f32 v104, v104, v105
    v_cvt_pk_bf16_f32 v105, v106, v107
    buffer_store_dwordx2 v[104:105], v131, s[24:27], s71 offen offset:64
    v_cvt_pk_bf16_f32 v108, v108, v109
    v_cvt_pk_bf16_f32 v109, v110, v111
    buffer_store_dwordx2 v[108:109], v131, s[24:27], s71 offen offset:96
    v_cvt_pk_bf16_f32 v112, v112, v113
    v_cvt_pk_bf16_f32 v113, v114, v115
    buffer_store_dwordx2 v[112:113], v131, s[24:27], s71 offen offset:128
    v_cvt_pk_bf16_f32 v116, v116, v117
    v_cvt_pk_bf16_f32 v117, v118, v119
    buffer_store_dwordx2 v[116:117], v131, s[24:27], s71 offen offset:160
    v_cvt_pk_bf16_f32 v120, v120, v121
    v_cvt_pk_bf16_f32 v121, v122, v123
    buffer_store_dwordx2 v[120:121], v131, s[24:27], s71 offen offset:192
    v_cvt_pk_bf16_f32 v124, v124, v125
    v_cvt_pk_bf16_f32 v125, v126, v127
    buffer_store_dwordx2 v[124:125], v131, s[24:27], s71 offen offset:224
    s_add_u32 s71, s71, 4096
    s_cmp_lt_u32 s71, 20480
    s_cbranch_scc1 L_slow_tile
L_slow_next:
    s_add_u32 s70, s70, 1
    s_cmp_lt_u32 s70, 2
    s_cbranch_scc1 L_slow_pass
    s_endpgm
    s_endpgm
    s_endpgm
    s_endpgm
    s_endpgm
    s_endpgm
    s_endpgm
    s_endpgm
    s_endpgm
    s_endpgm
    s_endpgm
    s_endpgm
    s_endpgm
    s_endpgm
    s_endpgm
    s_endpgm
    s_endpgm
    s_endpgm
    s_endpgm
    s_endpgm
    s_endpgm
    s_endpgm
    s_endpgm
    s_endpgm
    s_endpgm
    s_endpgm
    s_endpgm
    s_endpgm
    s_endpgm
    s_endpgm
    s_endpgm
    s_endpgm
    s_endpgm
    s_endpgm
    s_endpgm
    s_endpgm
    s_endpgm
    s_endpgm
    s_endpgm
    s_endpgm
    s_endpgm
    s_endpgm
    s_endpgm
    s_endpgm
    s_endpgm
    s_endpgm
    s_endpgm
    s_endpgm
    s_endpgm
    s_endpgm
    s_endpgm
    s_endpgm
    s_endpgm
    s_endpgm
    s_endpgm
    s_endpgm
    s_endpgm
    s_endpgm
    s_endpgm
    s_endpgm
    s_endpgm
    s_endpgm
    s_endpgm
    s_endpgm
    s_endpgm
    s_endpgm
    s_endpgm
    s_endpgm
    s_endpgm
    s_endpgm
    s_endpgm
    s_endpgm
    s_endpgm
    s_endpgm
    s_endpgm
    s_endpgm
    s_endpgm
    s_endpgm
    s_endpgm
    s_endpgm
    s_endpgm
    s_endpgm
    s_endpgm
    s_endpgm
    s_endpgm
    s_endpgm
    s_endpgm
    s_endpgm
    s_endpgm
    s_endpgm
    s_endpgm
    s_endpgm
    s_endpgm
    s_endpgm
    s_endpgm
    s_endpgm
    s_endpgm
    s_endpgm
    s_endpgm
    s_endpgm
    s_endpgm
    s_endpgm
    s_endpgm
    s_endpgm
    s_endpgm
    s_endpgm
    s_endpgm
    s_endpgm
    s_endpgm
    s_endpgm
    s_endpgm
    s_endpgm
    s_endpgm
    s_endpgm
    s_endpgm
    s_endpgm
    s_endpgm
    s_endpgm
    s_endpgm
    s_endpgm
    s_endpgm
    s_endpgm
    s_endpgm
    s_endpgm
    s_endpgm
    s_endpgm
    s_endpgm
    s_endpgm
    s_endpgm
    s_endpgm
    s_endpgm
    s_endpgm
    s_endpgm
    s_endpgm
    s_endpgm
    s_endpgm
    s_endpgm
    s_endpgm
    s_endpgm
    s_endpgm
    s_endpgm
    s_endpgm
    s_endpgm
    s_endpgm
    s_endpgm
    s_endpgm
    s_endpgm
    s_endpgm
    s_endpgm
    s_endpgm
    s_endpgm
    s_endpgm
    s_endpgm
    s_endpgm
    s_endpgm
    s_endpgm
    s_endpgm
    s_endpgm
    s_endpgm
    s_endpgm
    s_endpgm
    s_endpgm
    s_endpgm
    s_endpgm
    s_endpgm
    s_endpgm
    s_endpgm
    s_endpgm
    s_endpgm
    s_endpgm
    s_endpgm
    s_endpgm
    s_endpgm
    s_endpgm
    s_endpgm
    s_endpgm
    s_endpgm
    s_endpgm
    s_endpgm
    s_endpgm
    s_endpgm
    s_endpgm
    s_endpgm
    s_endpgm
    s_endpgm
    s_endpgm
    s_endpgm
    s_endpgm
    s_endpgm
    s_endpgm
    s_endpgm
    s_endpgm
    s_endpgm
L_all_end:
.section .rodata,"a"
.p2align 6
.amdhsa_kernel standalone__mha_softmax__near_ridge_kernel
  .amdhsa_next_free_vgpr 512
  .amdhsa_next_free_sgpr 80
  .amdhsa_accum_offset 256
  .amdhsa_group_segment_fixed_size 0
  .amdhsa_kernarg_size 48
  .amdhsa_user_sgpr_count 2
  .amdhsa_user_sgpr_kernarg_segment_ptr 1
  .amdhsa_system_sgpr_workgroup_id_x 1
.end_amdhsa_kernel
```
